```python
import torch

def _softmax(x, axis=-1):
    return torch.softmax(x, dim=axis)
def _gelu(x):
    return torch.nn.functional.gelu(x, approximate="tanh")
def _silu(x):
    return torch.nn.functional.silu(x)
def _sigmoid(x):
    return torch.sigmoid(x)
def _layernorm(x, axis=-1, eps=1e-5):
    m = x.mean(dim=axis, keepdim=True)
    v = x.var(dim=axis, keepdim=True, unbiased=False)
    return (x - m) / torch.sqrt(v + eps)
def _scatter_add(tgt, idx, src, axis=0):
    return tgt.clone().index_add_(axis, idx, src)
def _segment_sum(src, seg, n):
    out = torch.zeros((n,) + src.shape[1:], dtype=src.dtype)
    return out.index_add_(0, seg, src)
def _pad(x, pw):
    flat = tuple(v for pair in reversed(pw) for v in pair)
    return torch.nn.functional.pad(x, flat)

kernel_name = 'concat_heads__mha_block_cached__mha_block_cached__near_ridge'

def setup_inputs():

    _w = (lambda a: (lambda t: t.to(torch.bfloat16) if t.is_floating_point() else t)(torch.as_tensor(a)))
    def _A_setup():
        B, Sq, D = 8, 128, 576
        H, Sk, Dh = 32, 512, 128
        return {
            "x": _w((lambda *s: torch.randn(*s, dtype=torch.bfloat16) * 0.8)(B, Sq, D)),
            "k_cache": _w((lambda *s: torch.randn(*s, dtype=torch.bfloat16) * 0.8)(B, H, Sk, Dh)),
            "v_cache": _w((lambda *s: torch.randn(*s, dtype=torch.bfloat16) * 0.05)(B, H, Sk, Dh)),
            "wq": _w((lambda *s: torch.randn(*s, dtype=torch.bfloat16) * 0.8)(D, H * Dh) * (D ** -0.5)),
            "wo": _w((lambda *s: torch.randn(*s, dtype=torch.bfloat16) * 0.05)(H * Dh, D) * ((H * Dh) ** -0.5)),
        }
    _A_in = _A_setup()

    def _B_setup():
        B, Sq, D = 8, 128, 576
        H, Sk, Dh = 32, 512, 128
        return {
            "x": _w((lambda *s: torch.randn(*s, dtype=torch.bfloat16) * 0.8)(B, Sq, D)),
            "k_cache": _w((lambda *s: torch.randn(*s, dtype=torch.bfloat16) * 0.8)(B, H, Sk, Dh)),
            "v_cache": _w((lambda *s: torch.randn(*s, dtype=torch.bfloat16) * 0.05)(B, H, Sk, Dh)),
            "wq": _w((lambda *s: torch.randn(*s, dtype=torch.bfloat16) * 0.8)(D, H * Dh) * (D ** -0.5)),
            "wo": _w((lambda *s: torch.randn(*s, dtype=torch.bfloat16) * 0.05)(H * Dh, D) * ((H * Dh) ** -0.5)),
        }
    _B_in = _B_setup()

    return {
        "A_x": _A_in["x"],
        "A_k_cache": _A_in["k_cache"],
        "A_v_cache": _A_in["v_cache"],
        "A_wq": _A_in["wq"],
        "A_wo": _A_in["wo"],
        "B_x": _B_in["x"],
        "B_k_cache": _B_in["k_cache"],
        "B_v_cache": _B_in["v_cache"],
        "B_wq": _B_in["wq"],
        "B_wo": _B_in["wo"],
    }

def reference(A_x, A_k_cache, A_v_cache, A_wq, A_wo, B_x, B_k_cache, B_v_cache, B_wq, B_wo):
    def _A_ref(x, k_cache, v_cache, wq, wo):
        B, Sq, D = x.shape
        H, Dh = 32, 128
        q = (lambda x, *d: x.permute(*d))((x @ wq).reshape(B, Sq, H, Dh), 0, 2, 1, 3)
        scores = torch.einsum("bhqd,bhkd->bhqk", q, k_cache) * (Dh ** -0.5)
        p = _softmax(scores, axis=-1)
        o = torch.einsum("bhqk,bhkd->bhqd", p, v_cache)
        return (lambda x, *d: x.permute(*d))(o, 0, 2, 1, 3).reshape(B, Sq, H * Dh) @ wo

    def _B_ref(x, k_cache, v_cache, wq, wo):
        B, Sq, D = x.shape
        H, Dh = 32, 128
        q = (lambda x, *d: x.permute(*d))((x @ wq).reshape(B, Sq, H, Dh), 0, 2, 1, 3)
        scores = torch.einsum("bhqd,bhkd->bhqk", q, k_cache) * (Dh ** -0.5)
        p = _softmax(scores, axis=-1)
        o = torch.einsum("bhqk,bhkd->bhqd", p, v_cache)
        return (lambda x, *d: x.permute(*d))(o, 0, 2, 1, 3).reshape(B, Sq, H * Dh) @ wo

    a = _A_ref(A_x, A_k_cache, A_v_cache, A_wq, A_wo)
    b = _B_ref(B_x, B_k_cache, B_v_cache, B_wq, B_wo)
    return torch.concatenate([a, b], axis=-1)
```

```asm
; @launch grid=(256,1,1) block=(256,1,1) lds=163840
.amdgcn_target "amdgcn-amd-amdhsa--gfx950"
.text
.globl concat_heads__mha_block_cached__mha_block_cached__near_ridge_kernel
.p2align 12
.type concat_heads__mha_block_cached__mha_block_cached__near_ridge_kernel,@function
concat_heads__mha_block_cached__mha_block_cached__near_ridge_kernel:
    s_cmp_ge_u32 s2, 256
    s_cbranch_scc1 K1_END
    s_load_dwordx8 s[64:71], s[0:1], 0
    s_load_dwordx8 s[72:79], s[0:1], 40
    s_load_dwordx2 s[80:81], s[0:1], 96
    s_load_dwordx2 s[84:85], s[0:1], 32
    s_load_dwordx2 s[86:87], s[0:1], 72
    s_load_dwordx4 s[88:91], s[0:1], 80
    v_lshrrev_b32 v104, 6, v0
    v_and_b32 v0, 63, v0
    v_readfirstlane_b32 s35, v104
    s_and_b32 s36, s2, 7
    s_lshr_b32 s37, s2, 3
    s_lshr_b32 s38, s36, 2
    s_and_b32 s36, s36, 3
    s_lshl_b32 s36, s36, 2
    s_and_b32 s39, s37, 3
    s_xor_b32 s39, s39, 0
    s_add_u32 s36, s36, s39
    s_lshr_b32 s37, s37, 2
    s_lshl_b32 s24, s35, 12
    s_xor_b32 s39, s39, 0
    s_lshl_b32 s39, s39, 1
    s_add_u32 s39, s39, s37
    s_cmp_ge_u32 s39, 9
    s_cselect_b32 s34, 9, 0
    s_sub_u32 s39, s39, s34
    s_mul_i32 s39, s39, 1
    s_lshl_b32 s25, s39, 7
    s_lshl_b32 s26, s39, 19
    s_and_b32 s3, s37, 3
    s_min_u32 s3, s3, 2
    s_lshl2_add_u32 s3, s3, s35
    v_lshrrev_b32 v104, 3, v0
    s_lshl_b32 s34, s35, 5
    v_add_u32 v104, s34, v104
    v_mul_u32_u24 v104, 1152, v104
    v_and_b32 v105, 7, v0
    v_lshrrev_b32 v106, 4, v0
    v_xor_b32 v107, v105, v106
    v_xor_b32 v108, 4, v107
    v_lshlrev_b32 v107, 4, v107
    v_lshlrev_b32 v108, 4, v108
    v_add_u32 v36, v104, v107
    v_add_u32 v37, v104, v108
    v_add_u32 v38, 16384, v36
    v_add_u32 v39, 24576, v37
    v_add_u32 v37, 8192, v37
    v_and_b32 v105, 15, v0
    v_lshlrev_b32 v107, 2, v106
    v_xor_b32 v107, v105, v107
    v_lshlrev_b32 v107, 4, v107
    s_lshl_b32 s34, s35, 4
    v_add_u32 v104, s34, v106
    v_lshlrev_b32 v108, 13, v104
    v_add_u32 v22, v108, v107
    v_add_u32 v23, 31744, v22
    v_add_u32 v24, 63488, v22
    v_add_u32 v25, 95232, v22
    v_lshlrev_b32 v108, 8, v104
    v_add_u32 v21, v108, v107
    v_add_u32 v107, 0, v106
    v_xor_b32 v107, v105, v107
    v_lshlrev_b32 v107, 4, v107
    v_add_u32 v17, v108, v107
    v_add_u32 v107, 4, v106
    v_xor_b32 v107, v105, v107
    v_lshlrev_b32 v107, 4, v107
    v_add_u32 v18, v108, v107
    v_add_u32 v107, 8, v106
    v_xor_b32 v107, v105, v107
    v_lshlrev_b32 v107, 4, v107
    v_add_u32 v19, v108, v107
    v_add_u32 v107, 12, v106
    v_xor_b32 v107, v105, v107
    v_lshlrev_b32 v107, 4, v107
    v_add_u32 v20, v108, v107
    s_waitcnt lgkmcnt(0)
    s_cmp_eq_u32 s38, 0
    s_cselect_b32 s4, s64, s72
    s_cselect_b32 s5, s65, s73
    s_cselect_b32 s12, s66, s74
    s_cselect_b32 s13, s67, s75
    s_cselect_b32 s16, s68, s76
    s_cselect_b32 s17, s69, s77
    s_cselect_b32 s8, s70, s78
    s_cselect_b32 s9, s71, s79
    s_mul_i32 s34, s37, 147456
    s_add_u32 s4, s4, s34
    s_addc_u32 s5, s5, 0
    s_mov_b32 s6, 147456
    s_mov_b32 s7, 0x20000
    s_lshl_b32 s34, s36, 9
    s_add_u32 s8, s8, s34
    s_addc_u32 s9, s9, 0
    s_sub_u32 s10, 4718592, s34
    s_mov_b32 s11, 0x20000
    s_lshl_b32 s34, s37, 4
    s_add_u32 s34, s34, s36
    s_lshl_b32 s82, s34, 18
    s_add_u32 s12, s12, s82
    s_addc_u32 s13, s13, 0
    s_mov_b32 s14, 262144
    s_mov_b32 s15, 0x20000
    s_add_u32 s16, s16, s82
    s_addc_u32 s17, s17, 0
    s_mov_b32 s18, 262144
    s_mov_b32 s19, 0x20000
    s_add_u32 m0, s24, 81920
    s_nop 0
    buffer_load_dwordx4 v36, s[4:7], s25 offen offset:0  lds
    buffer_load_dwordx4 v37, s[4:7], s25 offen offset:1024  lds
    buffer_load_dwordx4 v38, s[4:7], s25 offen offset:2048  lds
    buffer_load_dwordx4 v39, s[4:7], s25 offen offset:3072  lds
    s_add_u32 s25, s25, 128
    s_cmp_eq_u32 s25, 1152
    s_cselect_b32 s25, 0, s25
    s_add_u32 m0, s24, 114688
    s_add_u32 s27, s26, 0
    buffer_load_dwordx4 v22, s[8:11], s27 offen offset:0  lds
    buffer_load_dwordx4 v23, s[8:11], s27 offen offset:1024  lds
    buffer_load_dwordx4 v24, s[8:11], s27 offen offset:2048  lds
    buffer_load_dwordx4 v25, s[8:11], s27 offen offset:3072  lds
    s_add_u32 s26, s26, 524288
    s_cmp_eq_u32 s26, 4718592
    s_cselect_b32 s26, 0, s26
    s_mov_b32 s28, 0x45800000
    s_mov_b32 s32, 0x3e0293ee
    s_mov_b32 s33, 0x3e0293ee
    s_lshl_b32 s34, s38, 3
    s_add_u32 s34, s34, s37
    s_add_u32 s34, s34, 1
    s_lshl_b32 s34, s34, 21
    s_add_u32 s82, s80, s34
    s_addc_u32 s83, s81, 0
    s_lshl_b32 s34, s36, 15
    s_add_u32 s20, s82, s34
    s_addc_u32 s21, s83, 0
    s_mov_b32 s22, 557056
    s_mov_b32 s23, 0x20000
    v_and_b32 v104, 31, v0
    v_lshrrev_b32 v107, 5, v0
    v_lshlrev_b32 v108, 8, v104
    v_xor_b32 v109, v107, v105
    v_xor_b32 v1, 0, v109
    v_lshlrev_b32 v1, 4, v1
    v_add_u32 v1, v1, v108
    v_xor_b32 v2, 2, v109
    v_lshlrev_b32 v2, 4, v2
    v_add_u32 v2, v2, v108
    v_xor_b32 v3, 4, v109
    v_lshlrev_b32 v3, 4, v3
    v_add_u32 v3, v3, v108
    v_xor_b32 v4, 6, v109
    v_lshlrev_b32 v4, 4, v4
    v_add_u32 v4, v4, v108
    v_xor_b32 v5, 8, v109
    v_lshlrev_b32 v5, 4, v5
    v_add_u32 v5, v5, v108
    v_xor_b32 v6, 10, v109
    v_lshlrev_b32 v6, 4, v6
    v_add_u32 v6, v6, v108
    v_xor_b32 v7, 12, v109
    v_lshlrev_b32 v7, 4, v7
    v_add_u32 v7, v7, v108
    v_xor_b32 v8, 14, v109
    v_lshlrev_b32 v8, 4, v8
    v_add_u32 v8, v8, v108
    v_lshrrev_b32 v109, 1, v105
    v_xor_b32 v109, v107, v109
    v_lshlrev_b32 v108, 7, v104
    s_add_u32 s34, s24, 49152
    v_add_u32 v108, s34, v108
    v_xor_b32 v32, 0, v109
    v_lshlrev_b32 v32, 4, v32
    v_add_u32 v32, v32, v108
    v_xor_b32 v33, 2, v109
    v_lshlrev_b32 v33, 4, v33
    v_add_u32 v33, v33, v108
    v_xor_b32 v34, 4, v109
    v_lshlrev_b32 v34, 4, v34
    v_add_u32 v34, v34, v108
    v_xor_b32 v35, 6, v109
    v_lshlrev_b32 v35, 4, v35
    v_add_u32 v35, v35, v108
    v_lshrrev_b32 v104, 2, v105
    v_and_b32 v108, 1, v0
    v_lshlrev_b32 v108, 4, v108
    v_and_b32 v109, 2, v0
    v_lshlrev_b32 v109, 2, v109
    v_add_u32 v108, v108, v109
    v_and_b32 v109, 16, v0
    v_lshlrev_b32 v109, 1, v109
    v_add_u32 v108, v108, v109
    v_lshlrev_b32 v109, 8, v104
    v_add_u32 v108, v108, v109
    v_lshlrev_b32 v107, 10, v107
    v_xor_b32 v109, 0, v104
    v_lshlrev_b32 v109, 6, v109
    v_add_u32 v109, v109, v108
    v_add_u32 v109, v109, v107
    v_add_u32 v9, 49152, v109
    v_add_u32 v109, v109, v107
    v_add_u32 v13, 98304, v109
    v_xor_b32 v109, 1, v104
    v_lshlrev_b32 v109, 6, v109
    v_add_u32 v109, v109, v108
    v_add_u32 v109, v109, v107
    v_add_u32 v10, 49152, v109
    v_add_u32 v109, v109, v107
    v_add_u32 v14, 98304, v109
    v_xor_b32 v109, 2, v104
    v_lshlrev_b32 v109, 6, v109
    v_add_u32 v109, v109, v108
    v_add_u32 v109, v109, v107
    v_add_u32 v11, 49152, v109
    v_add_u32 v109, v109, v107
    v_add_u32 v15, 98304, v109
    v_xor_b32 v109, 3, v104
    v_lshlrev_b32 v109, 6, v109
    v_add_u32 v109, v109, v108
    v_add_u32 v109, v109, v107
    v_add_u32 v12, 49152, v109
    v_add_u32 v109, v109, v107
    v_add_u32 v16, 98304, v109
    v_lshlrev_b32 v0, 4, v0
    s_lshl_b32 s34, s35, 13
    v_add_u32 v0, s34, v0
    s_and_b32 s96, s36, 3
    s_lshr_b32 s97, s36, 2
    s_add_u32 s68, s82, 1835008
    s_addc_u32 s69, s83, 0
    s_mov_b32 s70, 2048
    s_mov_b32 s71, 0x20000
    s_call_b64 s[30:31], K1_TD
    s_branch K1_TDE
K1_TD:
    s_add_u32 s3, s3, 4
    s_cmp_ge_u32 s3, 12
    s_cselect_b32 s34, 12, 0
    s_sub_u32 s3, s3, s34
    s_cmp_eq_u32 s3, 0
    s_cbranch_scc1 K1_TP1
    s_cmp_eq_u32 s3, 1
    s_cbranch_scc1 K1_TP2
    s_cmp_eq_u32 s3, 2
    s_cbranch_scc1 K1_TP3
    s_cmp_eq_u32 s3, 3
    s_cbranch_scc1 K1_TP4
    s_cmp_eq_u32 s3, 4
    s_cbranch_scc1 K1_TP5
    s_cmp_eq_u32 s3, 5
    s_cbranch_scc1 K1_TP6
    s_cmp_eq_u32 s3, 6
    s_cbranch_scc1 K1_TP7
    s_cmp_eq_u32 s3, 7
    s_cbranch_scc1 K1_TP8
    s_cmp_eq_u32 s3, 8
    s_cbranch_scc1 K1_TP9
    s_cmp_eq_u32 s3, 9
    s_cbranch_scc1 K1_TP10
    s_cmp_eq_u32 s3, 10
    s_cbranch_scc1 K1_TP11
    s_setpc_b64 s[30:31]
K1_TDE:
    s_add_u32 m0, s24, 98304
    s_nop 0
    buffer_load_dwordx4 v36, s[4:7], s25 offen offset:0  lds
    buffer_load_dwordx4 v37, s[4:7], s25 offen offset:1024  lds
    buffer_load_dwordx4 v38, s[4:7], s25 offen offset:2048  lds
    buffer_load_dwordx4 v39, s[4:7], s25 offen offset:3072  lds
    s_add_u32 s25, s25, 128
    s_cmp_eq_u32 s25, 1152
    s_cselect_b32 s25, 0, s25
    s_add_u32 m0, s24, 131072
    s_add_u32 s27, s26, 0
    buffer_load_dwordx4 v22, s[8:11], s27 offen offset:0  lds
    buffer_load_dwordx4 v23, s[8:11], s27 offen offset:1024  lds
    buffer_load_dwordx4 v24, s[8:11], s27 offen offset:2048  lds
    buffer_load_dwordx4 v25, s[8:11], s27 offen offset:3072  lds
    s_add_u32 s26, s26, 524288
    s_cmp_eq_u32 s26, 4718592
    s_cselect_b32 s26, 0, s26
    s_call_b64 s[30:31], K1_TD
    s_call_b64 s[30:31], K1_TD
    s_waitcnt vmcnt(12)
    ds_read_b128 a[0:3], v32 offset:32768
    ds_read_b128 a[4:7], v33 offset:32768
    ds_read_b128 a[8:11], v34 offset:32768
    ds_read_b128 a[12:15], v35 offset:32768
    s_waitcnt lgkmcnt(0)
    s_waitcnt vmcnt(8)
    s_barrier
    ds_read_b64_tr_b16 a[240:241], v13 offset:16384
    ds_read_b64_tr_b16 a[242:243], v13 offset:17408
    ds_read_b64_tr_b16 a[244:245], v14 offset:16384
    ds_read_b64_tr_b16 a[246:247], v14 offset:17408
    ds_read_b64_tr_b16 a[248:249], v15 offset:16384
    ds_read_b64_tr_b16 a[250:251], v15 offset:17408
    ds_read_b64_tr_b16 a[252:253], v16 offset:16384
    ds_read_b64_tr_b16 a[254:255], v16 offset:17408
    ds_read_b64_tr_b16 v[112:113], v13 offset:20480
    ds_read_b64_tr_b16 v[114:115], v13 offset:21504
    ds_read_b64_tr_b16 v[116:117], v14 offset:20480
    ds_read_b64_tr_b16 v[118:119], v14 offset:21504
    ds_read_b64_tr_b16 v[120:121], v15 offset:20480
    ds_read_b64_tr_b16 v[122:123], v15 offset:21504
    ds_read_b64_tr_b16 v[124:125], v16 offset:20480
    ds_read_b64_tr_b16 v[126:127], v16 offset:21504
    s_waitcnt lgkmcnt(14)
    v_mfma_f32_32x32x16_bf16 v[128:143], a[240:243], a[0:3], 0
    ds_read_b64_tr_b16 a[240:241], v13 offset:24576
    ds_read_b64_tr_b16 a[242:243], v13 offset:25600
    s_add_u32 m0, s24, 147456
    s_add_u32 s27, s26, 0
    buffer_load_dwordx4 v22, s[8:11], s27 offen offset:0  lds
    s_waitcnt lgkmcnt(14)
    v_mfma_f32_32x32x16_bf16 v[144:159], a[244:247], a[0:3], 0
    ds_read_b64_tr_b16 a[244:245], v14 offset:24576
    ds_read_b64_tr_b16 a[246:247], v14 offset:25600
    buffer_load_dwordx4 v23, s[8:11], s27 offen offset:1024  lds
    buffer_load_dwordx4 v24, s[8:11], s27 offen offset:2048  lds
    s_waitcnt lgkmcnt(14)
    v_mfma_f32_32x32x16_bf16 v[160:175], a[248:251], a[0:3], 0
    ds_read_b64_tr_b16 a[248:249], v15 offset:24576
    ds_read_b64_tr_b16 a[250:251], v15 offset:25600
    buffer_load_dwordx4 v25, s[8:11], s27 offen offset:3072  lds
    s_add_u32 s26, s26, 524288
    s_cmp_eq_u32 s26, 4718592
    s_cselect_b32 s26, 0, s26
    s_waitcnt lgkmcnt(14)
    v_mfma_f32_32x32x16_bf16 v[176:191], a[252:255], a[0:3], 0
    ds_read_b64_tr_b16 a[252:253], v16 offset:24576
    ds_read_b64_tr_b16 a[254:255], v16 offset:25600
    s_add_u32 m0, s24, 81920
    s_nop 0
    buffer_load_dwordx4 v36, s[4:7], s25 offen offset:0  lds
    buffer_load_dwordx4 v37, s[4:7], s25 offen offset:1024  lds
    s_waitcnt lgkmcnt(14)
    v_mfma_f32_32x32x16_bf16 v[128:143], v[112:115], a[4:7], v[128:143]
    ds_read_b64_tr_b16 v[112:113], v13 offset:28672
    ds_read_b64_tr_b16 v[114:115], v13 offset:29696
    buffer_load_dwordx4 v38, s[4:7], s25 offen offset:2048  lds
    buffer_load_dwordx4 v39, s[4:7], s25 offen offset:3072  lds
    s_waitcnt lgkmcnt(14)
    v_mfma_f32_32x32x16_bf16 v[144:159], v[116:119], a[4:7], v[144:159]
    ds_read_b64_tr_b16 v[116:117], v14 offset:28672
    ds_read_b64_tr_b16 v[118:119], v14 offset:29696
    s_add_u32 s25, s25, 128
    s_cmp_eq_u32 s25, 1152
    s_cselect_b32 s25, 0, s25
    s_add_u32 m0, s24, 0
    s_mov_b32 s27, 0
    s_waitcnt lgkmcnt(14)
    v_mfma_f32_32x32x16_bf16 v[160:175], v[120:123], a[4:7], v[160:175]
    ds_read_b64_tr_b16 v[120:121], v15 offset:28672
    ds_read_b64_tr_b16 v[122:123], v15 offset:29696
    s_waitcnt vmcnt(12)
    ds_read_b128 a[16:19], v32 offset:49152
    ds_read_b128 a[20:23], v33 offset:49152
    ds_read_b128 a[24:27], v34 offset:49152
    buffer_load_dwordx4 v17, s[12:15], s27 offen offset:0 nt lds
    s_waitcnt lgkmcnt(14)
    v_mfma_f32_32x32x16_bf16 v[176:191], v[124:127], a[4:7], v[176:191]
    ds_read_b64_tr_b16 v[124:125], v16 offset:28672
    ds_read_b64_tr_b16 v[126:127], v16 offset:29696
    ds_read_b128 a[28:31], v35 offset:49152
    buffer_load_dwordx4 v18, s[12:15], s27 offen offset:1024 nt lds
    buffer_load_dwordx4 v19, s[12:15], s27 offen offset:2048 nt lds
    buffer_load_dwordx4 v20, s[12:15], s27 offen offset:3072 nt lds
    v_mfma_f32_32x32x16_bf16 v[128:143], a[240:243], a[8:11], v[128:143]
    s_waitcnt lgkmcnt(14)
    v_mfma_f32_32x32x16_bf16 v[144:159], a[244:247], a[8:11], v[144:159]
    v_mfma_f32_32x32x16_bf16 v[160:175], a[248:251], a[8:11], v[160:175]
    s_waitcnt lgkmcnt(0)
    s_waitcnt vmcnt(12)
    s_barrier
    ds_read_b64_tr_b16 a[240:241], v13 offset:32768
    ds_read_b64_tr_b16 a[242:243], v13 offset:33792
    ds_read_b64_tr_b16 a[244:245], v14 offset:32768
    ds_read_b64_tr_b16 a[246:247], v14 offset:33792
    v_mfma_f32_32x32x16_bf16 v[176:191], a[252:255], a[8:11], v[176:191]
    ds_read_b64_tr_b16 a[248:249], v15 offset:32768
    ds_read_b64_tr_b16 a[250:251], v15 offset:33792
    s_add_u32 m0, s24, 114688
    s_add_u32 s27, s26, 0
    buffer_load_dwordx4 v22, s[8:11], s27 offen offset:0  lds
    v_mfma_f32_32x32x16_bf16 v[128:143], v[112:115], a[12:15], v[128:143]
    ds_read_b64_tr_b16 a[252:253], v16 offset:32768
    ds_read_b64_tr_b16 a[254:255], v16 offset:33792
    buffer_load_dwordx4 v23, s[8:11], s27 offen offset:1024  lds
    buffer_load_dwordx4 v24, s[8:11], s27 offen offset:2048  lds
    v_mfma_f32_32x32x16_bf16 v[144:159], v[116:119], a[12:15], v[144:159]
    ds_read_b64_tr_b16 v[112:113], v13 offset:36864
    ds_read_b64_tr_b16 v[114:115], v13 offset:37888
    ds_read_b64_tr_b16 v[116:117], v14 offset:36864
    ds_read_b64_tr_b16 v[118:119], v14 offset:37888
    buffer_load_dwordx4 v25, s[8:11], s27 offen offset:3072  lds
    v_mfma_f32_32x32x16_bf16 v[160:175], v[120:123], a[12:15], v[160:175]
    s_add_u32 s26, s26, 524288
    s_cmp_eq_u32 s26, 4718592
    s_cselect_b32 s26, 0, s26
    s_add_u32 m0, s24, 98304
    s_nop 0
    buffer_load_dwordx4 v36, s[4:7], s25 offen offset:0  lds
    v_mfma_f32_32x32x16_bf16 v[176:191], v[124:127], a[12:15], v[176:191]
    ds_read_b64_tr_b16 v[120:121], v15 offset:36864
    ds_read_b64_tr_b16 v[122:123], v15 offset:37888
    buffer_load_dwordx4 v37, s[4:7], s25 offen offset:1024  lds
    buffer_load_dwordx4 v38, s[4:7], s25 offen offset:2048  lds
    s_waitcnt lgkmcnt(12)
    v_mfma_f32_32x32x16_bf16 v[128:143], a[240:243], a[16:19], v[128:143]
    ds_read_b64_tr_b16 v[124:125], v16 offset:36864
    ds_read_b64_tr_b16 v[126:127], v16 offset:37888
    ds_read_b64_tr_b16 a[240:241], v13 offset:40960
    ds_read_b64_tr_b16 a[242:243], v13 offset:41984
    buffer_load_dwordx4 v39, s[4:7], s25 offen offset:3072  lds
    s_waitcnt lgkmcnt(14)
    v_mfma_f32_32x32x16_bf16 v[144:159], a[244:247], a[16:19], v[144:159]
    ds_read_b64_tr_b16 a[244:245], v14 offset:40960
    ds_read_b64_tr_b16 a[246:247], v14 offset:41984
    s_add_u32 s25, s25, 128
    s_cmp_eq_u32 s25, 1152
    s_cselect_b32 s25, 0, s25
    s_add_u32 m0, s24, 16384
    s_waitcnt lgkmcnt(14)
    v_mfma_f32_32x32x16_bf16 v[160:175], a[248:251], a[16:19], v[160:175]
    ds_read_b64_tr_b16 a[248:249], v15 offset:40960
    ds_read_b64_tr_b16 a[250:251], v15 offset:41984
    s_mov_b32 s27, 16384
    buffer_load_dwordx4 v17, s[12:15], s27 offen offset:0 nt lds
    s_waitcnt lgkmcnt(14)
    v_mfma_f32_32x32x16_bf16 v[176:191], a[252:255], a[16:19], v[176:191]
    buffer_load_dwordx4 v18, s[12:15], s27 offen offset:1024 nt lds
    buffer_load_dwordx4 v19, s[12:15], s27 offen offset:2048 nt lds
    buffer_load_dwordx4 v20, s[12:15], s27 offen offset:3072 nt lds
    s_waitcnt lgkmcnt(12)
    v_mfma_f32_32x32x16_bf16 v[128:143], v[112:115], a[20:23], v[128:143]
    ds_read_b64_tr_b16 a[252:253], v16 offset:40960
    ds_read_b64_tr_b16 a[254:255], v16 offset:41984
    ds_read_b64_tr_b16 v[112:113], v13 offset:45056
    ds_read_b64_tr_b16 v[114:115], v13 offset:46080
    s_waitcnt lgkmcnt(14)
    v_mfma_f32_32x32x16_bf16 v[144:159], v[116:119], a[20:23], v[144:159]
    ds_read_b64_tr_b16 v[116:117], v14 offset:45056
    ds_read_b64_tr_b16 v[118:119], v14 offset:46080
    s_waitcnt lgkmcnt(14)
    v_mfma_f32_32x32x16_bf16 v[160:175], v[120:123], a[20:23], v[160:175]
    ds_read_b64_tr_b16 v[120:121], v15 offset:45056
    ds_read_b64_tr_b16 v[122:123], v15 offset:46080
    s_waitcnt vmcnt(16)
    ds_read_b128 a[32:35], v32 offset:32768
    ds_read_b128 a[36:39], v33 offset:32768
    ds_read_b128 a[40:43], v34 offset:32768
    ds_read_b128 a[44:47], v35 offset:32768
    s_waitcnt lgkmcnt(14)
    v_mfma_f32_32x32x16_bf16 v[176:191], v[124:127], a[20:23], v[176:191]
    ds_read_b64_tr_b16 v[124:125], v16 offset:45056
    ds_read_b64_tr_b16 v[126:127], v16 offset:46080
    v_mfma_f32_32x32x16_bf16 v[128:143], a[240:243], a[24:27], v[128:143]
    v_mfma_f32_32x32x16_bf16 v[144:159], a[244:247], a[24:27], v[144:159]
    s_waitcnt lgkmcnt(14)
    v_mfma_f32_32x32x16_bf16 v[160:175], a[248:251], a[24:27], v[160:175]
    s_waitcnt lgkmcnt(0)
    s_barrier
    ds_read_b64_tr_b16 a[240:241], v13 offset:49152
    ds_read_b64_tr_b16 a[242:243], v13 offset:50176
    ds_read_b64_tr_b16 a[244:245], v14 offset:49152
    ds_read_b64_tr_b16 a[246:247], v14 offset:50176
    v_mfma_f32_32x32x16_bf16 v[176:191], a[252:255], a[24:27], v[176:191]
    ds_read_b64_tr_b16 a[248:249], v15 offset:49152
    ds_read_b64_tr_b16 a[250:251], v15 offset:50176
    s_add_u32 m0, s24, 131072
    s_add_u32 s27, s26, 0
    buffer_load_dwordx4 v22, s[8:11], s27 offen offset:0  lds
    v_mfma_f32_32x32x16_bf16 v[128:143], v[112:115], a[28:31], v[128:143]
    ds_read_b64_tr_b16 a[252:253], v16 offset:49152
    ds_read_b64_tr_b16 a[254:255], v16 offset:50176
    buffer_load_dwordx4 v23, s[8:11], s27 offen offset:1024  lds
    buffer_load_dwordx4 v24, s[8:11], s27 offen offset:2048  lds
    v_mfma_f32_32x32x16_bf16 v[144:159], v[116:119], a[28:31], v[144:159]
    ds_read_b64_tr_b16 v[112:113], v13 offset:53248
    ds_read_b64_tr_b16 v[114:115], v13 offset:54272
    ds_read_b64_tr_b16 v[116:117], v14 offset:53248
    ds_read_b64_tr_b16 v[118:119], v14 offset:54272
    buffer_load_dwordx4 v25, s[8:11], s27 offen offset:3072  lds
    v_mfma_f32_32x32x16_bf16 v[160:175], v[120:123], a[28:31], v[160:175]
    s_add_u32 s26, s26, 524288
    s_cmp_eq_u32 s26, 4718592
    s_cselect_b32 s26, 0, s26
    s_add_u32 m0, s24, 81920
    s_nop 0
    buffer_load_dwordx4 v36, s[4:7], s25 offen offset:0  lds
    v_mfma_f32_32x32x16_bf16 v[176:191], v[124:127], a[28:31], v[176:191]
    ds_read_b64_tr_b16 v[120:121], v15 offset:53248
    ds_read_b64_tr_b16 v[122:123], v15 offset:54272
    buffer_load_dwordx4 v37, s[4:7], s25 offen offset:1024  lds
    buffer_load_dwordx4 v38, s[4:7], s25 offen offset:2048  lds
    s_waitcnt lgkmcnt(12)
    v_mfma_f32_32x32x16_bf16 v[128:143], a[240:243], a[32:35], v[128:143]
    ds_read_b64_tr_b16 v[124:125], v16 offset:53248
    ds_read_b64_tr_b16 v[126:127], v16 offset:54272
    ds_read_b64_tr_b16 a[240:241], v13 offset:57344
    ds_read_b64_tr_b16 a[242:243], v13 offset:58368
    buffer_load_dwordx4 v39, s[4:7], s25 offen offset:3072  lds
    s_waitcnt lgkmcnt(14)
    v_mfma_f32_32x32x16_bf16 v[144:159], a[244:247], a[32:35], v[144:159]
    ds_read_b64_tr_b16 a[244:245], v14 offset:57344
    ds_read_b64_tr_b16 a[246:247], v14 offset:58368
    s_add_u32 s25, s25, 128
    s_cmp_eq_u32 s25, 1152
    s_cselect_b32 s25, 0, s25
    s_add_u32 m0, s24, 32768
    s_waitcnt lgkmcnt(14)
    v_mfma_f32_32x32x16_bf16 v[160:175], a[248:251], a[32:35], v[160:175]
    ds_read_b64_tr_b16 a[248:249], v15 offset:57344
    ds_read_b64_tr_b16 a[250:251], v15 offset:58368
    s_mov_b32 s27, 32768
    buffer_load_dwordx4 v17, s[12:15], s27 offen offset:0 nt lds
    s_waitcnt lgkmcnt(14)
    v_mfma_f32_32x32x16_bf16 v[176:191], a[252:255], a[32:35], v[176:191]
    buffer_load_dwordx4 v18, s[12:15], s27 offen offset:1024 nt lds
    buffer_load_dwordx4 v19, s[12:15], s27 offen offset:2048 nt lds
    buffer_load_dwordx4 v20, s[12:15], s27 offen offset:3072 nt lds
    s_waitcnt lgkmcnt(12)
    v_mfma_f32_32x32x16_bf16 v[128:143], v[112:115], a[36:39], v[128:143]
    ds_read_b64_tr_b16 a[252:253], v16 offset:57344
    ds_read_b64_tr_b16 a[254:255], v16 offset:58368
    ds_read_b64_tr_b16 v[112:113], v13 offset:61440
    ds_read_b64_tr_b16 v[114:115], v13 offset:62464
    s_waitcnt lgkmcnt(14)
    v_mfma_f32_32x32x16_bf16 v[144:159], v[116:119], a[36:39], v[144:159]
    ds_read_b64_tr_b16 v[116:117], v14 offset:61440
    ds_read_b64_tr_b16 v[118:119], v14 offset:62464
    s_waitcnt lgkmcnt(14)
    v_mfma_f32_32x32x16_bf16 v[160:175], v[120:123], a[36:39], v[160:175]
    ds_read_b64_tr_b16 v[120:121], v15 offset:61440
    ds_read_b64_tr_b16 v[122:123], v15 offset:62464
    s_waitcnt vmcnt(16)
    ds_read_b128 a[48:51], v32 offset:49152
    ds_read_b128 a[52:55], v33 offset:49152
    ds_read_b128 a[56:59], v34 offset:49152
    ds_read_b128 a[60:63], v35 offset:49152
    s_waitcnt lgkmcnt(14)
    v_mfma_f32_32x32x16_bf16 v[176:191], v[124:127], a[36:39], v[176:191]
    ds_read_b64_tr_b16 v[124:125], v16 offset:61440
    ds_read_b64_tr_b16 v[126:127], v16 offset:62464
    v_mfma_f32_32x32x16_bf16 v[128:143], a[240:243], a[40:43], v[128:143]
    v_mfma_f32_32x32x16_bf16 v[144:159], a[244:247], a[40:43], v[144:159]
    s_waitcnt lgkmcnt(14)
    v_mfma_f32_32x32x16_bf16 v[160:175], a[248:251], a[40:43], v[160:175]
    s_waitcnt lgkmcnt(0)
    s_barrier
    ds_read_b64_tr_b16 a[240:241], v13 offset:16384
    ds_read_b64_tr_b16 a[242:243], v13 offset:17408
    ds_read_b64_tr_b16 a[244:245], v14 offset:16384
    ds_read_b64_tr_b16 a[246:247], v14 offset:17408
    v_mfma_f32_32x32x16_bf16 v[176:191], a[252:255], a[40:43], v[176:191]
    ds_read_b64_tr_b16 a[248:249], v15 offset:16384
    ds_read_b64_tr_b16 a[250:251], v15 offset:17408
    s_add_u32 m0, s24, 147456
    s_add_u32 s27, s26, 0
    buffer_load_dwordx4 v22, s[8:11], s27 offen offset:0  lds
    v_mfma_f32_32x32x16_bf16 v[128:143], v[112:115], a[44:47], v[128:143]
    ds_read_b64_tr_b16 a[252:253], v16 offset:16384
    ds_read_b64_tr_b16 a[254:255], v16 offset:17408
    buffer_load_dwordx4 v23, s[8:11], s27 offen offset:1024  lds
    buffer_load_dwordx4 v24, s[8:11], s27 offen offset:2048  lds
    v_mfma_f32_32x32x16_bf16 v[144:159], v[116:119], a[44:47], v[144:159]
    ds_read_b64_tr_b16 v[112:113], v13 offset:20480
    ds_read_b64_tr_b16 v[114:115], v13 offset:21504
    ds_read_b64_tr_b16 v[116:117], v14 offset:20480
    ds_read_b64_tr_b16 v[118:119], v14 offset:21504
    buffer_load_dwordx4 v25, s[8:11], s27 offen offset:3072  lds
    v_mfma_f32_32x32x16_bf16 v[160:175], v[120:123], a[44:47], v[160:175]
    s_add_u32 s26, s26, 524288
    s_cmp_eq_u32 s26, 4718592
    s_cselect_b32 s26, 0, s26
    s_add_u32 m0, s24, 98304
    s_nop 0
    buffer_load_dwordx4 v36, s[4:7], s25 offen offset:0  lds
    v_mfma_f32_32x32x16_bf16 v[176:191], v[124:127], a[44:47], v[176:191]
    ds_read_b64_tr_b16 v[120:121], v15 offset:20480
    ds_read_b64_tr_b16 v[122:123], v15 offset:21504
    buffer_load_dwordx4 v37, s[4:7], s25 offen offset:1024  lds
    buffer_load_dwordx4 v38, s[4:7], s25 offen offset:2048  lds
    s_waitcnt lgkmcnt(12)
    v_mfma_f32_32x32x16_bf16 v[128:143], a[240:243], a[48:51], v[128:143]
    ds_read_b64_tr_b16 v[124:125], v16 offset:20480
    ds_read_b64_tr_b16 v[126:127], v16 offset:21504
    ds_read_b64_tr_b16 a[240:241], v13 offset:24576
    ds_read_b64_tr_b16 a[242:243], v13 offset:25600
    buffer_load_dwordx4 v39, s[4:7], s25 offen offset:3072  lds
    s_waitcnt lgkmcnt(14)
    v_mfma_f32_32x32x16_bf16 v[144:159], a[244:247], a[48:51], v[144:159]
    ds_read_b64_tr_b16 a[244:245], v14 offset:24576
    ds_read_b64_tr_b16 a[246:247], v14 offset:25600
    s_add_u32 s25, s25, 128
    s_cmp_eq_u32 s25, 1152
    s_cselect_b32 s25, 0, s25
    s_add_u32 m0, s24, 49152
    s_waitcnt lgkmcnt(14)
    v_mfma_f32_32x32x16_bf16 v[160:175], a[248:251], a[48:51], v[160:175]
    ds_read_b64_tr_b16 a[248:249], v15 offset:24576
    ds_read_b64_tr_b16 a[250:251], v15 offset:25600
    s_mov_b32 s27, 49152
    buffer_load_dwordx4 v17, s[12:15], s27 offen offset:0 nt lds
    s_waitcnt lgkmcnt(14)
    v_mfma_f32_32x32x16_bf16 v[176:191], a[252:255], a[48:51], v[176:191]
    buffer_load_dwordx4 v18, s[12:15], s27 offen offset:1024 nt lds
    buffer_load_dwordx4 v19, s[12:15], s27 offen offset:2048 nt lds
    buffer_load_dwordx4 v20, s[12:15], s27 offen offset:3072 nt lds
    s_waitcnt lgkmcnt(12)
    v_mfma_f32_32x32x16_bf16 v[128:143], v[112:115], a[52:55], v[128:143]
    ds_read_b64_tr_b16 a[252:253], v16 offset:24576
    ds_read_b64_tr_b16 a[254:255], v16 offset:25600
    ds_read_b64_tr_b16 v[112:113], v13 offset:28672
    ds_read_b64_tr_b16 v[114:115], v13 offset:29696
    s_waitcnt lgkmcnt(14)
    v_mfma_f32_32x32x16_bf16 v[144:159], v[116:119], a[52:55], v[144:159]
    ds_read_b64_tr_b16 v[116:117], v14 offset:28672
    ds_read_b64_tr_b16 v[118:119], v14 offset:29696
    s_waitcnt lgkmcnt(14)
    v_mfma_f32_32x32x16_bf16 v[160:175], v[120:123], a[52:55], v[160:175]
    ds_read_b64_tr_b16 v[120:121], v15 offset:28672
    ds_read_b64_tr_b16 v[122:123], v15 offset:29696
    s_waitcnt vmcnt(16)
    ds_read_b128 a[64:67], v32 offset:32768
    ds_read_b128 a[68:71], v33 offset:32768
    ds_read_b128 a[72:75], v34 offset:32768
    ds_read_b128 a[76:79], v35 offset:32768
    s_waitcnt lgkmcnt(14)
    v_mfma_f32_32x32x16_bf16 v[176:191], v[124:127], a[52:55], v[176:191]
    ds_read_b64_tr_b16 v[124:125], v16 offset:28672
    ds_read_b64_tr_b16 v[126:127], v16 offset:29696
    v_mfma_f32_32x32x16_bf16 v[128:143], a[240:243], a[56:59], v[128:143]
    v_mfma_f32_32x32x16_bf16 v[144:159], a[244:247], a[56:59], v[144:159]
    s_waitcnt lgkmcnt(14)
    v_mfma_f32_32x32x16_bf16 v[160:175], a[248:251], a[56:59], v[160:175]
    s_waitcnt lgkmcnt(0)
    s_barrier
    ds_read_b64_tr_b16 a[240:241], v13 offset:32768
    ds_read_b64_tr_b16 a[242:243], v13 offset:33792
    ds_read_b64_tr_b16 a[244:245], v14 offset:32768
    ds_read_b64_tr_b16 a[246:247], v14 offset:33792
    v_mfma_f32_32x32x16_bf16 v[176:191], a[252:255], a[56:59], v[176:191]
    ds_read_b64_tr_b16 a[248:249], v15 offset:32768
    ds_read_b64_tr_b16 a[250:251], v15 offset:33792
    s_add_u32 m0, s24, 114688
    s_add_u32 s27, s26, 0
    buffer_load_dwordx4 v22, s[8:11], s27 offen offset:0  lds
    v_mfma_f32_32x32x16_bf16 v[128:143], v[112:115], a[60:63], v[128:143]
    ds_read_b64_tr_b16 a[252:253], v16 offset:32768
    ds_read_b64_tr_b16 a[254:255], v16 offset:33792
    buffer_load_dwordx4 v23, s[8:11], s27 offen offset:1024  lds
    buffer_load_dwordx4 v24, s[8:11], s27 offen offset:2048  lds
    v_mfma_f32_32x32x16_bf16 v[144:159], v[116:119], a[60:63], v[144:159]
    s_branch K1_TJ1
K1_TP1:
    s_setpc_b64 s[30:31]
K1_TJ1:
    ds_read_b64_tr_b16 v[112:113], v13 offset:36864
    ds_read_b64_tr_b16 v[114:115], v13 offset:37888
    ds_read_b64_tr_b16 v[116:117], v14 offset:36864
    ds_read_b64_tr_b16 v[118:119], v14 offset:37888
    buffer_load_dwordx4 v25, s[8:11], s27 offen offset:3072  lds
    v_mfma_f32_32x32x16_bf16 v[160:175], v[120:123], a[60:63], v[160:175]
    s_add_u32 s26, s26, 524288
    s_cmp_eq_u32 s26, 4718592
    s_cselect_b32 s26, 0, s26
    s_add_u32 m0, s24, 81920
    s_nop 0
    buffer_load_dwordx4 v36, s[4:7], s25 offen offset:0  lds
    v_mfma_f32_32x32x16_bf16 v[176:191], v[124:127], a[60:63], v[176:191]
    ds_read_b64_tr_b16 v[120:121], v15 offset:36864
    ds_read_b64_tr_b16 v[122:123], v15 offset:37888
    buffer_load_dwordx4 v37, s[4:7], s25 offen offset:1024  lds
    buffer_load_dwordx4 v38, s[4:7], s25 offen offset:2048  lds
    s_waitcnt lgkmcnt(12)
    v_mfma_f32_32x32x16_bf16 v[128:143], a[240:243], a[64:67], v[128:143]
    ds_read_b64_tr_b16 v[124:125], v16 offset:36864
    ds_read_b64_tr_b16 v[126:127], v16 offset:37888
    ds_read_b64_tr_b16 a[240:241], v13 offset:40960
    ds_read_b64_tr_b16 a[242:243], v13 offset:41984
    buffer_load_dwordx4 v39, s[4:7], s25 offen offset:3072  lds
    s_waitcnt lgkmcnt(14)
    v_mfma_f32_32x32x16_bf16 v[144:159], a[244:247], a[64:67], v[144:159]
    ds_read_b64_tr_b16 a[244:245], v14 offset:40960
    ds_read_b64_tr_b16 a[246:247], v14 offset:41984
    s_add_u32 s25, s25, 128
    s_cmp_eq_u32 s25, 1152
    s_cselect_b32 s25, 0, s25
    s_add_u32 m0, s24, 65536
    s_waitcnt lgkmcnt(14)
    v_mfma_f32_32x32x16_bf16 v[160:175], a[248:251], a[64:67], v[160:175]
    ds_read_b64_tr_b16 a[248:249], v15 offset:40960
    ds_read_b64_tr_b16 a[250:251], v15 offset:41984
    s_mov_b32 s27, 0
    buffer_load_dwordx4 v21, s[16:19], s27 offen offset:0 nt lds
    s_waitcnt lgkmcnt(14)
    v_mfma_f32_32x32x16_bf16 v[176:191], a[252:255], a[64:67], v[176:191]
    buffer_load_dwordx4 v21, s[16:19], s27 offen offset:1024 nt lds
    buffer_load_dwordx4 v21, s[16:19], s27 offen offset:2048 nt lds
    buffer_load_dwordx4 v21, s[16:19], s27 offen offset:3072 nt lds
    s_waitcnt lgkmcnt(12)
    v_mfma_f32_32x32x16_bf16 v[128:143], v[112:115], a[68:71], v[128:143]
    ds_read_b64_tr_b16 a[252:253], v16 offset:40960
    ds_read_b64_tr_b16 a[254:255], v16 offset:41984
    ds_read_b64_tr_b16 v[112:113], v13 offset:45056
    ds_read_b64_tr_b16 v[114:115], v13 offset:46080
    s_waitcnt lgkmcnt(14)
    v_mfma_f32_32x32x16_bf16 v[144:159], v[116:119], a[68:71], v[144:159]
    ds_read_b64_tr_b16 v[116:117], v14 offset:45056
    ds_read_b64_tr_b16 v[118:119], v14 offset:46080
    s_waitcnt lgkmcnt(14)
    v_mfma_f32_32x32x16_bf16 v[160:175], v[120:123], a[68:71], v[160:175]
    ds_read_b64_tr_b16 v[120:121], v15 offset:45056
    ds_read_b64_tr_b16 v[122:123], v15 offset:46080
    s_waitcnt vmcnt(16)
    ds_read_b128 a[80:83], v32 offset:49152
    ds_read_b128 a[84:87], v33 offset:49152
    ds_read_b128 a[88:91], v34 offset:49152
    ds_read_b128 a[92:95], v35 offset:49152
    s_waitcnt lgkmcnt(14)
    v_mfma_f32_32x32x16_bf16 v[176:191], v[124:127], a[68:71], v[176:191]
    ds_read_b64_tr_b16 v[124:125], v16 offset:45056
    ds_read_b64_tr_b16 v[126:127], v16 offset:46080
    v_mfma_f32_32x32x16_bf16 v[128:143], a[240:243], a[72:75], v[128:143]
    v_mfma_f32_32x32x16_bf16 v[144:159], a[244:247], a[72:75], v[144:159]
    s_waitcnt lgkmcnt(14)
    v_mfma_f32_32x32x16_bf16 v[160:175], a[248:251], a[72:75], v[160:175]
    s_waitcnt lgkmcnt(0)
    s_barrier
    ds_read_b64_tr_b16 a[240:241], v13 offset:49152
    ds_read_b64_tr_b16 a[242:243], v13 offset:50176
    ds_read_b64_tr_b16 a[244:245], v14 offset:49152
    ds_read_b64_tr_b16 a[246:247], v14 offset:50176
    v_mfma_f32_32x32x16_bf16 v[176:191], a[252:255], a[72:75], v[176:191]
    ds_read_b64_tr_b16 a[248:249], v15 offset:49152
    ds_read_b64_tr_b16 a[250:251], v15 offset:50176
    s_add_u32 m0, s24, 131072
    s_add_u32 s27, s26, 0
    buffer_load_dwordx4 v22, s[8:11], s27 offen offset:0  lds
    v_mfma_f32_32x32x16_bf16 v[128:143], v[112:115], a[76:79], v[128:143]
    ds_read_b64_tr_b16 a[252:253], v16 offset:49152
    ds_read_b64_tr_b16 a[254:255], v16 offset:50176
    ds_read_b64_tr_b16 v[112:113], v13 offset:53248
    ds_read_b64_tr_b16 v[114:115], v13 offset:54272
    buffer_load_dwordx4 v23, s[8:11], s27 offen offset:1024  lds
    v_mfma_f32_32x32x16_bf16 v[144:159], v[116:119], a[76:79], v[144:159]
    ds_read_b64_tr_b16 v[116:117], v14 offset:53248
    ds_read_b64_tr_b16 v[118:119], v14 offset:54272
    buffer_load_dwordx4 v24, s[8:11], s27 offen offset:2048  lds
    buffer_load_dwordx4 v25, s[8:11], s27 offen offset:3072  lds
    v_mfma_f32_32x32x16_bf16 v[160:175], v[120:123], a[76:79], v[160:175]
    ds_read_b64_tr_b16 v[120:121], v15 offset:53248
    ds_read_b64_tr_b16 v[122:123], v15 offset:54272
    s_add_u32 s26, s26, 524288
    s_cmp_eq_u32 s26, 4718592
    s_cselect_b32 s26, 0, s26
    s_add_u32 m0, s24, 98304
    v_mfma_f32_32x32x16_bf16 v[176:191], v[124:127], a[76:79], v[176:191]
    ds_read_b64_tr_b16 v[124:125], v16 offset:53248
    ds_read_b64_tr_b16 v[126:127], v16 offset:54272
    buffer_load_dwordx4 v36, s[4:7], s25 offen offset:0  lds
    buffer_load_dwordx4 v37, s[4:7], s25 offen offset:1024  lds
    s_waitcnt lgkmcnt(14)
    v_mfma_f32_32x32x16_bf16 v[128:143], a[240:243], a[80:83], v[128:143]
    ds_read_b64_tr_b16 a[240:241], v13 offset:57344
    ds_read_b64_tr_b16 a[242:243], v13 offset:58368
    buffer_load_dwordx4 v38, s[4:7], s25 offen offset:2048  lds
    s_waitcnt lgkmcnt(14)
    v_mfma_f32_32x32x16_bf16 v[144:159], a[244:247], a[80:83], v[144:159]
    ds_read_b64_tr_b16 a[244:245], v14 offset:57344
    ds_read_b64_tr_b16 a[246:247], v14 offset:58368
    buffer_load_dwordx4 v39, s[4:7], s25 offen offset:3072  lds
    s_waitcnt lgkmcnt(14)
    v_mfma_f32_32x32x16_bf16 v[160:175], a[248:251], a[80:83], v[160:175]
    ds_read_b64_tr_b16 a[248:249], v15 offset:57344
    ds_read_b64_tr_b16 a[250:251], v15 offset:58368
    s_add_u32 s25, s25, 128
    s_cmp_eq_u32 s25, 1152
    s_cselect_b32 s25, 0, s25
    s_waitcnt lgkmcnt(14)
    v_mfma_f32_32x32x16_bf16 v[176:191], a[252:255], a[80:83], v[176:191]
    ds_read_b64_tr_b16 a[252:253], v16 offset:57344
    ds_read_b64_tr_b16 a[254:255], v16 offset:58368
    s_waitcnt lgkmcnt(14)
    v_mfma_f32_32x32x16_bf16 v[128:143], v[112:115], a[84:87], v[128:143]
    ds_read_b64_tr_b16 v[112:113], v13 offset:61440
    ds_read_b64_tr_b16 v[114:115], v13 offset:62464
    s_waitcnt lgkmcnt(14)
    v_mfma_f32_32x32x16_bf16 v[144:159], v[116:119], a[84:87], v[144:159]
    ds_read_b64_tr_b16 v[116:117], v14 offset:61440
    ds_read_b64_tr_b16 v[118:119], v14 offset:62464
    s_waitcnt lgkmcnt(14)
    v_mfma_f32_32x32x16_bf16 v[160:175], v[120:123], a[84:87], v[160:175]
    ds_read_b64_tr_b16 v[120:121], v15 offset:61440
    ds_read_b64_tr_b16 v[122:123], v15 offset:62464
    s_waitcnt vmcnt(12)
    ds_read_b128 a[96:99], v32 offset:32768
    ds_read_b128 a[100:103], v33 offset:32768
    ds_read_b128 a[104:107], v34 offset:32768
    ds_read_b128 a[108:111], v35 offset:32768
    s_waitcnt lgkmcnt(14)
    v_mfma_f32_32x32x16_bf16 v[176:191], v[124:127], a[84:87], v[176:191]
    ds_read_b64_tr_b16 v[124:125], v16 offset:61440
    ds_read_b64_tr_b16 v[126:127], v16 offset:62464
    v_mfma_f32_32x32x16_bf16 v[128:143], a[240:243], a[88:91], v[128:143]
    v_mfma_f32_32x32x16_bf16 v[144:159], a[244:247], a[88:91], v[144:159]
    s_waitcnt lgkmcnt(14)
    v_mfma_f32_32x32x16_bf16 v[160:175], a[248:251], a[88:91], v[160:175]
    s_waitcnt lgkmcnt(0)
    s_barrier
    ds_read_b64_tr_b16 a[240:241], v13 offset:16384
    ds_read_b64_tr_b16 a[242:243], v13 offset:17408
    ds_read_b64_tr_b16 a[244:245], v14 offset:16384
    ds_read_b64_tr_b16 a[246:247], v14 offset:17408
    v_mfma_f32_32x32x16_bf16 v[176:191], a[252:255], a[88:91], v[176:191]
    ds_read_b64_tr_b16 a[248:249], v15 offset:16384
    ds_read_b64_tr_b16 a[250:251], v15 offset:17408
    s_add_u32 m0, s24, 147456
    s_add_u32 s27, s26, 0
    buffer_load_dwordx4 v22, s[8:11], s27 offen offset:0  lds
    v_mfma_f32_32x32x16_bf16 v[128:143], v[112:115], a[92:95], v[128:143]
    ds_read_b64_tr_b16 a[252:253], v16 offset:16384
    ds_read_b64_tr_b16 a[254:255], v16 offset:17408
    ds_read_b64_tr_b16 v[112:113], v13 offset:20480
    ds_read_b64_tr_b16 v[114:115], v13 offset:21504
    buffer_load_dwordx4 v23, s[8:11], s27 offen offset:1024  lds
    v_mfma_f32_32x32x16_bf16 v[144:159], v[116:119], a[92:95], v[144:159]
    ds_read_b64_tr_b16 v[116:117], v14 offset:20480
    ds_read_b64_tr_b16 v[118:119], v14 offset:21504
    buffer_load_dwordx4 v24, s[8:11], s27 offen offset:2048  lds
    buffer_load_dwordx4 v25, s[8:11], s27 offen offset:3072  lds
    v_mfma_f32_32x32x16_bf16 v[160:175], v[120:123], a[92:95], v[160:175]
    ds_read_b64_tr_b16 v[120:121], v15 offset:20480
    ds_read_b64_tr_b16 v[122:123], v15 offset:21504
    s_add_u32 s26, s26, 524288
    s_cmp_eq_u32 s26, 4718592
    s_cselect_b32 s26, 0, s26
    s_add_u32 m0, s24, 81920
    v_mfma_f32_32x32x16_bf16 v[176:191], v[124:127], a[92:95], v[176:191]
    ds_read_b64_tr_b16 v[124:125], v16 offset:20480
    ds_read_b64_tr_b16 v[126:127], v16 offset:21504
    buffer_load_dwordx4 v36, s[4:7], s25 offen offset:0  lds
    buffer_load_dwordx4 v37, s[4:7], s25 offen offset:1024  lds
    s_waitcnt lgkmcnt(14)
    v_mfma_f32_32x32x16_bf16 v[128:143], a[240:243], a[96:99], v[128:143]
    ds_read_b64_tr_b16 a[240:241], v13 offset:24576
    ds_read_b64_tr_b16 a[242:243], v13 offset:25600
    buffer_load_dwordx4 v38, s[4:7], s25 offen offset:2048  lds
    s_waitcnt lgkmcnt(14)
    v_mfma_f32_32x32x16_bf16 v[144:159], a[244:247], a[96:99], v[144:159]
    ds_read_b64_tr_b16 a[244:245], v14 offset:24576
    ds_read_b64_tr_b16 a[246:247], v14 offset:25600
    buffer_load_dwordx4 v39, s[4:7], s25 offen offset:3072  lds
    s_waitcnt lgkmcnt(14)
    v_mfma_f32_32x32x16_bf16 v[160:175], a[248:251], a[96:99], v[160:175]
    ds_read_b64_tr_b16 a[248:249], v15 offset:24576
    ds_read_b64_tr_b16 a[250:251], v15 offset:25600
    s_add_u32 s25, s25, 128
    s_cmp_eq_u32 s25, 1152
    s_cselect_b32 s25, 0, s25
    s_waitcnt lgkmcnt(14)
    v_mfma_f32_32x32x16_bf16 v[176:191], a[252:255], a[96:99], v[176:191]
    ds_read_b64_tr_b16 a[252:253], v16 offset:24576
    ds_read_b64_tr_b16 a[254:255], v16 offset:25600
    s_waitcnt lgkmcnt(14)
    v_mfma_f32_32x32x16_bf16 v[128:143], v[112:115], a[100:103], v[128:143]
    ds_read_b64_tr_b16 v[112:113], v13 offset:28672
    ds_read_b64_tr_b16 v[114:115], v13 offset:29696
    s_waitcnt lgkmcnt(14)
    v_mfma_f32_32x32x16_bf16 v[144:159], v[116:119], a[100:103], v[144:159]
    ds_read_b64_tr_b16 v[116:117], v14 offset:28672
    ds_read_b64_tr_b16 v[118:119], v14 offset:29696
    s_waitcnt lgkmcnt(14)
    v_mfma_f32_32x32x16_bf16 v[160:175], v[120:123], a[100:103], v[160:175]
    ds_read_b64_tr_b16 v[120:121], v15 offset:28672
    ds_read_b64_tr_b16 v[122:123], v15 offset:29696
    s_waitcnt vmcnt(8)
    ds_read_b128 a[112:115], v32 offset:49152
    ds_read_b128 a[116:119], v33 offset:49152
    ds_read_b128 a[120:123], v34 offset:49152
    ds_read_b128 a[124:127], v35 offset:49152
    s_waitcnt lgkmcnt(14)
    v_mfma_f32_32x32x16_bf16 v[176:191], v[124:127], a[100:103], v[176:191]
    ds_read_b64_tr_b16 v[124:125], v16 offset:28672
    ds_read_b64_tr_b16 v[126:127], v16 offset:29696
    v_mfma_f32_32x32x16_bf16 v[128:143], a[240:243], a[104:107], v[128:143]
    v_mfma_f32_32x32x16_bf16 v[144:159], a[244:247], a[104:107], v[144:159]
    s_waitcnt lgkmcnt(14)
    v_mfma_f32_32x32x16_bf16 v[160:175], a[248:251], a[104:107], v[160:175]
    s_waitcnt lgkmcnt(0)
    s_barrier
    ds_read_b64_tr_b16 a[240:241], v13 offset:32768
    ds_read_b64_tr_b16 a[242:243], v13 offset:33792
    ds_read_b64_tr_b16 a[244:245], v14 offset:32768
    ds_read_b64_tr_b16 a[246:247], v14 offset:33792
    v_mfma_f32_32x32x16_bf16 v[176:191], a[252:255], a[104:107], v[176:191]
    ds_read_b64_tr_b16 a[248:249], v15 offset:32768
    ds_read_b64_tr_b16 a[250:251], v15 offset:33792
    ds_read_b64_tr_b16 a[252:253], v16 offset:32768
    ds_read_b64_tr_b16 a[254:255], v16 offset:33792
    s_add_u32 m0, s24, 114688
    s_add_u32 s27, s26, 256
    v_mfma_f32_32x32x16_bf16 v[128:143], v[112:115], a[108:111], v[128:143]
    ds_read_b64_tr_b16 v[112:113], v13 offset:36864
    ds_read_b64_tr_b16 v[114:115], v13 offset:37888
    buffer_load_dwordx4 v22, s[8:11], s27 offen offset:0  lds
    buffer_load_dwordx4 v23, s[8:11], s27 offen offset:1024  lds
    v_mfma_f32_32x32x16_bf16 v[144:159], v[116:119], a[108:111], v[144:159]
    ds_read_b64_tr_b16 v[116:117], v14 offset:36864
    ds_read_b64_tr_b16 v[118:119], v14 offset:37888
    v_mfma_f32_32x32x16_bf16 v[160:175], v[120:123], a[108:111], v[160:175]
    ds_read_b64_tr_b16 v[120:121], v15 offset:36864
    ds_read_b64_tr_b16 v[122:123], v15 offset:37888
    buffer_load_dwordx4 v24, s[8:11], s27 offen offset:2048  lds
    v_mfma_f32_32x32x16_bf16 v[176:191], v[124:127], a[108:111], v[176:191]
    ds_read_b64_tr_b16 v[124:125], v16 offset:36864
    ds_read_b64_tr_b16 v[126:127], v16 offset:37888
    buffer_load_dwordx4 v25, s[8:11], s27 offen offset:3072  lds
    s_waitcnt lgkmcnt(14)
    v_mfma_f32_32x32x16_bf16 v[128:143], a[240:243], a[112:115], v[128:143]
    ds_read_b64_tr_b16 a[240:241], v13 offset:40960
    ds_read_b64_tr_b16 a[242:243], v13 offset:41984
    s_waitcnt lgkmcnt(14)
    v_mfma_f32_32x32x16_bf16 v[144:159], a[244:247], a[112:115], v[144:159]
    ds_read_b64_tr_b16 a[244:245], v14 offset:40960
    ds_read_b64_tr_b16 a[246:247], v14 offset:41984
    s_add_u32 s26, s26, 524288
    s_cmp_eq_u32 s26, 4718592
    s_cselect_b32 s26, 0, s26
    s_waitcnt lgkmcnt(14)
    v_mfma_f32_32x32x16_bf16 v[160:175], a[248:251], a[112:115], v[160:175]
    ds_read_b64_tr_b16 a[248:249], v15 offset:40960
    ds_read_b64_tr_b16 a[250:251], v15 offset:41984
    s_waitcnt lgkmcnt(14)
    v_mfma_f32_32x32x16_bf16 v[176:191], a[252:255], a[112:115], v[176:191]
    ds_read_b64_tr_b16 a[252:253], v16 offset:40960
    ds_read_b64_tr_b16 a[254:255], v16 offset:41984
    s_waitcnt lgkmcnt(14)
    v_mfma_f32_32x32x16_bf16 v[128:143], v[112:115], a[116:119], v[128:143]
    ds_read_b64_tr_b16 v[112:113], v13 offset:45056
    ds_read_b64_tr_b16 v[114:115], v13 offset:46080
    s_waitcnt lgkmcnt(14)
    v_mfma_f32_32x32x16_bf16 v[144:159], v[116:119], a[116:119], v[144:159]
    ds_read_b64_tr_b16 v[116:117], v14 offset:45056
    ds_read_b64_tr_b16 v[118:119], v14 offset:46080
    s_waitcnt lgkmcnt(14)
    v_mfma_f32_32x32x16_bf16 v[160:175], v[120:123], a[116:119], v[160:175]
    ds_read_b64_tr_b16 v[120:121], v15 offset:45056
    ds_read_b64_tr_b16 v[122:123], v15 offset:46080
    s_waitcnt vmcnt(4)
    ds_read_b128 a[128:131], v32 offset:32768
    ds_read_b128 a[132:135], v33 offset:32768
    ds_read_b128 a[136:139], v34 offset:32768
    ds_read_b128 a[140:143], v35 offset:32768
    s_waitcnt lgkmcnt(14)
    v_mfma_f32_32x32x16_bf16 v[176:191], v[124:127], a[116:119], v[176:191]
    ds_read_b64_tr_b16 v[124:125], v16 offset:45056
    ds_read_b64_tr_b16 v[126:127], v16 offset:46080
    v_mfma_f32_32x32x16_bf16 v[128:143], a[240:243], a[120:123], v[128:143]
    v_mfma_f32_32x32x16_bf16 v[144:159], a[244:247], a[120:123], v[144:159]
    s_waitcnt lgkmcnt(14)
    v_mfma_f32_32x32x16_bf16 v[160:175], a[248:251], a[120:123], v[160:175]
    s_waitcnt lgkmcnt(0)
    s_barrier
    ds_read_b64_tr_b16 a[240:241], v13 offset:49152
    ds_read_b64_tr_b16 a[242:243], v13 offset:50176
    ds_read_b64_tr_b16 a[244:245], v14 offset:49152
    ds_read_b64_tr_b16 a[246:247], v14 offset:50176
    v_mfma_f32_32x32x16_bf16 v[176:191], a[252:255], a[120:123], v[176:191]
    ds_read_b64_tr_b16 a[248:249], v15 offset:49152
    ds_read_b64_tr_b16 a[250:251], v15 offset:50176
    s_add_u32 m0, s24, 131072
    s_add_u32 s27, s26, 256
    buffer_load_dwordx4 v22, s[8:11], s27 offen offset:0  lds
    v_mfma_f32_32x32x16_bf16 v[128:143], v[112:115], a[124:127], v[128:143]
    ds_read_b64_tr_b16 a[252:253], v16 offset:49152
    ds_read_b64_tr_b16 a[254:255], v16 offset:50176
    ds_read_b64_tr_b16 v[112:113], v13 offset:53248
    ds_read_b64_tr_b16 v[114:115], v13 offset:54272
    buffer_load_dwordx4 v23, s[8:11], s27 offen offset:1024  lds
    v_mfma_f32_32x32x16_bf16 v[144:159], v[116:119], a[124:127], v[144:159]
    ds_read_b64_tr_b16 v[116:117], v14 offset:53248
    ds_read_b64_tr_b16 v[118:119], v14 offset:54272
    buffer_load_dwordx4 v24, s[8:11], s27 offen offset:2048  lds
    buffer_load_dwordx4 v25, s[8:11], s27 offen offset:3072  lds
    v_mfma_f32_32x32x16_bf16 v[160:175], v[120:123], a[124:127], v[160:175]
    ds_read_b64_tr_b16 v[120:121], v15 offset:53248
    ds_read_b64_tr_b16 v[122:123], v15 offset:54272
    s_add_u32 s26, s26, 524288
    s_cmp_eq_u32 s26, 4718592
    s_cselect_b32 s26, 0, s26
    s_add_u32 m0, s24, 81920
    v_mfma_f32_32x32x16_bf16 v[176:191], v[124:127], a[124:127], v[176:191]
    ds_read_b64_tr_b16 v[124:125], v16 offset:53248
    ds_read_b64_tr_b16 v[126:127], v16 offset:54272
    s_mov_b32 s27, 16384
    buffer_load_dwordx4 v21, s[16:19], s27 offen offset:0 nt lds
    s_waitcnt lgkmcnt(14)
    v_mfma_f32_32x32x16_bf16 v[128:143], a[240:243], a[128:131], v[128:143]
    ds_read_b64_tr_b16 a[240:241], v13 offset:57344
    ds_read_b64_tr_b16 a[242:243], v13 offset:58368
    buffer_load_dwordx4 v21, s[16:19], s27 offen offset:1024 nt lds
    s_waitcnt lgkmcnt(14)
    v_mfma_f32_32x32x16_bf16 v[144:159], a[244:247], a[128:131], v[144:159]
    ds_read_b64_tr_b16 a[244:245], v14 offset:57344
    ds_read_b64_tr_b16 a[246:247], v14 offset:58368
    buffer_load_dwordx4 v21, s[16:19], s27 offen offset:2048 nt lds
    s_waitcnt lgkmcnt(14)
    v_mfma_f32_32x32x16_bf16 v[160:175], a[248:251], a[128:131], v[160:175]
    ds_read_b64_tr_b16 a[248:249], v15 offset:57344
    ds_read_b64_tr_b16 a[250:251], v15 offset:58368
    buffer_load_dwordx4 v21, s[16:19], s27 offen offset:3072 nt lds
    s_waitcnt lgkmcnt(14)
    v_mfma_f32_32x32x16_bf16 v[176:191], a[252:255], a[128:131], v[176:191]
    ds_read_b64_tr_b16 a[252:253], v16 offset:57344
    ds_read_b64_tr_b16 a[254:255], v16 offset:58368
    s_waitcnt lgkmcnt(14)
    v_mfma_f32_32x32x16_bf16 v[128:143], v[112:115], a[132:135], v[128:143]
    ds_read_b64_tr_b16 v[112:113], v13 offset:61440
    ds_read_b64_tr_b16 v[114:115], v13 offset:62464
    s_waitcnt lgkmcnt(14)
    v_mfma_f32_32x32x16_bf16 v[144:159], v[116:119], a[132:135], v[144:159]
    ds_read_b64_tr_b16 v[116:117], v14 offset:61440
    ds_read_b64_tr_b16 v[118:119], v14 offset:62464
    s_waitcnt lgkmcnt(14)
    v_mfma_f32_32x32x16_bf16 v[160:175], v[120:123], a[132:135], v[160:175]
    ds_read_b64_tr_b16 v[120:121], v15 offset:61440
    ds_read_b64_tr_b16 v[122:123], v15 offset:62464
    s_waitcnt lgkmcnt(14)
    v_mfma_f32_32x32x16_bf16 v[176:191], v[124:127], a[132:135], v[176:191]
    ds_read_b64_tr_b16 v[124:125], v16 offset:61440
    ds_read_b64_tr_b16 v[126:127], v16 offset:62464
    s_waitcnt lgkmcnt(14)
    v_mfma_f32_32x32x16_bf16 v[128:143], a[240:243], a[136:139], v[128:143]
    s_waitcnt lgkmcnt(12)
    v_mfma_f32_32x32x16_bf16 v[144:159], a[244:247], a[136:139], v[144:159]
    s_waitcnt lgkmcnt(10)
    v_mfma_f32_32x32x16_bf16 v[160:175], a[248:251], a[136:139], v[160:175]
    s_waitcnt lgkmcnt(0)
    s_waitcnt vmcnt(8)
    s_barrier
    ds_read_b128 v[224:227], v1 offset:0
    ds_read_b128 v[228:231], v2 offset:0
    ds_read_b128 v[232:235], v3 offset:0
    ds_read_b128 v[236:239], v4 offset:0
    v_mfma_f32_32x32x16_bf16 v[176:191], a[252:255], a[136:139], v[176:191]
    ds_read_b128 v[240:243], v5 offset:0
    ds_read_b128 v[244:247], v6 offset:0
    ds_read_b128 v[248:251], v7 offset:0
    ds_read_b128 v[252:255], v8 offset:0
    s_add_u32 m0, s24, 147456
    s_add_u32 s27, s26, 256
    v_mfma_f32_32x32x16_bf16 v[128:143], v[112:115], a[140:143], v[128:143]
    buffer_load_dwordx4 v22, s[8:11], s27 offen offset:0  lds
    buffer_load_dwordx4 v23, s[8:11], s27 offen offset:1024  lds
    v_mfma_f32_32x32x16_bf16 v[144:159], v[116:119], a[140:143], v[144:159]
    buffer_load_dwordx4 v24, s[8:11], s27 offen offset:2048  lds
    buffer_load_dwordx4 v25, s[8:11], s27 offen offset:3072  lds
    v_mfma_f32_32x32x16_bf16 v[160:175], v[120:123], a[140:143], v[160:175]
    s_add_u32 s26, s26, 524288
    s_cmp_eq_u32 s26, 4718592
    s_cselect_b32 s26, 0, s26
    v_mfma_f32_32x32x16_bf16 v[176:191], v[124:127], a[140:143], v[176:191]
    s_nop 1
    v_pk_mul_f32 v[128:129], v[128:129], s[32:33]
    v_pk_mul_f32 v[130:131], v[130:131], s[32:33]
    v_pk_mul_f32 v[132:133], v[132:133], s[32:33]
    v_cvt_pk_bf16_f32 v192, v128, v129
    v_pk_mul_f32 v[134:135], v[134:135], s[32:33]
    v_cvt_pk_bf16_f32 v193, v130, v131
    v_pk_mul_f32 v[136:137], v[136:137], s[32:33]
    v_cvt_pk_bf16_f32 v194, v132, v133
    v_pk_mul_f32 v[138:139], v[138:139], s[32:33]
    v_cvt_pk_bf16_f32 v195, v134, v135
    v_pk_mul_f32 v[140:141], v[140:141], s[32:33]
    v_cvt_pk_bf16_f32 v196, v136, v137
    v_pk_mul_f32 v[142:143], v[142:143], s[32:33]
    v_cvt_pk_bf16_f32 v197, v138, v139
    v_pk_mul_f32 v[144:145], v[144:145], s[32:33]
    v_cvt_pk_bf16_f32 v198, v140, v141
    v_pk_mul_f32 v[146:147], v[146:147], s[32:33]
    v_cvt_pk_bf16_f32 v199, v142, v143
    v_pk_mul_f32 v[148:149], v[148:149], s[32:33]
    v_cvt_pk_bf16_f32 v200, v144, v145
    v_pk_mul_f32 v[150:151], v[150:151], s[32:33]
    v_cvt_pk_bf16_f32 v201, v146, v147
    v_pk_mul_f32 v[152:153], v[152:153], s[32:33]
    v_cvt_pk_bf16_f32 v202, v148, v149
    v_pk_mul_f32 v[154:155], v[154:155], s[32:33]
    v_cvt_pk_bf16_f32 v203, v150, v151
    v_pk_mul_f32 v[156:157], v[156:157], s[32:33]
    v_cvt_pk_bf16_f32 v204, v152, v153
    v_pk_mul_f32 v[158:159], v[158:159], s[32:33]
    v_cvt_pk_bf16_f32 v205, v154, v155
    v_pk_mul_f32 v[160:161], v[160:161], s[32:33]
    v_cvt_pk_bf16_f32 v206, v156, v157
    v_pk_mul_f32 v[162:163], v[162:163], s[32:33]
    v_cvt_pk_bf16_f32 v207, v158, v159
    v_pk_mul_f32 v[164:165], v[164:165], s[32:33]
    v_cvt_pk_bf16_f32 v208, v160, v161
    v_pk_mul_f32 v[166:167], v[166:167], s[32:33]
    v_cvt_pk_bf16_f32 v209, v162, v163
    v_pk_mul_f32 v[168:169], v[168:169], s[32:33]
    v_cvt_pk_bf16_f32 v210, v164, v165
    v_pk_mul_f32 v[170:171], v[170:171], s[32:33]
    v_cvt_pk_bf16_f32 v211, v166, v167
    v_pk_mul_f32 v[172:173], v[172:173], s[32:33]
    v_cvt_pk_bf16_f32 v212, v168, v169
    v_pk_mul_f32 v[174:175], v[174:175], s[32:33]
    v_cvt_pk_bf16_f32 v213, v170, v171
    v_pk_mul_f32 v[176:177], v[176:177], s[32:33]
    v_cvt_pk_bf16_f32 v214, v172, v173
    v_pk_mul_f32 v[178:179], v[178:179], s[32:33]
    v_cvt_pk_bf16_f32 v215, v174, v175
    v_pk_mul_f32 v[180:181], v[180:181], s[32:33]
    v_cvt_pk_bf16_f32 v216, v176, v177
    v_pk_mul_f32 v[182:183], v[182:183], s[32:33]
    v_cvt_pk_bf16_f32 v217, v178, v179
    v_pk_mul_f32 v[184:185], v[184:185], s[32:33]
    v_cvt_pk_bf16_f32 v218, v180, v181
    v_pk_mul_f32 v[186:187], v[186:187], s[32:33]
    v_cvt_pk_bf16_f32 v219, v182, v183
    v_pk_mul_f32 v[188:189], v[188:189], s[32:33]
    v_cvt_pk_bf16_f32 v220, v184, v185
    v_pk_mul_f32 v[190:191], v[190:191], s[32:33]
    v_cvt_pk_bf16_f32 v221, v186, v187
    v_cvt_pk_bf16_f32 v222, v188, v189
    v_cvt_pk_bf16_f32 v223, v190, v191
    s_waitcnt lgkmcnt(7)
    v_mfma_f32_32x32x16_bf16 v[40:55], v[224:227], v[192:195], 0
    ds_read_b128 v[224:227], v1 offset:8192
    ds_read_b64_tr_b16 a[240:241], v13 offset:16384
    ds_read_b64_tr_b16 a[242:243], v13 offset:17408
    ds_read_b64_tr_b16 a[244:245], v14 offset:16384
    ds_read_b64_tr_b16 a[246:247], v14 offset:17408
    s_waitcnt lgkmcnt(11)
    v_mfma_f32_32x32x16_bf16 v[40:55], v[228:231], v[196:199], v[40:55]
    ds_read_b128 v[228:231], v2 offset:8192
    ds_read_b64_tr_b16 a[248:249], v15 offset:16384
    ds_read_b64_tr_b16 a[250:251], v15 offset:17408
    s_waitcnt lgkmcnt(13)
    v_mfma_f32_32x32x16_bf16 v[40:55], v[232:235], v[200:203], v[40:55]
    ds_read_b128 v[232:235], v3 offset:8192
    ds_read_b64_tr_b16 a[252:253], v16 offset:16384
    ds_read_b64_tr_b16 a[254:255], v16 offset:17408
    s_waitcnt lgkmcnt(14)
    v_mfma_f32_32x32x16_bf16 v[40:55], v[236:239], v[204:207], v[40:55]
    ds_read_b128 v[236:239], v4 offset:8192
    ds_read_b64_tr_b16 v[112:113], v13 offset:20480
    ds_read_b64_tr_b16 v[114:115], v13 offset:21504
    v_mfma_f32_32x32x16_bf16 v[40:55], v[240:243], v[208:211], v[40:55]
    ds_read_b128 v[240:243], v5 offset:8192
    ds_read_b64_tr_b16 v[116:117], v14 offset:20480
    ds_read_b64_tr_b16 v[118:119], v14 offset:21504
    s_waitcnt lgkmcnt(14)
    v_mfma_f32_32x32x16_bf16 v[40:55], v[244:247], v[212:215], v[40:55]
    ds_read_b128 v[244:247], v6 offset:8192
    ds_read_b64_tr_b16 v[120:121], v15 offset:20480
    ds_read_b64_tr_b16 v[122:123], v15 offset:21504
    v_mfma_f32_32x32x16_bf16 v[40:55], v[248:251], v[216:219], v[40:55]
    ds_read_b128 v[248:251], v7 offset:8192
    ds_read_b64_tr_b16 v[124:125], v16 offset:20480
    ds_read_b64_tr_b16 v[126:127], v16 offset:21504
    v_mfma_f32_32x32x16_bf16 v[40:55], v[252:255], v[220:223], v[40:55]
    ds_read_b128 v[252:255], v8 offset:8192
    v_mfma_f32_32x32x16_bf16 v[128:143], a[240:243], a[0:3], 0
    ds_read_b64_tr_b16 a[240:241], v13 offset:24576
    ds_read_b64_tr_b16 a[242:243], v13 offset:25600
    s_waitcnt lgkmcnt(14)
    v_mfma_f32_32x32x16_bf16 v[144:159], a[244:247], a[0:3], 0
    ds_read_b64_tr_b16 a[244:245], v14 offset:24576
    ds_read_b64_tr_b16 a[246:247], v14 offset:25600
    s_nop 3
    v_max3_f32 v30, v40, v41, v42
    v_max3_f32 v31, v43, v44, v45
    v_max3_f32 v30, v30, v46, v47
    v_max3_f32 v31, v31, v48, v49
    v_max3_f32 v30, v30, v50, v51
    v_max3_f32 v31, v31, v52, v53
    v_mfma_f32_32x32x16_bf16 v[160:175], a[248:251], a[0:3], 0
    ds_read_b64_tr_b16 a[248:249], v15 offset:24576
    ds_read_b64_tr_b16 a[250:251], v15 offset:25600
    v_max3_f32 v30, v30, v54, v55
    v_max_f32 v30, v30, v31
    v_mov_b32 v31, v30
    v_mfma_f32_32x32x16_bf16 v[176:191], a[252:255], a[0:3], 0
    ds_read_b64_tr_b16 a[252:253], v16 offset:24576
    v_permlane32_swap_b32 v30, v31
    v_max_f32 v30, v30, v31
    v_sub_f32 v72, 0, v30
    v_mov_b32 v73, v72
    v_mov_b32 v74, v72
    s_waitcnt lgkmcnt(14)
    v_mfma_f32_32x32x16_bf16 v[128:143], v[112:115], a[4:7], v[128:143]
    ds_read_b64_tr_b16 a[254:255], v16 offset:25600
    v_mov_b32 v75, v72
    v_mov_b32 v76, v72
    v_mov_b32 v77, v72
    v_mov_b32 v78, v72
    v_mov_b32 v79, v72
    v_mov_b32 v80, v72
    v_mfma_f32_32x32x16_bf16 v[144:159], v[116:119], a[4:7], v[144:159]
    ds_read_b64_tr_b16 v[112:113], v13 offset:28672
    ds_read_b64_tr_b16 v[114:115], v13 offset:29696
    v_mov_b32 v81, v72
    v_mov_b32 v82, v72
    v_mov_b32 v83, v72
    v_mov_b32 v84, v72
    v_mov_b32 v85, v72
    v_mov_b32 v86, v72
    s_waitcnt lgkmcnt(14)
    v_mfma_f32_32x32x16_bf16 v[160:175], v[120:123], a[4:7], v[160:175]
    ds_read_b64_tr_b16 v[116:117], v14 offset:28672
    ds_read_b64_tr_b16 v[118:119], v14 offset:29696
    v_mov_b32 v87, v72
    v_sub_f32 v40, v40, v30
    v_sub_f32 v41, v41, v30
    v_sub_f32 v42, v42, v30
    v_sub_f32 v43, v43, v30
    s_waitcnt lgkmcnt(13)
    v_mfma_f32_32x32x16_bf16 v[176:191], v[124:127], a[4:7], v[176:191]
    ds_read_b64_tr_b16 v[120:121], v15 offset:28672
    ds_read_b64_tr_b16 v[122:123], v15 offset:29696
    s_branch K1_TJ2
K1_TP2:
    s_setpc_b64 s[30:31]
K1_TJ2:
    ds_read_b64_tr_b16 v[124:125], v16 offset:28672
    ds_read_b64_tr_b16 v[126:127], v16 offset:29696
    v_sub_f32 v44, v44, v30
    v_sub_f32 v45, v45, v30
    v_sub_f32 v46, v46, v30
    v_sub_f32 v47, v47, v30
    v_sub_f32 v48, v48, v30
    v_sub_f32 v49, v49, v30
    v_sub_f32 v50, v50, v30
    v_sub_f32 v51, v51, v30
    v_sub_f32 v52, v52, v30
    v_sub_f32 v53, v53, v30
    v_sub_f32 v54, v54, v30
    v_sub_f32 v55, v55, v30
    v_mfma_f32_32x32x16_bf16 v[56:71], v[224:227], v[192:195], v[72:87]
    v_exp_f32 v104, v40
    v_exp_f32 v105, v41
    v_exp_f32 v106, v42
    s_waitcnt lgkmcnt(14)
    v_mfma_f32_32x32x16_bf16 v[128:143], a[240:243], a[8:11], v[128:143]
    v_exp_f32 v107, v43
    v_cvt_pk_bf16_f32 v88, v104, v105
    v_mfma_f32_32x32x16_bf16 v[56:71], v[228:231], v[196:199], v[56:71]
    s_waitcnt lgkmcnt(0)
    s_waitcnt vmcnt(0)
    s_barrier
    ds_read_b128 v[224:227], v1 offset:16384
    ds_read_b128 v[228:231], v2 offset:16384
    ds_read_b64_tr_b16 a[208:209], v9 offset:16384
    ds_read_b64_tr_b16 a[240:241], v13 offset:32768
    ds_read_b64_tr_b16 a[242:243], v13 offset:33792
    v_mfma_f32_32x32x16_bf16 v[144:159], a[244:247], a[8:11], v[144:159]
    ds_read_b64_tr_b16 a[210:211], v9 offset:18432
    ds_read_b64_tr_b16 a[244:245], v14 offset:32768
    ds_read_b64_tr_b16 a[246:247], v14 offset:33792
    s_add_u32 m0, s24, 114688
    v_exp_f32 v108, v44
    v_add_f32 v30, v104, v106
    v_mfma_f32_32x32x16_bf16 v[56:71], v[232:235], v[200:203], v[56:71]
    ds_read_b128 v[232:235], v3 offset:16384
    ds_read_b64_tr_b16 a[212:213], v10 offset:16384
    s_add_u32 s27, s26, 256
    v_exp_f32 v109, v45
    v_add_f32 v31, v105, v107
    v_cvt_pk_bf16_f32 v89, v106, v107
    v_mfma_f32_32x32x16_bf16 v[160:175], a[248:251], a[8:11], v[160:175]
    ds_read_b64_tr_b16 a[214:215], v10 offset:18432
    ds_read_b64_tr_b16 a[248:249], v15 offset:32768
    ds_read_b64_tr_b16 a[250:251], v15 offset:33792
    buffer_load_dwordx4 v22, s[8:11], s27 offen offset:0  lds
    v_exp_f32 v110, v46
    v_mfma_f32_32x32x16_bf16 v[56:71], v[236:239], v[204:207], v[56:71]
    ds_read_b128 v[236:239], v4 offset:16384
    ds_read_b64_tr_b16 a[216:217], v11 offset:16384
    buffer_load_dwordx4 v23, s[8:11], s27 offen offset:1024  lds
    v_add_f32 v30, v30, v108
    v_exp_f32 v111, v47
    v_mfma_f32_32x32x16_bf16 v[176:191], a[252:255], a[8:11], v[176:191]
    ds_read_b64_tr_b16 a[218:219], v11 offset:18432
    ds_read_b64_tr_b16 a[252:253], v16 offset:32768
    ds_read_b64_tr_b16 a[254:255], v16 offset:33792
    buffer_load_dwordx4 v24, s[8:11], s27 offen offset:2048  lds
    v_add_f32 v31, v31, v109
    v_cvt_pk_bf16_f32 v90, v108, v109
    v_mfma_f32_32x32x16_bf16 v[128:143], v[112:115], a[12:15], v[128:143]
    ds_read_b64_tr_b16 a[220:221], v12 offset:16384
    ds_read_b64_tr_b16 v[112:113], v13 offset:36864
    ds_read_b64_tr_b16 v[114:115], v13 offset:37888
    ds_read_b64_tr_b16 a[222:223], v12 offset:18432
    v_exp_f32 v104, v48
    v_add_f32 v30, v30, v110
    v_mfma_f32_32x32x16_bf16 v[56:71], v[240:243], v[208:211], v[56:71]
    ds_read_b128 v[240:243], v5 offset:16384
    buffer_load_dwordx4 v25, s[8:11], s27 offen offset:3072  lds
    v_exp_f32 v105, v49
    v_add_f32 v31, v31, v111
    v_cvt_pk_bf16_f32 v91, v110, v111
    v_mfma_f32_32x32x16_bf16 v[144:159], v[116:119], a[12:15], v[144:159]
    ds_read_b64_tr_b16 a[224:225], v9 offset:20480
    ds_read_b64_tr_b16 v[116:117], v14 offset:36864
    ds_read_b64_tr_b16 v[118:119], v14 offset:37888
    v_exp_f32 v106, v50
    v_add_f32 v30, v30, v104
    v_mfma_f32_32x32x16_bf16 v[56:71], v[244:247], v[212:215], v[56:71]
    ds_read_b128 v[244:247], v6 offset:16384
    ds_read_b64_tr_b16 a[226:227], v9 offset:22528
    s_add_u32 s26, s26, 524288
    s_cmp_eq_u32 s26, 4718592
    s_cselect_b32 s26, 0, s26
    v_exp_f32 v107, v51
    v_mfma_f32_32x32x16_bf16 v[160:175], v[120:123], a[12:15], v[160:175]
    ds_read_b64_tr_b16 a[228:229], v10 offset:20480
    s_add_u32 m0, s24, 98304
    s_mov_b32 s27, 32768
    v_add_f32 v31, v31, v105
    v_cvt_pk_bf16_f32 v92, v104, v105
    v_exp_f32 v108, v52
    v_mfma_f32_32x32x16_bf16 v[56:71], v[248:251], v[216:219], v[56:71]
    ds_read_b64_tr_b16 v[120:121], v15 offset:36864
    ds_read_b64_tr_b16 v[122:123], v15 offset:37888
    buffer_load_dwordx4 v21, s[16:19], s27 offen offset:0 nt lds
    v_add_f32 v30, v30, v106
    v_exp_f32 v109, v53
    v_mfma_f32_32x32x16_bf16 v[176:191], v[124:127], a[12:15], v[176:191]
    ds_read_b128 v[248:251], v7 offset:16384
    ds_read_b64_tr_b16 a[230:231], v10 offset:22528
    ds_read_b64_tr_b16 a[232:233], v11 offset:20480
    ds_read_b64_tr_b16 v[124:125], v16 offset:36864
    ds_read_b64_tr_b16 v[126:127], v16 offset:37888
    v_add_f32 v31, v31, v107
    v_cvt_pk_bf16_f32 v93, v106, v107
    v_mfma_f32_32x32x16_bf16 v[56:71], v[252:255], v[220:223], v[56:71]
    ds_read_b128 v[252:255], v8 offset:16384
    ds_read_b64_tr_b16 a[234:235], v11 offset:22528
    buffer_load_dwordx4 v21, s[16:19], s27 offen offset:1024 nt lds
    v_exp_f32 v110, v54
    v_add_f32 v30, v30, v108
    s_waitcnt lgkmcnt(14)
    v_mfma_f32_32x32x16_bf16 v[128:143], a[240:243], a[16:19], v[128:143]
    ds_read_b64_tr_b16 a[236:237], v12 offset:20480
    ds_read_b64_tr_b16 a[240:241], v13 offset:40960
    buffer_load_dwordx4 v21, s[16:19], s27 offen offset:2048 nt lds
    v_exp_f32 v111, v55
    v_add_f32 v31, v31, v109
    v_mfma_f32_32x32x16_bf16 v[144:159], a[244:247], a[16:19], v[144:159]
    ds_read_b64_tr_b16 a[242:243], v13 offset:41984
    ds_read_b64_tr_b16 a[238:239], v12 offset:22528
    ds_read_b64_tr_b16 a[244:245], v14 offset:40960
    ds_read_b64_tr_b16 a[246:247], v14 offset:41984
    buffer_load_dwordx4 v21, s[16:19], s27 offen offset:3072 nt lds
    v_cvt_pk_bf16_f32 v94, v108, v109
    v_add_f32 v30, v30, v110
    v_add_f32 v31, v31, v111
    v_cvt_pk_bf16_f32 v95, v110, v111
    v_add_f32 v28, v30, v31
    v_mfma_f32_32x32x16_bf16 v[40:55], v[224:227], v[192:195], v[72:87]
    ds_read_b128 v[224:227], v1 offset:24576
    s_add_u32 m0, s24, 0
    v_exp_f32 v104, v56
    v_exp_f32 v105, v57
    v_mfma_f32_32x32x16_bf16 v[40:55], v[228:231], v[196:199], v[40:55]
    ds_read_b128 v[228:231], v2 offset:24576
    s_mov_b32 s27, 65536
    v_exp_f32 v106, v58
    v_mfma_f32_32x32x16_bf16 v[160:175], a[248:251], a[16:19], v[160:175]
    ds_read_b64_tr_b16 a[248:249], v15 offset:40960
    ds_read_b64_tr_b16 a[250:251], v15 offset:41984
    buffer_load_dwordx4 v17, s[12:15], s27 offen offset:0 nt lds
    v_exp_f32 v107, v59
    v_mfma_f32_32x32x16_bf16 a[144:159], a[208:211], v[88:91], 0
    ds_read_b64_tr_b16 a[208:209], v9 offset:24576
    ds_read_b64_tr_b16 a[210:211], v9 offset:26624
    v_cvt_pk_bf16_f32 v96, v104, v105
    v_exp_f32 v108, v60
    v_mfma_f32_32x32x16_bf16 v[40:55], v[232:235], v[200:203], v[40:55]
    ds_read_b128 v[232:235], v3 offset:24576
    buffer_load_dwordx4 v18, s[12:15], s27 offen offset:1024 nt lds
    v_add_f32 v30, v104, v106
    v_exp_f32 v109, v61
    v_mfma_f32_32x32x16_bf16 v[176:191], a[252:255], a[16:19], v[176:191]
    ds_read_b64_tr_b16 a[252:253], v16 offset:40960
    ds_read_b64_tr_b16 a[254:255], v16 offset:41984
    v_add_f32 v31, v105, v107
    v_cvt_pk_bf16_f32 v97, v106, v107
    v_mfma_f32_32x32x16_bf16 a[160:175], a[212:215], v[88:91], 0
    ds_read_b64_tr_b16 a[212:213], v10 offset:24576
    ds_read_b64_tr_b16 a[214:215], v10 offset:26624
    buffer_load_dwordx4 v19, s[12:15], s27 offen offset:2048 nt lds
    v_exp_f32 v110, v62
    v_mfma_f32_32x32x16_bf16 v[128:143], v[112:115], a[20:23], v[128:143]
    ds_read_b64_tr_b16 v[112:113], v13 offset:45056
    ds_read_b64_tr_b16 v[114:115], v13 offset:46080
    v_add_f32 v30, v30, v108
    v_exp_f32 v111, v63
    v_mfma_f32_32x32x16_bf16 v[40:55], v[236:239], v[204:207], v[40:55]
    ds_read_b128 v[236:239], v4 offset:24576
    buffer_load_dwordx4 v20, s[12:15], s27 offen offset:3072 nt lds
    v_add_f32 v31, v31, v109
    v_mfma_f32_32x32x16_bf16 a[176:191], a[216:219], v[88:91], 0
    ds_read_b64_tr_b16 a[216:217], v11 offset:24576
    ds_read_b64_tr_b16 a[218:219], v11 offset:26624
    v_cvt_pk_bf16_f32 v98, v108, v109
    v_exp_f32 v104, v64
    s_waitcnt lgkmcnt(14)
    v_mfma_f32_32x32x16_bf16 v[144:159], v[116:119], a[20:23], v[144:159]
    ds_read_b64_tr_b16 v[116:117], v14 offset:45056
    ds_read_b64_tr_b16 v[118:119], v14 offset:46080
    v_add_f32 v30, v30, v110
    v_mfma_f32_32x32x16_bf16 v[40:55], v[240:243], v[208:211], v[40:55]
    ds_read_b128 v[240:243], v5 offset:24576
    v_exp_f32 v105, v65
    v_add_f32 v31, v31, v111
    v_mfma_f32_32x32x16_bf16 v[160:175], v[120:123], a[20:23], v[160:175]
    ds_read_b64_tr_b16 v[120:121], v15 offset:45056
    ds_read_b64_tr_b16 v[122:123], v15 offset:46080
    v_cvt_pk_bf16_f32 v99, v110, v111
    v_exp_f32 v106, v66
    v_mfma_f32_32x32x16_bf16 a[192:207], a[220:223], v[88:91], 0
    ds_read_b64_tr_b16 a[220:221], v12 offset:24576
    ds_read_b64_tr_b16 a[222:223], v12 offset:26624
    v_add_f32 v30, v30, v104
    v_mfma_f32_32x32x16_bf16 v[40:55], v[244:247], v[212:215], v[40:55]
    ds_read_b128 v[244:247], v6 offset:24576
    v_exp_f32 v107, v67
    v_add_f32 v31, v31, v105
    v_mfma_f32_32x32x16_bf16 v[176:191], v[124:127], a[20:23], v[176:191]
    ds_read_b64_tr_b16 v[124:125], v16 offset:45056
    ds_read_b64_tr_b16 v[126:127], v16 offset:46080
    v_cvt_pk_bf16_f32 v100, v104, v105
    v_mfma_f32_32x32x16_bf16 a[144:159], a[224:227], v[92:95], a[144:159]
    ds_read_b64_tr_b16 a[224:225], v9 offset:28672
    ds_read_b64_tr_b16 a[226:227], v9 offset:30720
    v_exp_f32 v108, v68
    v_add_f32 v30, v30, v106
    v_mfma_f32_32x32x16_bf16 v[40:55], v[248:251], v[216:219], v[40:55]
    ds_read_b128 v[248:251], v7 offset:24576
    v_exp_f32 v109, v69
    v_mfma_f32_32x32x16_bf16 v[128:143], a[240:243], a[24:27], v[128:143]
    v_and_b32 v36, 0x1f0, v0
    v_lshrrev_b32 v36, 2, v36
    s_lshl_b32 s94, s97, 8
    buffer_load_dword v26, v36, s[68:71], s94 offen sc1
    s_and_b32 s94, s96, 1
    s_lshl_b32 s94, s94, 8
    s_add_u32 s94, s94, 1024
    buffer_load_dword v27, v36, s[68:71], s94 offen sc1
    v_mfma_f32_32x32x16_bf16 a[160:175], a[228:231], v[92:95], a[160:175]
    ds_read_b64_tr_b16 a[240:241], v13 offset:49152
    ds_read_b64_tr_b16 a[242:243], v13 offset:50176
    ds_read_b64_tr_b16 a[228:229], v10 offset:28672
    ds_read_b64_tr_b16 a[230:231], v10 offset:30720
    v_add_f32 v31, v31, v107
    v_cvt_pk_bf16_f32 v101, v106, v107
    v_mfma_f32_32x32x16_bf16 v[144:159], a[244:247], a[24:27], v[144:159]
    ds_read_b64_tr_b16 a[244:245], v14 offset:49152
    ds_read_b64_tr_b16 a[246:247], v14 offset:50176
    v_exp_f32 v110, v70
    v_add_f32 v30, v30, v108
    v_mfma_f32_32x32x16_bf16 v[40:55], v[252:255], v[220:223], v[40:55]
    ds_read_b128 v[252:255], v8 offset:24576
    v_exp_f32 v111, v71
    v_add_f32 v31, v31, v109
    v_cvt_pk_bf16_f32 v102, v108, v109
    v_mfma_f32_32x32x16_bf16 a[176:191], a[232:235], v[92:95], a[176:191]
    ds_read_b64_tr_b16 a[232:233], v11 offset:28672
    ds_read_b64_tr_b16 a[234:235], v11 offset:30720
    v_add_f32 v30, v30, v110
    v_add_f32 v31, v31, v111
    v_cvt_pk_bf16_f32 v103, v110, v111
    s_waitcnt lgkmcnt(14)
    v_mfma_f32_32x32x16_bf16 v[160:175], a[248:251], a[24:27], v[160:175]
    ds_read_b64_tr_b16 a[248:249], v15 offset:49152
    ds_read_b64_tr_b16 a[250:251], v15 offset:50176
    v_add_f32 v30, v30, v31
    v_cmp_nge_f32 vcc, s28, v30
    v_mfma_f32_32x32x16_bf16 a[192:207], a[236:239], v[92:95], a[192:207]
    ds_read_b64_tr_b16 a[236:237], v12 offset:28672
    ds_read_b64_tr_b16 a[238:239], v12 offset:30720
    s_cbranch_vccnz K1_STUB_1
K1_BACK_1:
    v_add_f32 v28, v28, v30
    v_mfma_f32_32x32x16_bf16 v[176:191], a[252:255], a[24:27], v[176:191]
    ds_read_b64_tr_b16 a[252:253], v16 offset:49152
    ds_read_b64_tr_b16 a[254:255], v16 offset:50176
    v_mfma_f32_32x32x16_bf16 v[56:71], v[224:227], v[192:195], v[72:87]
    v_exp_f32 v104, v40
    v_exp_f32 v105, v41
    v_mfma_f32_32x32x16_bf16 v[56:71], v[228:231], v[196:199], v[56:71]
    v_exp_f32 v106, v42
    v_mfma_f32_32x32x16_bf16 v[128:143], v[112:115], a[28:31], v[128:143]
    s_waitcnt lgkmcnt(0)
    s_waitcnt vmcnt(10)
    s_barrier
    ds_read_b128 v[224:227], v1 offset:32768
    ds_read_b128 v[228:231], v2 offset:32768
    ds_read_b64_tr_b16 v[112:113], v13 offset:53248
    ds_read_b64_tr_b16 v[114:115], v13 offset:54272
    v_mfma_f32_32x32x16_bf16 a[144:159], a[208:211], v[96:99], a[144:159]
    ds_read_b64_tr_b16 a[208:209], v9 offset:32768
    ds_read_b64_tr_b16 a[210:211], v9 offset:34816
    s_add_u32 m0, s24, 131072
    v_exp_f32 v107, v43
    v_cvt_pk_bf16_f32 v88, v104, v105
    v_mfma_f32_32x32x16_bf16 v[56:71], v[232:235], v[200:203], v[56:71]
    ds_read_b128 v[232:235], v3 offset:32768
    s_add_u32 s27, s26, 256
    v_exp_f32 v108, v44
    v_add_f32 v30, v104, v106
    v_mfma_f32_32x32x16_bf16 v[144:159], v[116:119], a[28:31], v[144:159]
    ds_read_b64_tr_b16 v[116:117], v14 offset:53248
    ds_read_b64_tr_b16 v[118:119], v14 offset:54272
    buffer_load_dwordx4 v22, s[8:11], s27 offen offset:0  lds
    v_exp_f32 v109, v45
    v_mfma_f32_32x32x16_bf16 a[160:175], a[212:215], v[96:99], a[160:175]
    ds_read_b64_tr_b16 a[212:213], v10 offset:32768
    ds_read_b64_tr_b16 a[214:215], v10 offset:34816
    v_add_f32 v31, v105, v107
    v_cvt_pk_bf16_f32 v89, v106, v107
    v_exp_f32 v110, v46
    v_mfma_f32_32x32x16_bf16 v[160:175], v[120:123], a[28:31], v[160:175]
    ds_read_b64_tr_b16 v[120:121], v15 offset:53248
    ds_read_b64_tr_b16 v[122:123], v15 offset:54272
    buffer_load_dwordx4 v23, s[8:11], s27 offen offset:1024  lds
    v_add_f32 v30, v30, v108
    v_mfma_f32_32x32x16_bf16 v[56:71], v[236:239], v[204:207], v[56:71]
    ds_read_b128 v[236:239], v4 offset:32768
    buffer_load_dwordx4 v24, s[8:11], s27 offen offset:2048  lds
    v_exp_f32 v111, v47
    v_add_f32 v31, v31, v109
    v_mfma_f32_32x32x16_bf16 a[176:191], a[216:219], v[96:99], a[176:191]
    ds_read_b64_tr_b16 a[216:217], v11 offset:32768
    ds_read_b64_tr_b16 a[218:219], v11 offset:34816
    v_cvt_pk_bf16_f32 v90, v108, v109
    v_exp_f32 v104, v48
    v_mfma_f32_32x32x16_bf16 v[176:191], v[124:127], a[28:31], v[176:191]
    ds_read_b64_tr_b16 v[124:125], v16 offset:53248
    ds_read_b64_tr_b16 v[126:127], v16 offset:54272
    buffer_load_dwordx4 v25, s[8:11], s27 offen offset:3072  lds
    v_add_f32 v30, v30, v110
    v_mfma_f32_32x32x16_bf16 v[56:71], v[240:243], v[208:211], v[56:71]
    ds_read_b128 v[240:243], v5 offset:32768
    v_exp_f32 v105, v49
    v_add_f32 v31, v31, v111
    v_mfma_f32_32x32x16_bf16 v[128:143], a[240:243], a[32:35], v[128:143]
    ds_read_b64_tr_b16 a[240:241], v13 offset:57344
    ds_read_b64_tr_b16 a[242:243], v13 offset:58368
    v_cvt_pk_bf16_f32 v91, v110, v111
    v_exp_f32 v106, v50
    v_mfma_f32_32x32x16_bf16 a[192:207], a[220:223], v[96:99], a[192:207]
    ds_read_b64_tr_b16 a[220:221], v12 offset:32768
    ds_read_b64_tr_b16 a[222:223], v12 offset:34816
    s_add_u32 s26, s26, 524288
    s_cmp_eq_u32 s26, 4718592
    s_cselect_b32 s26, 0, s26
    v_add_f32 v30, v30, v104
    v_mfma_f32_32x32x16_bf16 v[56:71], v[244:247], v[212:215], v[56:71]
    ds_read_b128 v[244:247], v6 offset:32768
    v_exp_f32 v107, v51
    v_add_f32 v31, v31, v105
    v_mfma_f32_32x32x16_bf16 v[144:159], a[244:247], a[32:35], v[144:159]
    ds_read_b64_tr_b16 a[244:245], v14 offset:57344
    ds_read_b64_tr_b16 a[246:247], v14 offset:58368
    s_add_u32 m0, s24, 65536
    v_cvt_pk_bf16_f32 v92, v104, v105
    v_mfma_f32_32x32x16_bf16 a[144:159], a[224:227], v[100:103], a[144:159]
    ds_read_b64_tr_b16 a[224:225], v9 offset:36864
    ds_read_b64_tr_b16 a[226:227], v9 offset:38912
    s_mov_b32 s27, 49152
    v_exp_f32 v108, v52
    v_add_f32 v30, v30, v106
    v_mfma_f32_32x32x16_bf16 v[56:71], v[248:251], v[216:219], v[56:71]
    ds_read_b128 v[248:251], v7 offset:32768
    buffer_load_dwordx4 v21, s[16:19], s27 offen offset:0 nt lds
    v_exp_f32 v109, v53
    v_mfma_f32_32x32x16_bf16 v[160:175], a[248:251], a[32:35], v[160:175]
    ds_read_b64_tr_b16 a[248:249], v15 offset:57344
    ds_read_b64_tr_b16 a[250:251], v15 offset:58368
    v_add_f32 v31, v31, v107
    v_cvt_pk_bf16_f32 v93, v106, v107
    v_mfma_f32_32x32x16_bf16 a[160:175], a[228:231], v[100:103], a[160:175]
    ds_read_b64_tr_b16 a[228:229], v10 offset:36864
    ds_read_b64_tr_b16 a[230:231], v10 offset:38912
    v_exp_f32 v110, v54
    v_add_f32 v30, v30, v108
    v_mfma_f32_32x32x16_bf16 v[176:191], a[252:255], a[32:35], v[176:191]
    ds_read_b64_tr_b16 a[252:253], v16 offset:57344
    ds_read_b64_tr_b16 a[254:255], v16 offset:58368
    buffer_load_dwordx4 v21, s[16:19], s27 offen offset:1024 nt lds
    v_exp_f32 v111, v55
    v_mfma_f32_32x32x16_bf16 v[56:71], v[252:255], v[220:223], v[56:71]
    ds_read_b128 v[252:255], v8 offset:32768
    buffer_load_dwordx4 v21, s[16:19], s27 offen offset:2048 nt lds
    v_add_f32 v31, v31, v109
    v_cvt_pk_bf16_f32 v94, v108, v109
    v_mfma_f32_32x32x16_bf16 a[176:191], a[232:235], v[100:103], a[176:191]
    ds_read_b64_tr_b16 a[232:233], v11 offset:36864
    ds_read_b64_tr_b16 a[234:235], v11 offset:38912
    v_add_f32 v30, v30, v110
    v_add_f32 v31, v31, v111
    v_cvt_pk_bf16_f32 v95, v110, v111
    s_waitcnt lgkmcnt(14)
    v_mfma_f32_32x32x16_bf16 v[128:143], v[112:115], a[36:39], v[128:143]
    ds_read_b64_tr_b16 v[112:113], v13 offset:61440
    ds_read_b64_tr_b16 v[114:115], v13 offset:62464
    buffer_load_dwordx4 v21, s[16:19], s27 offen offset:3072 nt lds
    v_add_f32 v30, v30, v31
    v_cmp_nge_f32 vcc, s28, v30
    v_mfma_f32_32x32x16_bf16 a[192:207], a[236:239], v[100:103], a[192:207]
    ds_read_b64_tr_b16 a[236:237], v12 offset:36864
    ds_read_b64_tr_b16 a[238:239], v12 offset:38912
    s_cbranch_vccnz K1_STUB_2
K1_BACK_2:
    v_add_f32 v28, v28, v30
    v_mfma_f32_32x32x16_bf16 v[144:159], v[116:119], a[36:39], v[144:159]
    ds_read_b64_tr_b16 v[116:117], v14 offset:61440
    ds_read_b64_tr_b16 v[118:119], v14 offset:62464
    v_mfma_f32_32x32x16_bf16 v[40:55], v[224:227], v[192:195], v[72:87]
    ds_read_b128 v[224:227], v1 offset:40960
    s_add_u32 m0, s24, 16384
    v_exp_f32 v104, v56
    v_exp_f32 v105, v57
    v_mfma_f32_32x32x16_bf16 v[40:55], v[228:231], v[196:199], v[40:55]
    ds_read_b128 v[228:231], v2 offset:40960
    v_exp_f32 v106, v58
    v_mfma_f32_32x32x16_bf16 v[160:175], v[120:123], a[36:39], v[160:175]
    ds_read_b64_tr_b16 v[120:121], v15 offset:61440
    ds_read_b64_tr_b16 v[122:123], v15 offset:62464
    s_mov_b32 s27, 81920
    v_exp_f32 v107, v59
    v_cvt_pk_bf16_f32 v96, v104, v105
    v_mfma_f32_32x32x16_bf16 a[144:159], a[208:211], v[88:91], a[144:159]
    ds_read_b64_tr_b16 a[208:209], v9 offset:40960
    ds_read_b64_tr_b16 a[210:211], v9 offset:43008
    v_exp_f32 v108, v60
    v_mfma_f32_32x32x16_bf16 v[40:55], v[232:235], v[200:203], v[40:55]
    ds_read_b128 v[232:235], v3 offset:40960
    v_add_f32 v30, v104, v106
    v_exp_f32 v109, v61
    v_mfma_f32_32x32x16_bf16 v[176:191], v[124:127], a[36:39], v[176:191]
    ds_read_b64_tr_b16 v[124:125], v16 offset:61440
    ds_read_b64_tr_b16 v[126:127], v16 offset:62464
    v_add_f32 v31, v105, v107
    v_cvt_pk_bf16_f32 v97, v106, v107
    v_mfma_f32_32x32x16_bf16 a[160:175], a[212:215], v[88:91], a[160:175]
    ds_read_b64_tr_b16 a[212:213], v10 offset:40960
    ds_read_b64_tr_b16 a[214:215], v10 offset:43008
    buffer_load_dwordx4 v17, s[12:15], s27 offen offset:0 nt lds
    v_exp_f32 v110, v62
    v_mfma_f32_32x32x16_bf16 v[128:143], a[240:243], a[40:43], v[128:143]
    ds_read_b64_tr_b16 a[240:241], v13 offset:16384
    ds_read_b64_tr_b16 a[242:243], v13 offset:17408
    v_add_f32 v30, v30, v108
    v_exp_f32 v111, v63
    v_mfma_f32_32x32x16_bf16 v[40:55], v[236:239], v[204:207], v[40:55]
    ds_read_b128 v[236:239], v4 offset:40960
    v_add_f32 v31, v31, v109
    v_mfma_f32_32x32x16_bf16 a[176:191], a[216:219], v[88:91], a[176:191]
    ds_read_b64_tr_b16 a[216:217], v11 offset:40960
    ds_read_b64_tr_b16 a[218:219], v11 offset:43008
    v_cvt_pk_bf16_f32 v98, v108, v109
    v_exp_f32 v104, v64
    s_waitcnt lgkmcnt(14)
    v_mfma_f32_32x32x16_bf16 v[144:159], a[244:247], a[40:43], v[144:159]
    ds_read_b64_tr_b16 a[244:245], v14 offset:16384
    ds_read_b64_tr_b16 a[246:247], v14 offset:17408
    v_add_f32 v30, v30, v110
    v_mfma_f32_32x32x16_bf16 v[40:55], v[240:243], v[208:211], v[40:55]
    ds_read_b128 v[240:243], v5 offset:40960
    buffer_load_dwordx4 v18, s[12:15], s27 offen offset:1024 nt lds
    v_exp_f32 v105, v65
    v_add_f32 v31, v31, v111
    v_mfma_f32_32x32x16_bf16 v[160:175], a[248:251], a[40:43], v[160:175]
    ds_read_b64_tr_b16 a[248:249], v15 offset:16384
    ds_read_b64_tr_b16 a[250:251], v15 offset:17408
    v_cvt_pk_bf16_f32 v99, v110, v111
    v_exp_f32 v106, v66
    v_mfma_f32_32x32x16_bf16 a[192:207], a[220:223], v[88:91], a[192:207]
    ds_read_b64_tr_b16 a[220:221], v12 offset:40960
    ds_read_b64_tr_b16 a[222:223], v12 offset:43008
    v_add_f32 v30, v30, v104
    v_mfma_f32_32x32x16_bf16 v[40:55], v[244:247], v[212:215], v[40:55]
    ds_read_b128 v[244:247], v6 offset:40960
    v_exp_f32 v107, v67
    v_add_f32 v31, v31, v105
    v_mfma_f32_32x32x16_bf16 v[176:191], a[252:255], a[40:43], v[176:191]
    ds_read_b64_tr_b16 a[252:253], v16 offset:16384
    ds_read_b64_tr_b16 a[254:255], v16 offset:17408
    v_cvt_pk_bf16_f32 v100, v104, v105
    v_mfma_f32_32x32x16_bf16 a[144:159], a[224:227], v[92:95], a[144:159]
    ds_read_b64_tr_b16 a[224:225], v9 offset:45056
    ds_read_b64_tr_b16 a[226:227], v9 offset:47104
    v_exp_f32 v108, v68
    v_add_f32 v30, v30, v106
    v_mfma_f32_32x32x16_bf16 v[40:55], v[248:251], v[216:219], v[40:55]
    ds_read_b128 v[248:251], v7 offset:40960
    buffer_load_dwordx4 v19, s[12:15], s27 offen offset:2048 nt lds
    v_exp_f32 v109, v69
    v_mfma_f32_32x32x16_bf16 v[128:143], v[112:115], a[44:47], v[128:143]
    ds_read_b64_tr_b16 v[112:113], v13 offset:20480
    ds_read_b64_tr_b16 v[114:115], v13 offset:21504
    v_add_f32 v31, v31, v107
    v_cvt_pk_bf16_f32 v101, v106, v107
    v_mfma_f32_32x32x16_bf16 a[160:175], a[228:231], v[92:95], a[160:175]
    ds_read_b64_tr_b16 a[228:229], v10 offset:45056
    ds_read_b64_tr_b16 a[230:231], v10 offset:47104
    v_exp_f32 v110, v70
    v_add_f32 v30, v30, v108
    v_mfma_f32_32x32x16_bf16 v[144:159], v[116:119], a[44:47], v[144:159]
    ds_read_b64_tr_b16 v[116:117], v14 offset:20480
    ds_read_b64_tr_b16 v[118:119], v14 offset:21504
    v_exp_f32 v111, v71
    v_mfma_f32_32x32x16_bf16 v[40:55], v[252:255], v[220:223], v[40:55]
    ds_read_b128 v[252:255], v8 offset:40960
    v_add_f32 v31, v31, v109
    v_cvt_pk_bf16_f32 v102, v108, v109
    v_mfma_f32_32x32x16_bf16 a[176:191], a[232:235], v[92:95], a[176:191]
    ds_read_b64_tr_b16 a[232:233], v11 offset:45056
    ds_read_b64_tr_b16 a[234:235], v11 offset:47104
    buffer_load_dwordx4 v20, s[12:15], s27 offen offset:3072 nt lds
    v_add_f32 v30, v30, v110
    v_add_f32 v31, v31, v111
    s_waitcnt lgkmcnt(14)
    v_mfma_f32_32x32x16_bf16 v[160:175], v[120:123], a[44:47], v[160:175]
    ds_read_b64_tr_b16 v[120:121], v15 offset:20480
    ds_read_b64_tr_b16 v[122:123], v15 offset:21504
    v_cvt_pk_bf16_f32 v103, v110, v111
    v_add_f32 v30, v30, v31
    v_cmp_nge_f32 vcc, s28, v30
    v_mfma_f32_32x32x16_bf16 a[192:207], a[236:239], v[92:95], a[192:207]
    ds_read_b64_tr_b16 a[236:237], v12 offset:45056
    ds_read_b64_tr_b16 a[238:239], v12 offset:47104
    s_cbranch_vccnz K1_STUB_3
K1_BACK_3:
    v_add_f32 v28, v28, v30
    v_mfma_f32_32x32x16_bf16 v[176:191], v[124:127], a[44:47], v[176:191]
    ds_read_b64_tr_b16 v[124:125], v16 offset:20480
    ds_read_b64_tr_b16 v[126:127], v16 offset:21504
    v_mfma_f32_32x32x16_bf16 v[56:71], v[224:227], v[192:195], v[72:87]
    v_exp_f32 v104, v40
    v_exp_f32 v105, v41
    v_mfma_f32_32x32x16_bf16 v[56:71], v[228:231], v[196:199], v[56:71]
    v_exp_f32 v106, v42
    v_mfma_f32_32x32x16_bf16 v[128:143], a[240:243], a[48:51], v[128:143]
    s_waitcnt lgkmcnt(0)
    s_waitcnt vmcnt(8)
    s_barrier
    ds_read_b128 v[224:227], v1 offset:49152
    ds_read_b128 v[228:231], v2 offset:49152
    ds_read_b64_tr_b16 a[240:241], v13 offset:24576
    ds_read_b64_tr_b16 a[242:243], v13 offset:25600
    v_mfma_f32_32x32x16_bf16 a[144:159], a[208:211], v[96:99], a[144:159]
    ds_read_b64_tr_b16 a[208:209], v9 offset:49152
    ds_read_b64_tr_b16 a[210:211], v9 offset:51200
    s_add_u32 m0, s24, 147456
    v_exp_f32 v107, v43
    v_cvt_pk_bf16_f32 v88, v104, v105
    v_mfma_f32_32x32x16_bf16 v[56:71], v[232:235], v[200:203], v[56:71]
    ds_read_b128 v[232:235], v3 offset:49152
    s_add_u32 s27, s26, 256
    v_exp_f32 v108, v44
    v_add_f32 v30, v104, v106
    v_mfma_f32_32x32x16_bf16 v[144:159], a[244:247], a[48:51], v[144:159]
    ds_read_b64_tr_b16 a[244:245], v14 offset:24576
    ds_read_b64_tr_b16 a[246:247], v14 offset:25600
    buffer_load_dwordx4 v22, s[8:11], s27 offen offset:0  lds
    v_exp_f32 v109, v45
    v_mfma_f32_32x32x16_bf16 a[160:175], a[212:215], v[96:99], a[160:175]
    ds_read_b64_tr_b16 a[212:213], v10 offset:49152
    ds_read_b64_tr_b16 a[214:215], v10 offset:51200
    v_add_f32 v31, v105, v107
    v_cvt_pk_bf16_f32 v89, v106, v107
    v_exp_f32 v110, v46
    v_mfma_f32_32x32x16_bf16 v[160:175], a[248:251], a[48:51], v[160:175]
    ds_read_b64_tr_b16 a[248:249], v15 offset:24576
    ds_read_b64_tr_b16 a[250:251], v15 offset:25600
    buffer_load_dwordx4 v23, s[8:11], s27 offen offset:1024  lds
    v_add_f32 v30, v30, v108
    v_mfma_f32_32x32x16_bf16 v[56:71], v[236:239], v[204:207], v[56:71]
    ds_read_b128 v[236:239], v4 offset:49152
    buffer_load_dwordx4 v24, s[8:11], s27 offen offset:2048  lds
    v_exp_f32 v111, v47
    v_add_f32 v31, v31, v109
    v_mfma_f32_32x32x16_bf16 a[176:191], a[216:219], v[96:99], a[176:191]
    ds_read_b64_tr_b16 a[216:217], v11 offset:49152
    ds_read_b64_tr_b16 a[218:219], v11 offset:51200
    v_cvt_pk_bf16_f32 v90, v108, v109
    v_exp_f32 v104, v48
    v_mfma_f32_32x32x16_bf16 v[176:191], a[252:255], a[48:51], v[176:191]
    ds_read_b64_tr_b16 a[252:253], v16 offset:24576
    ds_read_b64_tr_b16 a[254:255], v16 offset:25600
    buffer_load_dwordx4 v25, s[8:11], s27 offen offset:3072  lds
    v_add_f32 v30, v30, v110
    v_mfma_f32_32x32x16_bf16 v[56:71], v[240:243], v[208:211], v[56:71]
    ds_read_b128 v[240:243], v5 offset:49152
    v_exp_f32 v105, v49
    v_add_f32 v31, v31, v111
    v_mfma_f32_32x32x16_bf16 v[128:143], v[112:115], a[52:55], v[128:143]
    ds_read_b64_tr_b16 v[112:113], v13 offset:28672
    ds_read_b64_tr_b16 v[114:115], v13 offset:29696
    v_cvt_pk_bf16_f32 v91, v110, v111
    v_exp_f32 v106, v50
    v_mfma_f32_32x32x16_bf16 a[192:207], a[220:223], v[96:99], a[192:207]
    ds_read_b64_tr_b16 a[220:221], v12 offset:49152
    ds_read_b64_tr_b16 a[222:223], v12 offset:51200
    s_add_u32 s26, s26, 524288
    s_cmp_eq_u32 s26, 4718592
    s_cselect_b32 s26, 0, s26
    v_add_f32 v30, v30, v104
    v_mfma_f32_32x32x16_bf16 v[56:71], v[244:247], v[212:215], v[56:71]
    ds_read_b128 v[244:247], v6 offset:49152
    v_exp_f32 v107, v51
    v_add_f32 v31, v31, v105
    v_mfma_f32_32x32x16_bf16 v[144:159], v[116:119], a[52:55], v[144:159]
    ds_read_b64_tr_b16 v[116:117], v14 offset:28672
    ds_read_b64_tr_b16 v[118:119], v14 offset:29696
    s_add_u32 m0, s24, 81920
    v_cvt_pk_bf16_f32 v92, v104, v105
    v_mfma_f32_32x32x16_bf16 a[144:159], a[224:227], v[100:103], a[144:159]
    ds_read_b64_tr_b16 a[224:225], v9 offset:53248
    ds_read_b64_tr_b16 a[226:227], v9 offset:55296
    s_mov_b32 s27, 65536
    v_exp_f32 v108, v52
    v_add_f32 v30, v30, v106
    v_mfma_f32_32x32x16_bf16 v[56:71], v[248:251], v[216:219], v[56:71]
    ds_read_b128 v[248:251], v7 offset:49152
    buffer_load_dwordx4 v21, s[16:19], s27 offen offset:0 nt lds
    v_exp_f32 v109, v53
    v_mfma_f32_32x32x16_bf16 v[160:175], v[120:123], a[52:55], v[160:175]
    ds_read_b64_tr_b16 v[120:121], v15 offset:28672
    ds_read_b64_tr_b16 v[122:123], v15 offset:29696
    v_add_f32 v31, v31, v107
    v_cvt_pk_bf16_f32 v93, v106, v107
    v_mfma_f32_32x32x16_bf16 a[160:175], a[228:231], v[100:103], a[160:175]
    s_branch K1_TJ3
K1_TP3:
    s_setpc_b64 s[30:31]
K1_TJ3:
    ds_read_b64_tr_b16 a[228:229], v10 offset:53248
    ds_read_b64_tr_b16 a[230:231], v10 offset:55296
    v_exp_f32 v110, v54
    v_add_f32 v30, v30, v108
    v_mfma_f32_32x32x16_bf16 v[176:191], v[124:127], a[52:55], v[176:191]
    ds_read_b64_tr_b16 v[124:125], v16 offset:28672
    ds_read_b64_tr_b16 v[126:127], v16 offset:29696
    buffer_load_dwordx4 v21, s[16:19], s27 offen offset:1024 nt lds
    v_exp_f32 v111, v55
    v_mfma_f32_32x32x16_bf16 v[56:71], v[252:255], v[220:223], v[56:71]
    ds_read_b128 v[252:255], v8 offset:49152
    buffer_load_dwordx4 v21, s[16:19], s27 offen offset:2048 nt lds
    v_add_f32 v31, v31, v109
    v_cvt_pk_bf16_f32 v94, v108, v109
    v_mfma_f32_32x32x16_bf16 a[176:191], a[232:235], v[100:103], a[176:191]
    ds_read_b64_tr_b16 a[232:233], v11 offset:53248
    ds_read_b64_tr_b16 a[234:235], v11 offset:55296
    v_add_f32 v30, v30, v110
    v_add_f32 v31, v31, v111
    v_cvt_pk_bf16_f32 v95, v110, v111
    s_waitcnt lgkmcnt(14)
    v_mfma_f32_32x32x16_bf16 v[128:143], a[240:243], a[56:59], v[128:143]
    ds_read_b64_tr_b16 a[240:241], v13 offset:32768
    ds_read_b64_tr_b16 a[242:243], v13 offset:33792
    buffer_load_dwordx4 v21, s[16:19], s27 offen offset:3072 nt lds
    v_add_f32 v30, v30, v31
    v_cmp_nge_f32 vcc, s28, v30
    v_mfma_f32_32x32x16_bf16 a[192:207], a[236:239], v[100:103], a[192:207]
    ds_read_b64_tr_b16 a[236:237], v12 offset:53248
    ds_read_b64_tr_b16 a[238:239], v12 offset:55296
    s_cbranch_vccnz K1_STUB_4
K1_BACK_4:
    v_add_f32 v28, v28, v30
    v_mfma_f32_32x32x16_bf16 v[144:159], a[244:247], a[56:59], v[144:159]
    ds_read_b64_tr_b16 a[244:245], v14 offset:32768
    ds_read_b64_tr_b16 a[246:247], v14 offset:33792
    v_mfma_f32_32x32x16_bf16 v[40:55], v[224:227], v[192:195], v[72:87]
    ds_read_b128 v[224:227], v1 offset:57344
    s_add_u32 m0, s24, 32768
    v_exp_f32 v104, v56
    v_exp_f32 v105, v57
    v_mfma_f32_32x32x16_bf16 v[40:55], v[228:231], v[196:199], v[40:55]
    ds_read_b128 v[228:231], v2 offset:57344
    v_exp_f32 v106, v58
    v_mfma_f32_32x32x16_bf16 v[160:175], a[248:251], a[56:59], v[160:175]
    ds_read_b64_tr_b16 a[248:249], v15 offset:32768
    ds_read_b64_tr_b16 a[250:251], v15 offset:33792
    s_mov_b32 s27, 98304
    v_exp_f32 v107, v59
    v_cvt_pk_bf16_f32 v96, v104, v105
    v_mfma_f32_32x32x16_bf16 a[144:159], a[208:211], v[88:91], a[144:159]
    ds_read_b64_tr_b16 a[208:209], v9 offset:57344
    ds_read_b64_tr_b16 a[210:211], v9 offset:59392
    v_exp_f32 v108, v60
    v_add_f32 v30, v104, v106
    v_mfma_f32_32x32x16_bf16 v[40:55], v[232:235], v[200:203], v[40:55]
    ds_read_b128 v[232:235], v3 offset:57344
    v_exp_f32 v109, v61
    v_mfma_f32_32x32x16_bf16 v[176:191], a[252:255], a[56:59], v[176:191]
    ds_read_b64_tr_b16 a[252:253], v16 offset:32768
    ds_read_b64_tr_b16 a[254:255], v16 offset:33792
    v_add_f32 v31, v105, v107
    v_cvt_pk_bf16_f32 v97, v106, v107
    v_mfma_f32_32x32x16_bf16 a[160:175], a[212:215], v[88:91], a[160:175]
    ds_read_b64_tr_b16 a[212:213], v10 offset:57344
    ds_read_b64_tr_b16 a[214:215], v10 offset:59392
    buffer_load_dwordx4 v17, s[12:15], s27 offen offset:0 nt lds
    v_exp_f32 v110, v62
    v_mfma_f32_32x32x16_bf16 v[40:55], v[236:239], v[204:207], v[40:55]
    ds_read_b128 v[236:239], v4 offset:57344
    v_add_f32 v30, v30, v108
    v_exp_f32 v111, v63
    v_mfma_f32_32x32x16_bf16 v[128:143], v[112:115], a[60:63], v[128:143]
    ds_read_b64_tr_b16 v[112:113], v13 offset:36864
    ds_read_b64_tr_b16 v[114:115], v13 offset:37888
    v_add_f32 v31, v31, v109
    v_cvt_pk_bf16_f32 v98, v108, v109
    v_mfma_f32_32x32x16_bf16 a[176:191], a[216:219], v[88:91], a[176:191]
    ds_read_b64_tr_b16 a[216:217], v11 offset:57344
    ds_read_b64_tr_b16 a[218:219], v11 offset:59392
    v_exp_f32 v104, v64
    v_add_f32 v30, v30, v110
    v_mfma_f32_32x32x16_bf16 v[40:55], v[240:243], v[208:211], v[40:55]
    ds_read_b128 v[240:243], v5 offset:57344
    v_exp_f32 v105, v65
    s_waitcnt lgkmcnt(14)
    v_mfma_f32_32x32x16_bf16 v[144:159], v[116:119], a[60:63], v[144:159]
    ds_read_b64_tr_b16 v[116:117], v14 offset:36864
    ds_read_b64_tr_b16 v[118:119], v14 offset:37888
    buffer_load_dwordx4 v18, s[12:15], s27 offen offset:1024 nt lds
    v_add_f32 v31, v31, v111
    v_cvt_pk_bf16_f32 v99, v110, v111
    v_mfma_f32_32x32x16_bf16 a[192:207], a[220:223], v[88:91], a[192:207]
    ds_read_b64_tr_b16 a[220:221], v12 offset:57344
    ds_read_b64_tr_b16 a[222:223], v12 offset:59392
    v_exp_f32 v106, v66
    v_mfma_f32_32x32x16_bf16 v[160:175], v[120:123], a[60:63], v[160:175]
    ds_read_b64_tr_b16 v[120:121], v15 offset:36864
    ds_read_b64_tr_b16 v[122:123], v15 offset:37888
    v_add_f32 v30, v30, v104
    v_exp_f32 v107, v67
    v_mfma_f32_32x32x16_bf16 v[40:55], v[244:247], v[212:215], v[40:55]
    ds_read_b128 v[244:247], v6 offset:57344
    v_add_f32 v31, v31, v105
    v_cvt_pk_bf16_f32 v100, v104, v105
    v_mfma_f32_32x32x16_bf16 a[144:159], a[224:227], v[92:95], a[144:159]
    ds_read_b64_tr_b16 a[224:225], v9 offset:61440
    ds_read_b64_tr_b16 a[226:227], v9 offset:63488
    v_exp_f32 v108, v68
    v_mfma_f32_32x32x16_bf16 v[176:191], v[124:127], a[60:63], v[176:191]
    ds_read_b64_tr_b16 v[124:125], v16 offset:36864
    ds_read_b64_tr_b16 v[126:127], v16 offset:37888
    buffer_load_dwordx4 v19, s[12:15], s27 offen offset:2048 nt lds
    v_add_f32 v30, v30, v106
    v_mfma_f32_32x32x16_bf16 v[40:55], v[248:251], v[216:219], v[40:55]
    ds_read_b128 v[248:251], v7 offset:57344
    v_exp_f32 v109, v69
    v_add_f32 v31, v31, v107
    v_cvt_pk_bf16_f32 v101, v106, v107
    v_mfma_f32_32x32x16_bf16 a[160:175], a[228:231], v[92:95], a[160:175]
    ds_read_b64_tr_b16 a[228:229], v10 offset:61440
    ds_read_b64_tr_b16 a[230:231], v10 offset:63488
    v_exp_f32 v110, v70
    v_mfma_f32_32x32x16_bf16 v[128:143], a[240:243], a[64:67], v[128:143]
    ds_read_b64_tr_b16 a[240:241], v13 offset:40960
    ds_read_b64_tr_b16 a[242:243], v13 offset:41984
    v_add_f32 v30, v30, v108
    v_exp_f32 v111, v71
    v_mfma_f32_32x32x16_bf16 v[40:55], v[252:255], v[220:223], v[40:55]
    ds_read_b128 v[252:255], v8 offset:57344
    v_add_f32 v31, v31, v109
    v_cvt_pk_bf16_f32 v102, v108, v109
    v_mfma_f32_32x32x16_bf16 a[176:191], a[232:235], v[92:95], a[176:191]
    ds_read_b64_tr_b16 a[232:233], v11 offset:61440
    ds_read_b64_tr_b16 a[234:235], v11 offset:63488
    buffer_load_dwordx4 v20, s[12:15], s27 offen offset:3072 nt lds
    v_add_f32 v30, v30, v110
    v_add_f32 v31, v31, v111
    v_mfma_f32_32x32x16_bf16 v[144:159], a[244:247], a[64:67], v[144:159]
    ds_read_b64_tr_b16 a[244:245], v14 offset:40960
    ds_read_b64_tr_b16 a[246:247], v14 offset:41984
    v_cvt_pk_bf16_f32 v103, v110, v111
    v_add_f32 v30, v30, v31
    v_cmp_nge_f32 vcc, s28, v30
    v_mfma_f32_32x32x16_bf16 a[192:207], a[236:239], v[92:95], a[192:207]
    ds_read_b64_tr_b16 a[236:237], v12 offset:61440
    ds_read_b64_tr_b16 a[238:239], v12 offset:63488
    s_cbranch_vccnz K1_STUB_5
K1_BACK_5:
    v_add_f32 v28, v28, v30
    s_waitcnt lgkmcnt(14)
    v_mfma_f32_32x32x16_bf16 v[160:175], a[248:251], a[64:67], v[160:175]
    ds_read_b64_tr_b16 a[248:249], v15 offset:40960
    ds_read_b64_tr_b16 a[250:251], v15 offset:41984
    v_mfma_f32_32x32x16_bf16 v[56:71], v[224:227], v[192:195], v[72:87]
    v_exp_f32 v104, v40
    v_exp_f32 v105, v41
    v_mfma_f32_32x32x16_bf16 v[56:71], v[228:231], v[196:199], v[56:71]
    v_exp_f32 v106, v42
    v_mfma_f32_32x32x16_bf16 v[176:191], a[252:255], a[64:67], v[176:191]
    s_waitcnt lgkmcnt(0)
    s_waitcnt vmcnt(8)
    s_barrier
    ds_read_b128 v[224:227], v1 offset:0
    ds_read_b128 v[228:231], v2 offset:0
    ds_read_b64_tr_b16 a[252:253], v16 offset:40960
    ds_read_b64_tr_b16 a[254:255], v16 offset:41984
    v_mfma_f32_32x32x16_bf16 a[144:159], a[208:211], v[96:99], a[144:159]
    ds_read_b64_tr_b16 a[208:209], v9 offset:16384
    ds_read_b64_tr_b16 a[210:211], v9 offset:18432
    s_add_u32 m0, s24, 114688
    v_exp_f32 v107, v43
    v_cvt_pk_bf16_f32 v88, v104, v105
    v_mfma_f32_32x32x16_bf16 v[56:71], v[232:235], v[200:203], v[56:71]
    ds_read_b128 v[232:235], v3 offset:0
    s_add_u32 s27, s26, 256
    v_exp_f32 v108, v44
    v_add_f32 v30, v104, v106
    v_mfma_f32_32x32x16_bf16 v[128:143], v[112:115], a[68:71], v[128:143]
    ds_read_b64_tr_b16 v[112:113], v13 offset:45056
    ds_read_b64_tr_b16 v[114:115], v13 offset:46080
    buffer_load_dwordx4 v22, s[8:11], s27 offen offset:0  lds
    v_exp_f32 v109, v45
    v_mfma_f32_32x32x16_bf16 a[160:175], a[212:215], v[96:99], a[160:175]
    ds_read_b64_tr_b16 a[212:213], v10 offset:16384
    ds_read_b64_tr_b16 a[214:215], v10 offset:18432
    v_add_f32 v31, v105, v107
    v_cvt_pk_bf16_f32 v89, v106, v107
    v_exp_f32 v110, v46
    v_mfma_f32_32x32x16_bf16 v[144:159], v[116:119], a[68:71], v[144:159]
    ds_read_b64_tr_b16 v[116:117], v14 offset:45056
    ds_read_b64_tr_b16 v[118:119], v14 offset:46080
    buffer_load_dwordx4 v23, s[8:11], s27 offen offset:1024  lds
    v_add_f32 v30, v30, v108
    v_mfma_f32_32x32x16_bf16 v[56:71], v[236:239], v[204:207], v[56:71]
    ds_read_b128 v[236:239], v4 offset:0
    buffer_load_dwordx4 v24, s[8:11], s27 offen offset:2048  lds
    v_exp_f32 v111, v47
    v_add_f32 v31, v31, v109
    v_mfma_f32_32x32x16_bf16 a[176:191], a[216:219], v[96:99], a[176:191]
    ds_read_b64_tr_b16 a[216:217], v11 offset:16384
    ds_read_b64_tr_b16 a[218:219], v11 offset:18432
    v_cvt_pk_bf16_f32 v90, v108, v109
    v_exp_f32 v104, v48
    v_mfma_f32_32x32x16_bf16 v[160:175], v[120:123], a[68:71], v[160:175]
    ds_read_b64_tr_b16 v[120:121], v15 offset:45056
    ds_read_b64_tr_b16 v[122:123], v15 offset:46080
    buffer_load_dwordx4 v25, s[8:11], s27 offen offset:3072  lds
    v_add_f32 v30, v30, v110
    v_mfma_f32_32x32x16_bf16 v[56:71], v[240:243], v[208:211], v[56:71]
    ds_read_b128 v[240:243], v5 offset:0
    v_exp_f32 v105, v49
    v_add_f32 v31, v31, v111
    v_mfma_f32_32x32x16_bf16 v[176:191], v[124:127], a[68:71], v[176:191]
    ds_read_b64_tr_b16 v[124:125], v16 offset:45056
    ds_read_b64_tr_b16 v[126:127], v16 offset:46080
    v_cvt_pk_bf16_f32 v91, v110, v111
    v_exp_f32 v106, v50
    v_mfma_f32_32x32x16_bf16 a[192:207], a[220:223], v[96:99], a[192:207]
    ds_read_b64_tr_b16 a[220:221], v12 offset:16384
    ds_read_b64_tr_b16 a[222:223], v12 offset:18432
    s_add_u32 s26, s26, 524288
    s_cmp_eq_u32 s26, 4718592
    s_cselect_b32 s26, 0, s26
    v_add_f32 v30, v30, v104
    v_mfma_f32_32x32x16_bf16 v[56:71], v[244:247], v[212:215], v[56:71]
    ds_read_b128 v[244:247], v6 offset:0
    v_exp_f32 v107, v51
    v_add_f32 v31, v31, v105
    v_mfma_f32_32x32x16_bf16 v[128:143], a[240:243], a[72:75], v[128:143]
    ds_read_b64_tr_b16 a[240:241], v13 offset:49152
    ds_read_b64_tr_b16 a[242:243], v13 offset:50176
    s_add_u32 m0, s24, 98304
    v_cvt_pk_bf16_f32 v92, v104, v105
    v_mfma_f32_32x32x16_bf16 a[144:159], a[224:227], v[100:103], a[144:159]
    ds_read_b64_tr_b16 a[224:225], v9 offset:20480
    ds_read_b64_tr_b16 a[226:227], v9 offset:22528
    s_mov_b32 s27, 81920
    v_exp_f32 v108, v52
    v_add_f32 v30, v30, v106
    v_mfma_f32_32x32x16_bf16 v[56:71], v[248:251], v[216:219], v[56:71]
    ds_read_b128 v[248:251], v7 offset:0
    buffer_load_dwordx4 v21, s[16:19], s27 offen offset:0 nt lds
    v_exp_f32 v109, v53
    v_mfma_f32_32x32x16_bf16 v[144:159], a[244:247], a[72:75], v[144:159]
    ds_read_b64_tr_b16 a[244:245], v14 offset:49152
    ds_read_b64_tr_b16 a[246:247], v14 offset:50176
    v_add_f32 v31, v31, v107
    v_cvt_pk_bf16_f32 v93, v106, v107
    v_mfma_f32_32x32x16_bf16 a[160:175], a[228:231], v[100:103], a[160:175]
    ds_read_b64_tr_b16 a[228:229], v10 offset:20480
    ds_read_b64_tr_b16 a[230:231], v10 offset:22528
    v_exp_f32 v110, v54
    v_add_f32 v30, v30, v108
    v_mfma_f32_32x32x16_bf16 v[160:175], a[248:251], a[72:75], v[160:175]
    ds_read_b64_tr_b16 a[248:249], v15 offset:49152
    ds_read_b64_tr_b16 a[250:251], v15 offset:50176
    buffer_load_dwordx4 v21, s[16:19], s27 offen offset:1024 nt lds
    v_exp_f32 v111, v55
    v_mfma_f32_32x32x16_bf16 v[56:71], v[252:255], v[220:223], v[56:71]
    ds_read_b128 v[252:255], v8 offset:0
    buffer_load_dwordx4 v21, s[16:19], s27 offen offset:2048 nt lds
    v_add_f32 v31, v31, v109
    v_cvt_pk_bf16_f32 v94, v108, v109
    v_mfma_f32_32x32x16_bf16 a[176:191], a[232:235], v[100:103], a[176:191]
    ds_read_b64_tr_b16 a[232:233], v11 offset:20480
    ds_read_b64_tr_b16 a[234:235], v11 offset:22528
    v_add_f32 v30, v30, v110
    v_add_f32 v31, v31, v111
    v_cvt_pk_bf16_f32 v95, v110, v111
    s_waitcnt lgkmcnt(14)
    v_mfma_f32_32x32x16_bf16 v[176:191], a[252:255], a[72:75], v[176:191]
    ds_read_b64_tr_b16 a[252:253], v16 offset:49152
    ds_read_b64_tr_b16 a[254:255], v16 offset:50176
    buffer_load_dwordx4 v21, s[16:19], s27 offen offset:3072 nt lds
    v_add_f32 v30, v30, v31
    v_cmp_nge_f32 vcc, s28, v30
    v_mfma_f32_32x32x16_bf16 a[192:207], a[236:239], v[100:103], a[192:207]
    ds_read_b64_tr_b16 a[236:237], v12 offset:20480
    ds_read_b64_tr_b16 a[238:239], v12 offset:22528
    s_cbranch_vccnz K1_STUB_6
K1_BACK_6:
    v_add_f32 v28, v28, v30
    v_mfma_f32_32x32x16_bf16 v[128:143], v[112:115], a[76:79], v[128:143]
    ds_read_b64_tr_b16 v[112:113], v13 offset:53248
    ds_read_b64_tr_b16 v[114:115], v13 offset:54272
    v_mfma_f32_32x32x16_bf16 v[40:55], v[224:227], v[192:195], v[72:87]
    ds_read_b128 v[224:227], v1 offset:8192
    s_add_u32 m0, s24, 49152
    v_exp_f32 v104, v56
    v_exp_f32 v105, v57
    v_mfma_f32_32x32x16_bf16 v[40:55], v[228:231], v[196:199], v[40:55]
    ds_read_b128 v[228:231], v2 offset:8192
    s_mov_b32 s27, 114688
    v_exp_f32 v106, v58
    v_mfma_f32_32x32x16_bf16 v[144:159], v[116:119], a[76:79], v[144:159]
    ds_read_b64_tr_b16 v[116:117], v14 offset:53248
    ds_read_b64_tr_b16 v[118:119], v14 offset:54272
    v_exp_f32 v107, v59
    v_cvt_pk_bf16_f32 v96, v104, v105
    v_mfma_f32_32x32x16_bf16 a[144:159], a[208:211], v[88:91], a[144:159]
    ds_read_b64_tr_b16 a[208:209], v9 offset:24576
    ds_read_b64_tr_b16 a[210:211], v9 offset:26624
    buffer_load_dwordx4 v17, s[12:15], s27 offen offset:0 nt lds
    v_exp_f32 v108, v60
    v_mfma_f32_32x32x16_bf16 v[40:55], v[232:235], v[200:203], v[40:55]
    ds_read_b128 v[232:235], v3 offset:8192
    v_add_f32 v30, v104, v106
    v_exp_f32 v109, v61
    v_mfma_f32_32x32x16_bf16 v[160:175], v[120:123], a[76:79], v[160:175]
    ds_read_b64_tr_b16 v[120:121], v15 offset:53248
    ds_read_b64_tr_b16 v[122:123], v15 offset:54272
    v_add_f32 v31, v105, v107
    v_cvt_pk_bf16_f32 v97, v106, v107
    v_mfma_f32_32x32x16_bf16 a[160:175], a[212:215], v[88:91], a[160:175]
    ds_read_b64_tr_b16 a[212:213], v10 offset:24576
    ds_read_b64_tr_b16 a[214:215], v10 offset:26624
    buffer_load_dwordx4 v18, s[12:15], s27 offen offset:1024 nt lds
    v_exp_f32 v110, v62
    v_mfma_f32_32x32x16_bf16 v[40:55], v[236:239], v[204:207], v[40:55]
    ds_read_b128 v[236:239], v4 offset:8192
    v_add_f32 v30, v30, v108
    v_exp_f32 v111, v63
    v_mfma_f32_32x32x16_bf16 v[176:191], v[124:127], a[76:79], v[176:191]
    ds_read_b64_tr_b16 v[124:125], v16 offset:53248
    ds_read_b64_tr_b16 v[126:127], v16 offset:54272
    v_add_f32 v31, v31, v109
    v_cvt_pk_bf16_f32 v98, v108, v109
    v_mfma_f32_32x32x16_bf16 a[176:191], a[216:219], v[88:91], a[176:191]
    ds_read_b64_tr_b16 a[216:217], v11 offset:24576
    ds_read_b64_tr_b16 a[218:219], v11 offset:26624
    buffer_load_dwordx4 v19, s[12:15], s27 offen offset:2048 nt lds
    v_exp_f32 v104, v64
    v_mfma_f32_32x32x16_bf16 v[40:55], v[240:243], v[208:211], v[40:55]
    ds_read_b128 v[240:243], v5 offset:8192
    v_add_f32 v30, v30, v110
    v_exp_f32 v105, v65
    s_waitcnt lgkmcnt(14)
    v_mfma_f32_32x32x16_bf16 v[128:143], a[240:243], a[80:83], v[128:143]
    ds_read_b64_tr_b16 a[240:241], v13 offset:57344
    ds_read_b64_tr_b16 a[242:243], v13 offset:58368
    v_add_f32 v31, v31, v111
    v_cvt_pk_bf16_f32 v99, v110, v111
    v_mfma_f32_32x32x16_bf16 a[192:207], a[220:223], v[88:91], a[192:207]
    ds_read_b64_tr_b16 a[220:221], v12 offset:24576
    ds_read_b64_tr_b16 a[222:223], v12 offset:26624
    buffer_load_dwordx4 v20, s[12:15], s27 offen offset:3072 nt lds
    v_exp_f32 v106, v66
    v_mfma_f32_32x32x16_bf16 v[144:159], a[244:247], a[80:83], v[144:159]
    ds_read_b64_tr_b16 a[244:245], v14 offset:57344
    ds_read_b64_tr_b16 a[246:247], v14 offset:58368
    v_add_f32 v30, v30, v104
    v_exp_f32 v107, v67
    v_mfma_f32_32x32x16_bf16 v[40:55], v[244:247], v[212:215], v[40:55]
    ds_read_b128 v[244:247], v6 offset:8192
    v_add_f32 v31, v31, v105
    v_cvt_pk_bf16_f32 v100, v104, v105
    v_mfma_f32_32x32x16_bf16 a[144:159], a[224:227], v[92:95], a[144:159]
    ds_read_b64_tr_b16 a[224:225], v9 offset:28672
    ds_read_b64_tr_b16 a[226:227], v9 offset:30720
    v_exp_f32 v108, v68
    v_mfma_f32_32x32x16_bf16 v[160:175], a[248:251], a[80:83], v[160:175]
    ds_read_b64_tr_b16 a[248:249], v15 offset:57344
    ds_read_b64_tr_b16 a[250:251], v15 offset:58368
    v_add_f32 v30, v30, v106
    v_exp_f32 v109, v69
    v_mfma_f32_32x32x16_bf16 v[40:55], v[248:251], v[216:219], v[40:55]
    ds_read_b128 v[248:251], v7 offset:8192
    v_add_f32 v31, v31, v107
    v_cvt_pk_bf16_f32 v101, v106, v107
    v_mfma_f32_32x32x16_bf16 a[160:175], a[228:231], v[92:95], a[160:175]
    ds_read_b64_tr_b16 a[228:229], v10 offset:28672
    ds_read_b64_tr_b16 a[230:231], v10 offset:30720
    v_exp_f32 v110, v70
    v_mfma_f32_32x32x16_bf16 v[176:191], a[252:255], a[80:83], v[176:191]
    ds_read_b64_tr_b16 a[252:253], v16 offset:57344
    ds_read_b64_tr_b16 a[254:255], v16 offset:58368
    v_add_f32 v30, v30, v108
    v_exp_f32 v111, v71
    v_mfma_f32_32x32x16_bf16 v[40:55], v[252:255], v[220:223], v[40:55]
    v_and_b32 v26, 1, v26
    v_cmp_eq_u32_e64 s[100:101], 0, v26
    s_nop 0
    s_mov_b32 s64, s100
    v_and_b32 v27, 1, v27
    v_cmp_eq_u32_e64 s[100:101], 0, v27
    s_nop 0
    s_mov_b32 s65, s100
    v_mfma_f32_32x32x16_bf16 a[176:191], a[232:235], v[92:95], a[176:191]
    ds_read_b128 v[252:255], v8 offset:8192
    ds_read_b64_tr_b16 a[232:233], v11 offset:28672
    ds_read_b64_tr_b16 a[234:235], v11 offset:30720
    v_add_f32 v31, v31, v109
    v_cvt_pk_bf16_f32 v102, v108, v109
    v_add_f32 v30, v30, v110
    v_mfma_f32_32x32x16_bf16 v[128:143], v[112:115], a[84:87], v[128:143]
    ds_read_b64_tr_b16 v[112:113], v13 offset:61440
    ds_read_b64_tr_b16 v[114:115], v13 offset:62464
    v_add_f32 v31, v31, v111
    v_cvt_pk_bf16_f32 v103, v110, v111
    v_add_f32 v30, v30, v31
    v_cmp_nge_f32 vcc, s28, v30
    v_mfma_f32_32x32x16_bf16 a[192:207], a[236:239], v[92:95], a[192:207]
    ds_read_b64_tr_b16 a[236:237], v12 offset:28672
    ds_read_b64_tr_b16 a[238:239], v12 offset:30720
    s_cbranch_vccnz K1_STUB_7
K1_BACK_7:
    v_add_f32 v28, v28, v30
    s_waitcnt lgkmcnt(14)
    v_mfma_f32_32x32x16_bf16 v[144:159], v[116:119], a[84:87], v[144:159]
    ds_read_b64_tr_b16 v[116:117], v14 offset:61440
    ds_read_b64_tr_b16 v[118:119], v14 offset:62464
    v_mfma_f32_32x32x16_bf16 v[56:71], v[224:227], v[192:195], v[72:87]
    v_exp_f32 v104, v40
    v_exp_f32 v105, v41
    v_mfma_f32_32x32x16_bf16 v[56:71], v[228:231], v[196:199], v[56:71]
    v_exp_f32 v106, v42
    v_mfma_f32_32x32x16_bf16 v[160:175], v[120:123], a[84:87], v[160:175]
    s_waitcnt lgkmcnt(0)
    s_waitcnt vmcnt(8)
    s_barrier
    ds_read_b128 v[224:227], v1 offset:16384
    ds_read_b128 v[228:231], v2 offset:16384
    ds_read_b64_tr_b16 v[120:121], v15 offset:61440
    ds_read_b64_tr_b16 v[122:123], v15 offset:62464
    v_mfma_f32_32x32x16_bf16 a[144:159], a[208:211], v[96:99], a[144:159]
    ds_read_b64_tr_b16 a[208:209], v9 offset:32768
    ds_read_b64_tr_b16 a[210:211], v9 offset:34816
    s_add_u32 m0, s24, 131072
    v_exp_f32 v107, v43
    v_cvt_pk_bf16_f32 v88, v104, v105
    v_mfma_f32_32x32x16_bf16 v[56:71], v[232:235], v[200:203], v[56:71]
    ds_read_b128 v[232:235], v3 offset:16384
    s_add_u32 s27, s26, 256
    v_exp_f32 v108, v44
    v_add_f32 v30, v104, v106
    v_mfma_f32_32x32x16_bf16 v[176:191], v[124:127], a[84:87], v[176:191]
    ds_read_b64_tr_b16 v[124:125], v16 offset:61440
    ds_read_b64_tr_b16 v[126:127], v16 offset:62464
    buffer_load_dwordx4 v22, s[8:11], s27 offen offset:0  lds
    v_exp_f32 v109, v45
    v_mfma_f32_32x32x16_bf16 a[160:175], a[212:215], v[96:99], a[160:175]
    ds_read_b64_tr_b16 a[212:213], v10 offset:32768
    ds_read_b64_tr_b16 a[214:215], v10 offset:34816
    v_add_f32 v31, v105, v107
    v_cvt_pk_bf16_f32 v89, v106, v107
    v_exp_f32 v110, v46
    v_mfma_f32_32x32x16_bf16 v[128:143], a[240:243], a[88:91], v[128:143]
    ds_read_b64_tr_b16 a[240:241], v13 offset:16384
    ds_read_b64_tr_b16 a[242:243], v13 offset:17408
    buffer_load_dwordx4 v23, s[8:11], s27 offen offset:1024  lds
    v_add_f32 v30, v30, v108
    v_mfma_f32_32x32x16_bf16 v[56:71], v[236:239], v[204:207], v[56:71]
    ds_read_b128 v[236:239], v4 offset:16384
    buffer_load_dwordx4 v24, s[8:11], s27 offen offset:2048  lds
    v_exp_f32 v111, v47
    v_add_f32 v31, v31, v109
    v_mfma_f32_32x32x16_bf16 a[176:191], a[216:219], v[96:99], a[176:191]
    ds_read_b64_tr_b16 a[216:217], v11 offset:32768
    ds_read_b64_tr_b16 a[218:219], v11 offset:34816
    v_cvt_pk_bf16_f32 v90, v108, v109
    v_exp_f32 v104, v48
    v_mfma_f32_32x32x16_bf16 v[144:159], a[244:247], a[88:91], v[144:159]
    ds_read_b64_tr_b16 a[244:245], v14 offset:16384
    ds_read_b64_tr_b16 a[246:247], v14 offset:17408
    buffer_load_dwordx4 v25, s[8:11], s27 offen offset:3072  lds
    v_add_f32 v30, v30, v110
    v_mfma_f32_32x32x16_bf16 v[56:71], v[240:243], v[208:211], v[56:71]
    ds_read_b128 v[240:243], v5 offset:16384
    v_exp_f32 v105, v49
    v_add_f32 v31, v31, v111
    v_mfma_f32_32x32x16_bf16 v[160:175], a[248:251], a[88:91], v[160:175]
    ds_read_b64_tr_b16 a[248:249], v15 offset:16384
    ds_read_b64_tr_b16 a[250:251], v15 offset:17408
    v_cvt_pk_bf16_f32 v91, v110, v111
    v_exp_f32 v106, v50
    v_mfma_f32_32x32x16_bf16 a[192:207], a[220:223], v[96:99], a[192:207]
    ds_read_b64_tr_b16 a[220:221], v12 offset:32768
    ds_read_b64_tr_b16 a[222:223], v12 offset:34816
    s_add_u32 s26, s26, 524288
    s_cmp_eq_u32 s26, 4718592
    s_cselect_b32 s26, 0, s26
    v_add_f32 v30, v30, v104
    v_mfma_f32_32x32x16_bf16 v[56:71], v[244:247], v[212:215], v[56:71]
    ds_read_b128 v[244:247], v6 offset:16384
    v_exp_f32 v107, v51
    v_add_f32 v31, v31, v105
    v_mfma_f32_32x32x16_bf16 v[176:191], a[252:255], a[88:91], v[176:191]
    ds_read_b64_tr_b16 a[252:253], v16 offset:16384
    ds_read_b64_tr_b16 a[254:255], v16 offset:17408
    s_add_u32 m0, s24, 65536
    v_cvt_pk_bf16_f32 v92, v104, v105
    v_mfma_f32_32x32x16_bf16 a[144:159], a[224:227], v[100:103], a[144:159]
    ds_read_b64_tr_b16 a[224:225], v9 offset:36864
    ds_read_b64_tr_b16 a[226:227], v9 offset:38912
    s_mov_b32 s27, 98304
    v_exp_f32 v108, v52
    v_add_f32 v30, v30, v106
    v_mfma_f32_32x32x16_bf16 v[56:71], v[248:251], v[216:219], v[56:71]
    ds_read_b128 v[248:251], v7 offset:16384
    buffer_load_dwordx4 v21, s[16:19], s27 offen offset:0 nt lds
    v_exp_f32 v109, v53
    v_mfma_f32_32x32x16_bf16 v[128:143], v[112:115], a[92:95], v[128:143]
    ds_read_b64_tr_b16 v[112:113], v13 offset:20480
    ds_read_b64_tr_b16 v[114:115], v13 offset:21504
    v_add_f32 v31, v31, v107
    v_cvt_pk_bf16_f32 v93, v106, v107
    v_mfma_f32_32x32x16_bf16 a[160:175], a[228:231], v[100:103], a[160:175]
    ds_read_b64_tr_b16 a[228:229], v10 offset:36864
    ds_read_b64_tr_b16 a[230:231], v10 offset:38912
    v_exp_f32 v110, v54
    v_add_f32 v30, v30, v108
    v_mfma_f32_32x32x16_bf16 v[144:159], v[116:119], a[92:95], v[144:159]
    ds_read_b64_tr_b16 v[116:117], v14 offset:20480
    ds_read_b64_tr_b16 v[118:119], v14 offset:21504
    buffer_load_dwordx4 v21, s[16:19], s27 offen offset:1024 nt lds
    v_exp_f32 v111, v55
    v_mfma_f32_32x32x16_bf16 v[56:71], v[252:255], v[220:223], v[56:71]
    ds_read_b128 v[252:255], v8 offset:16384
    buffer_load_dwordx4 v21, s[16:19], s27 offen offset:2048 nt lds
    v_add_f32 v31, v31, v109
    v_cvt_pk_bf16_f32 v94, v108, v109
    v_mfma_f32_32x32x16_bf16 a[176:191], a[232:235], v[100:103], a[176:191]
    ds_read_b64_tr_b16 a[232:233], v11 offset:36864
    ds_read_b64_tr_b16 a[234:235], v11 offset:38912
    v_add_f32 v30, v30, v110
    v_add_f32 v31, v31, v111
    v_cvt_pk_bf16_f32 v95, v110, v111
    s_waitcnt lgkmcnt(14)
    v_mfma_f32_32x32x16_bf16 v[160:175], v[120:123], a[92:95], v[160:175]
    ds_read_b64_tr_b16 v[120:121], v15 offset:20480
    ds_read_b64_tr_b16 v[122:123], v15 offset:21504
    buffer_load_dwordx4 v21, s[16:19], s27 offen offset:3072 nt lds
    v_add_f32 v30, v30, v31
    v_cmp_nge_f32 vcc, s28, v30
    v_mfma_f32_32x32x16_bf16 a[192:207], a[236:239], v[100:103], a[192:207]
    ds_read_b64_tr_b16 a[236:237], v12 offset:36864
    ds_read_b64_tr_b16 a[238:239], v12 offset:38912
    s_cbranch_vccnz K1_STUB_8
K1_BACK_8:
    v_add_f32 v28, v28, v30
    v_mfma_f32_32x32x16_bf16 v[176:191], v[124:127], a[92:95], v[176:191]
    ds_read_b64_tr_b16 v[124:125], v16 offset:20480
    ds_read_b64_tr_b16 v[126:127], v16 offset:21504
    v_mfma_f32_32x32x16_bf16 v[40:55], v[224:227], v[192:195], v[72:87]
    ds_read_b128 v[224:227], v1 offset:24576
    s_add_u32 m0, s24, 0
    v_exp_f32 v104, v56
    v_exp_f32 v105, v57
    v_mfma_f32_32x32x16_bf16 v[40:55], v[228:231], v[196:199], v[40:55]
    ds_read_b128 v[228:231], v2 offset:24576
    v_exp_f32 v106, v58
    v_mfma_f32_32x32x16_bf16 v[128:143], a[240:243], a[96:99], v[128:143]
    ds_read_b64_tr_b16 a[240:241], v13 offset:24576
    ds_read_b64_tr_b16 a[242:243], v13 offset:25600
    s_mov_b32 s27, 131072
    v_exp_f32 v107, v59
    v_cvt_pk_bf16_f32 v96, v104, v105
    v_mfma_f32_32x32x16_bf16 a[144:159], a[208:211], v[88:91], a[144:159]
    ds_read_b64_tr_b16 a[208:209], v9 offset:40960
    ds_read_b64_tr_b16 a[210:211], v9 offset:43008
    v_exp_f32 v108, v60
    v_add_f32 v30, v104, v106
    v_mfma_f32_32x32x16_bf16 v[40:55], v[232:235], v[200:203], v[40:55]
    ds_read_b128 v[232:235], v3 offset:24576
    v_exp_f32 v109, v61
    v_mfma_f32_32x32x16_bf16 v[144:159], a[244:247], a[96:99], v[144:159]
    ds_read_b64_tr_b16 a[244:245], v14 offset:24576
    ds_read_b64_tr_b16 a[246:247], v14 offset:25600
    v_add_f32 v31, v105, v107
    v_cvt_pk_bf16_f32 v97, v106, v107
    v_mfma_f32_32x32x16_bf16 a[160:175], a[212:215], v[88:91], a[160:175]
    ds_read_b64_tr_b16 a[212:213], v10 offset:40960
    ds_read_b64_tr_b16 a[214:215], v10 offset:43008
    buffer_load_dwordx4 v17, s[12:15], s27 offen offset:0 nt lds
    v_exp_f32 v110, v62
    v_mfma_f32_32x32x16_bf16 v[40:55], v[236:239], v[204:207], v[40:55]
    ds_read_b128 v[236:239], v4 offset:24576
    v_add_f32 v30, v30, v108
    v_exp_f32 v111, v63
    v_mfma_f32_32x32x16_bf16 v[160:175], a[248:251], a[96:99], v[160:175]
    ds_read_b64_tr_b16 a[248:249], v15 offset:24576
    ds_read_b64_tr_b16 a[250:251], v15 offset:25600
    v_add_f32 v31, v31, v109
    v_cvt_pk_bf16_f32 v98, v108, v109
    v_mfma_f32_32x32x16_bf16 a[176:191], a[216:219], v[88:91], a[176:191]
    ds_read_b64_tr_b16 a[216:217], v11 offset:40960
    ds_read_b64_tr_b16 a[218:219], v11 offset:43008
    v_exp_f32 v104, v64
    v_add_f32 v30, v30, v110
    v_mfma_f32_32x32x16_bf16 v[40:55], v[240:243], v[208:211], v[40:55]
    ds_read_b128 v[240:243], v5 offset:24576
    v_exp_f32 v105, v65
    s_waitcnt lgkmcnt(14)
    v_mfma_f32_32x32x16_bf16 v[176:191], a[252:255], a[96:99], v[176:191]
    ds_read_b64_tr_b16 a[252:253], v16 offset:24576
    ds_read_b64_tr_b16 a[254:255], v16 offset:25600
    buffer_load_dwordx4 v18, s[12:15], s27 offen offset:1024 nt lds
    v_add_f32 v31, v31, v111
    v_cvt_pk_bf16_f32 v99, v110, v111
    v_mfma_f32_32x32x16_bf16 a[192:207], a[220:223], v[88:91], a[192:207]
    ds_read_b64_tr_b16 a[220:221], v12 offset:40960
    ds_read_b64_tr_b16 a[222:223], v12 offset:43008
    v_exp_f32 v106, v66
    v_mfma_f32_32x32x16_bf16 v[128:143], v[112:115], a[100:103], v[128:143]
    ds_read_b64_tr_b16 v[112:113], v13 offset:28672
    ds_read_b64_tr_b16 v[114:115], v13 offset:29696
    v_add_f32 v30, v30, v104
    v_exp_f32 v107, v67
    v_mfma_f32_32x32x16_bf16 v[40:55], v[244:247], v[212:215], v[40:55]
    s_branch K1_TJ4
K1_TP4:
    s_setpc_b64 s[30:31]
K1_TJ4:
    ds_read_b128 v[244:247], v6 offset:24576
    v_add_f32 v31, v31, v105
    v_cvt_pk_bf16_f32 v100, v104, v105
    v_mfma_f32_32x32x16_bf16 a[144:159], a[224:227], v[92:95], a[144:159]
    ds_read_b64_tr_b16 a[224:225], v9 offset:45056
    ds_read_b64_tr_b16 a[226:227], v9 offset:47104
    v_exp_f32 v108, v68
    v_mfma_f32_32x32x16_bf16 v[144:159], v[116:119], a[100:103], v[144:159]
    ds_read_b64_tr_b16 v[116:117], v14 offset:28672
    ds_read_b64_tr_b16 v[118:119], v14 offset:29696
    buffer_load_dwordx4 v19, s[12:15], s27 offen offset:2048 nt lds
    v_add_f32 v30, v30, v106
    v_mfma_f32_32x32x16_bf16 v[40:55], v[248:251], v[216:219], v[40:55]
    ds_read_b128 v[248:251], v7 offset:24576
    v_exp_f32 v109, v69
    v_add_f32 v31, v31, v107
    v_cvt_pk_bf16_f32 v101, v106, v107
    v_mfma_f32_32x32x16_bf16 a[160:175], a[228:231], v[92:95], a[160:175]
    ds_read_b64_tr_b16 a[228:229], v10 offset:45056
    ds_read_b64_tr_b16 a[230:231], v10 offset:47104
    v_exp_f32 v110, v70
    v_mfma_f32_32x32x16_bf16 v[160:175], v[120:123], a[100:103], v[160:175]
    ds_read_b64_tr_b16 v[120:121], v15 offset:28672
    ds_read_b64_tr_b16 v[122:123], v15 offset:29696
    v_add_f32 v30, v30, v108
    v_exp_f32 v111, v71
    v_mfma_f32_32x32x16_bf16 v[40:55], v[252:255], v[220:223], v[40:55]
    ds_read_b128 v[252:255], v8 offset:24576
    v_add_f32 v31, v31, v109
    v_cvt_pk_bf16_f32 v102, v108, v109
    v_mfma_f32_32x32x16_bf16 a[176:191], a[232:235], v[92:95], a[176:191]
    ds_read_b64_tr_b16 a[232:233], v11 offset:45056
    ds_read_b64_tr_b16 a[234:235], v11 offset:47104
    buffer_load_dwordx4 v20, s[12:15], s27 offen offset:3072 nt lds
    v_add_f32 v30, v30, v110
    v_add_f32 v31, v31, v111
    v_mfma_f32_32x32x16_bf16 v[176:191], v[124:127], a[100:103], v[176:191]
    ds_read_b64_tr_b16 v[124:125], v16 offset:28672
    ds_read_b64_tr_b16 v[126:127], v16 offset:29696
    v_cvt_pk_bf16_f32 v103, v110, v111
    v_add_f32 v30, v30, v31
    v_cmp_nge_f32 vcc, s28, v30
    v_mfma_f32_32x32x16_bf16 a[192:207], a[236:239], v[92:95], a[192:207]
    ds_read_b64_tr_b16 a[236:237], v12 offset:45056
    ds_read_b64_tr_b16 a[238:239], v12 offset:47104
    s_cbranch_vccnz K1_STUB_9
K1_BACK_9:
    v_add_f32 v28, v28, v30
    s_waitcnt lgkmcnt(14)
    v_mfma_f32_32x32x16_bf16 v[128:143], a[240:243], a[104:107], v[128:143]
    v_mfma_f32_32x32x16_bf16 v[56:71], v[224:227], v[192:195], v[72:87]
    v_exp_f32 v104, v40
    v_exp_f32 v105, v41
    v_mfma_f32_32x32x16_bf16 v[56:71], v[228:231], v[196:199], v[56:71]
    v_exp_f32 v106, v42
    v_mfma_f32_32x32x16_bf16 v[144:159], a[244:247], a[104:107], v[144:159]
    s_waitcnt lgkmcnt(0)
    s_waitcnt vmcnt(8)
    s_barrier
    ds_read_b128 v[224:227], v1 offset:32768
    ds_read_b128 v[228:231], v2 offset:32768
    ds_read_b64_tr_b16 a[240:241], v13 offset:32768
    ds_read_b64_tr_b16 a[242:243], v13 offset:33792
    v_mfma_f32_32x32x16_bf16 a[144:159], a[208:211], v[96:99], a[144:159]
    ds_read_b64_tr_b16 a[244:245], v14 offset:32768
    ds_read_b64_tr_b16 a[246:247], v14 offset:33792
    ds_read_b64_tr_b16 a[208:209], v9 offset:49152
    ds_read_b64_tr_b16 a[210:211], v9 offset:51200
    v_exp_f32 v107, v43
    v_mfma_f32_32x32x16_bf16 v[56:71], v[232:235], v[200:203], v[56:71]
    ds_read_b128 v[232:235], v3 offset:32768
    s_add_u32 m0, s24, 114688
    s_add_u32 s27, s26, 256
    v_cvt_pk_bf16_f32 v88, v104, v105
    v_exp_f32 v108, v44
    v_mfma_f32_32x32x16_bf16 v[160:175], a[248:251], a[104:107], v[160:175]
    ds_read_b64_tr_b16 a[248:249], v15 offset:32768
    ds_read_b64_tr_b16 a[250:251], v15 offset:33792
    v_add_f32 v30, v104, v106
    v_exp_f32 v109, v45
    v_add_f32 v31, v105, v107
    v_mfma_f32_32x32x16_bf16 a[160:175], a[212:215], v[96:99], a[160:175]
    ds_read_b64_tr_b16 a[212:213], v10 offset:49152
    ds_read_b64_tr_b16 a[214:215], v10 offset:51200
    buffer_load_dwordx4 v22, s[8:11], s27 offen offset:0  lds
    v_cvt_pk_bf16_f32 v89, v106, v107
    v_mfma_f32_32x32x16_bf16 v[176:191], a[252:255], a[104:107], v[176:191]
    ds_read_b64_tr_b16 a[252:253], v16 offset:32768
    ds_read_b64_tr_b16 a[254:255], v16 offset:33792
    buffer_load_dwordx4 v23, s[8:11], s27 offen offset:1024  lds
    v_exp_f32 v110, v46
    v_mfma_f32_32x32x16_bf16 v[56:71], v[236:239], v[204:207], v[56:71]
    ds_read_b128 v[236:239], v4 offset:32768
    v_add_f32 v30, v30, v108
    v_exp_f32 v111, v47
    v_add_f32 v31, v31, v109
    v_mfma_f32_32x32x16_bf16 a[176:191], a[216:219], v[96:99], a[176:191]
    ds_read_b64_tr_b16 a[216:217], v11 offset:49152
    ds_read_b64_tr_b16 a[218:219], v11 offset:51200
    buffer_load_dwordx4 v24, s[8:11], s27 offen offset:2048  lds
    v_cvt_pk_bf16_f32 v90, v108, v109
    v_mfma_f32_32x32x16_bf16 v[128:143], v[112:115], a[108:111], v[128:143]
    ds_read_b64_tr_b16 v[112:113], v13 offset:36864
    ds_read_b64_tr_b16 v[114:115], v13 offset:37888
    v_exp_f32 v104, v48
    v_add_f32 v30, v30, v110
    v_mfma_f32_32x32x16_bf16 v[56:71], v[240:243], v[208:211], v[56:71]
    ds_read_b128 v[240:243], v5 offset:32768
    buffer_load_dwordx4 v25, s[8:11], s27 offen offset:3072  lds
    v_exp_f32 v105, v49
    v_add_f32 v31, v31, v111
    v_mfma_f32_32x32x16_bf16 v[144:159], v[116:119], a[108:111], v[144:159]
    ds_read_b64_tr_b16 v[116:117], v14 offset:36864
    ds_read_b64_tr_b16 v[118:119], v14 offset:37888
    v_cvt_pk_bf16_f32 v91, v110, v111
    v_exp_f32 v106, v50
    v_mfma_f32_32x32x16_bf16 a[192:207], a[220:223], v[96:99], a[192:207]
    ds_read_b64_tr_b16 a[220:221], v12 offset:49152
    ds_read_b64_tr_b16 a[222:223], v12 offset:51200
    s_add_u32 s26, s26, 524288
    s_cmp_eq_u32 s26, 4718592
    s_cselect_b32 s26, 0, s26
    v_add_f32 v30, v30, v104
    v_mfma_f32_32x32x16_bf16 v[56:71], v[244:247], v[212:215], v[56:71]
    ds_read_b128 v[244:247], v6 offset:32768
    v_exp_f32 v107, v51
    v_add_f32 v31, v31, v105
    v_mfma_f32_32x32x16_bf16 v[160:175], v[120:123], a[108:111], v[160:175]
    ds_read_b64_tr_b16 v[120:121], v15 offset:36864
    ds_read_b64_tr_b16 v[122:123], v15 offset:37888
    s_add_u32 m0, s24, 81920
    v_cvt_pk_bf16_f32 v92, v104, v105
    v_mfma_f32_32x32x16_bf16 a[144:159], a[224:227], v[100:103], a[144:159]
    ds_read_b64_tr_b16 a[224:225], v9 offset:53248
    ds_read_b64_tr_b16 a[226:227], v9 offset:55296
    s_mov_b32 s27, 114688
    v_exp_f32 v108, v52
    v_add_f32 v30, v30, v106
    v_mfma_f32_32x32x16_bf16 v[56:71], v[248:251], v[216:219], v[56:71]
    ds_read_b128 v[248:251], v7 offset:32768
    buffer_load_dwordx4 v21, s[16:19], s27 offen offset:0 nt lds
    v_exp_f32 v109, v53
    v_mfma_f32_32x32x16_bf16 v[176:191], v[124:127], a[108:111], v[176:191]
    ds_read_b64_tr_b16 v[124:125], v16 offset:36864
    ds_read_b64_tr_b16 v[126:127], v16 offset:37888
    v_add_f32 v31, v31, v107
    v_cvt_pk_bf16_f32 v93, v106, v107
    v_mfma_f32_32x32x16_bf16 a[160:175], a[228:231], v[100:103], a[160:175]
    ds_read_b64_tr_b16 a[228:229], v10 offset:53248
    ds_read_b64_tr_b16 a[230:231], v10 offset:55296
    v_exp_f32 v110, v54
    v_add_f32 v30, v30, v108
    s_waitcnt lgkmcnt(14)
    v_mfma_f32_32x32x16_bf16 v[128:143], a[240:243], a[112:115], v[128:143]
    ds_read_b64_tr_b16 a[240:241], v13 offset:40960
    ds_read_b64_tr_b16 a[242:243], v13 offset:41984
    buffer_load_dwordx4 v21, s[16:19], s27 offen offset:1024 nt lds
    v_exp_f32 v111, v55
    v_mfma_f32_32x32x16_bf16 v[56:71], v[252:255], v[220:223], v[56:71]
    ds_read_b128 v[252:255], v8 offset:32768
    buffer_load_dwordx4 v21, s[16:19], s27 offen offset:2048 nt lds
    v_add_f32 v31, v31, v109
    v_cvt_pk_bf16_f32 v94, v108, v109
    v_mfma_f32_32x32x16_bf16 a[176:191], a[232:235], v[100:103], a[176:191]
    ds_read_b64_tr_b16 a[232:233], v11 offset:53248
    ds_read_b64_tr_b16 a[234:235], v11 offset:55296
    v_add_f32 v30, v30, v110
    v_add_f32 v31, v31, v111
    v_cvt_pk_bf16_f32 v95, v110, v111
    v_mfma_f32_32x32x16_bf16 v[144:159], a[244:247], a[112:115], v[144:159]
    ds_read_b64_tr_b16 a[244:245], v14 offset:40960
    ds_read_b64_tr_b16 a[246:247], v14 offset:41984
    buffer_load_dwordx4 v21, s[16:19], s27 offen offset:3072 nt lds
    v_add_f32 v30, v30, v31
    v_cmp_nge_f32 vcc, s28, v30
    v_mfma_f32_32x32x16_bf16 a[192:207], a[236:239], v[100:103], a[192:207]
    ds_read_b64_tr_b16 a[236:237], v12 offset:53248
    ds_read_b64_tr_b16 a[238:239], v12 offset:55296
    s_cbranch_vccnz K1_STUB_10
K1_BACK_10:
    v_add_f32 v28, v28, v30
    v_mfma_f32_32x32x16_bf16 v[160:175], a[248:251], a[112:115], v[160:175]
    ds_read_b64_tr_b16 a[248:249], v15 offset:40960
    ds_read_b64_tr_b16 a[250:251], v15 offset:41984
    v_mfma_f32_32x32x16_bf16 v[40:55], v[224:227], v[192:195], v[72:87]
    ds_read_b128 v[224:227], v1 offset:40960
    s_add_u32 m0, s24, 16384
    v_exp_f32 v104, v56
    v_exp_f32 v105, v57
    v_mfma_f32_32x32x16_bf16 v[40:55], v[228:231], v[196:199], v[40:55]
    ds_read_b128 v[228:231], v2 offset:40960
    v_exp_f32 v106, v58
    v_mfma_f32_32x32x16_bf16 v[176:191], a[252:255], a[112:115], v[176:191]
    ds_read_b64_tr_b16 a[252:253], v16 offset:40960
    ds_read_b64_tr_b16 a[254:255], v16 offset:41984
    s_mov_b32 s27, 147456
    v_exp_f32 v107, v59
    v_cvt_pk_bf16_f32 v96, v104, v105
    v_mfma_f32_32x32x16_bf16 a[144:159], a[208:211], v[88:91], a[144:159]
    ds_read_b64_tr_b16 a[208:209], v9 offset:57344
    ds_read_b64_tr_b16 a[210:211], v9 offset:59392
    v_exp_f32 v108, v60
    v_add_f32 v30, v104, v106
    v_mfma_f32_32x32x16_bf16 v[40:55], v[232:235], v[200:203], v[40:55]
    ds_read_b128 v[232:235], v3 offset:40960
    v_exp_f32 v109, v61
    v_mfma_f32_32x32x16_bf16 v[128:143], v[112:115], a[116:119], v[128:143]
    ds_read_b64_tr_b16 v[112:113], v13 offset:45056
    ds_read_b64_tr_b16 v[114:115], v13 offset:46080
    v_add_f32 v31, v105, v107
    v_cvt_pk_bf16_f32 v97, v106, v107
    v_mfma_f32_32x32x16_bf16 a[160:175], a[212:215], v[88:91], a[160:175]
    ds_read_b64_tr_b16 a[212:213], v10 offset:57344
    ds_read_b64_tr_b16 a[214:215], v10 offset:59392
    buffer_load_dwordx4 v17, s[12:15], s27 offen offset:0 nt lds
    v_exp_f32 v110, v62
    v_mfma_f32_32x32x16_bf16 v[40:55], v[236:239], v[204:207], v[40:55]
    ds_read_b128 v[236:239], v4 offset:40960
    v_add_f32 v30, v30, v108
    v_exp_f32 v111, v63
    s_waitcnt lgkmcnt(14)
    v_mfma_f32_32x32x16_bf16 v[144:159], v[116:119], a[116:119], v[144:159]
    ds_read_b64_tr_b16 v[116:117], v14 offset:45056
    ds_read_b64_tr_b16 v[118:119], v14 offset:46080
    v_add_f32 v31, v31, v109
    v_cvt_pk_bf16_f32 v98, v108, v109
    v_mfma_f32_32x32x16_bf16 a[176:191], a[216:219], v[88:91], a[176:191]
    ds_read_b64_tr_b16 a[216:217], v11 offset:57344
    ds_read_b64_tr_b16 a[218:219], v11 offset:59392
    v_exp_f32 v104, v64
    v_add_f32 v30, v30, v110
    v_mfma_f32_32x32x16_bf16 v[40:55], v[240:243], v[208:211], v[40:55]
    ds_read_b128 v[240:243], v5 offset:40960
    v_exp_f32 v105, v65
    v_mfma_f32_32x32x16_bf16 v[160:175], v[120:123], a[116:119], v[160:175]
    ds_read_b64_tr_b16 v[120:121], v15 offset:45056
    ds_read_b64_tr_b16 v[122:123], v15 offset:46080
    buffer_load_dwordx4 v18, s[12:15], s27 offen offset:1024 nt lds
    v_add_f32 v31, v31, v111
    v_cvt_pk_bf16_f32 v99, v110, v111
    v_mfma_f32_32x32x16_bf16 a[192:207], a[220:223], v[88:91], a[192:207]
    ds_read_b64_tr_b16 a[220:221], v12 offset:57344
    ds_read_b64_tr_b16 a[222:223], v12 offset:59392
    v_exp_f32 v106, v66
    v_mfma_f32_32x32x16_bf16 v[176:191], v[124:127], a[116:119], v[176:191]
    ds_read_b64_tr_b16 v[124:125], v16 offset:45056
    ds_read_b64_tr_b16 v[126:127], v16 offset:46080
    v_add_f32 v30, v30, v104
    v_exp_f32 v107, v67
    v_mfma_f32_32x32x16_bf16 v[40:55], v[244:247], v[212:215], v[40:55]
    ds_read_b128 v[244:247], v6 offset:40960
    v_add_f32 v31, v31, v105
    v_cvt_pk_bf16_f32 v100, v104, v105
    v_mfma_f32_32x32x16_bf16 a[144:159], a[224:227], v[92:95], a[144:159]
    ds_read_b64_tr_b16 a[224:225], v9 offset:61440
    ds_read_b64_tr_b16 a[226:227], v9 offset:63488
    v_exp_f32 v108, v68
    v_mfma_f32_32x32x16_bf16 v[128:143], a[240:243], a[120:123], v[128:143]
    buffer_load_dwordx4 v19, s[12:15], s27 offen offset:2048 nt lds
    v_add_f32 v30, v30, v106
    v_exp_f32 v109, v69
    v_mfma_f32_32x32x16_bf16 v[40:55], v[248:251], v[216:219], v[40:55]
    ds_read_b128 v[248:251], v7 offset:40960
    v_add_f32 v31, v31, v107
    v_cvt_pk_bf16_f32 v101, v106, v107
    v_mfma_f32_32x32x16_bf16 a[160:175], a[228:231], v[92:95], a[160:175]
    ds_read_b64_tr_b16 a[228:229], v10 offset:61440
    ds_read_b64_tr_b16 a[230:231], v10 offset:63488
    v_exp_f32 v110, v70
    v_mfma_f32_32x32x16_bf16 v[144:159], a[244:247], a[120:123], v[144:159]
    v_add_f32 v30, v30, v108
    v_exp_f32 v111, v71
    v_mfma_f32_32x32x16_bf16 v[40:55], v[252:255], v[220:223], v[40:55]
    ds_read_b128 v[252:255], v8 offset:40960
    v_add_f32 v31, v31, v109
    v_cvt_pk_bf16_f32 v102, v108, v109
    v_mfma_f32_32x32x16_bf16 a[176:191], a[232:235], v[92:95], a[176:191]
    ds_read_b64_tr_b16 a[232:233], v11 offset:61440
    ds_read_b64_tr_b16 a[234:235], v11 offset:63488
    buffer_load_dwordx4 v20, s[12:15], s27 offen offset:3072 nt lds
    v_add_f32 v30, v30, v110
    v_add_f32 v31, v31, v111
    s_waitcnt lgkmcnt(14)
    v_mfma_f32_32x32x16_bf16 v[160:175], a[248:251], a[120:123], v[160:175]
    v_cvt_pk_bf16_f32 v103, v110, v111
    v_add_f32 v30, v30, v31
    v_cmp_nge_f32 vcc, s28, v30
    v_mfma_f32_32x32x16_bf16 a[192:207], a[236:239], v[92:95], a[192:207]
    ds_read_b64_tr_b16 a[236:237], v12 offset:61440
    ds_read_b64_tr_b16 a[238:239], v12 offset:63488
    s_cbranch_vccnz K1_STUB_11
K1_BACK_11:
    v_add_f32 v28, v28, v30
    v_mfma_f32_32x32x16_bf16 v[176:191], a[252:255], a[120:123], v[176:191]
    v_mfma_f32_32x32x16_bf16 v[56:71], v[224:227], v[192:195], v[72:87]
    v_exp_f32 v104, v40
    v_exp_f32 v105, v41
    v_mfma_f32_32x32x16_bf16 v[56:71], v[228:231], v[196:199], v[56:71]
    v_exp_f32 v106, v42
    v_mfma_f32_32x32x16_bf16 v[128:143], v[112:115], a[124:127], v[128:143]
    s_waitcnt lgkmcnt(0)
    s_waitcnt vmcnt(8)
    s_barrier
    ds_read_b128 v[224:227], v1 offset:49152
    ds_read_b128 v[228:231], v2 offset:49152
    ds_read_b64_tr_b16 a[240:241], v13 offset:16384
    ds_read_b64_tr_b16 a[242:243], v13 offset:17408
    v_mfma_f32_32x32x16_bf16 a[144:159], a[208:211], v[96:99], a[144:159]
    ds_read_b64_tr_b16 a[244:245], v14 offset:16384
    ds_read_b64_tr_b16 a[246:247], v14 offset:17408
    ds_read_b64_tr_b16 a[248:249], v15 offset:16384
    ds_read_b64_tr_b16 a[250:251], v15 offset:17408
    ds_read_b64_tr_b16 a[252:253], v16 offset:16384
    ds_read_b64_tr_b16 a[254:255], v16 offset:17408
    v_mfma_f32_32x32x16_bf16 v[56:71], v[232:235], v[200:203], v[56:71]
    ds_read_b64_tr_b16 v[112:113], v13 offset:20480
    ds_read_b64_tr_b16 v[114:115], v13 offset:21504
    ds_read_b64_tr_b16 a[208:209], v9 offset:16384
    ds_read_b64_tr_b16 a[210:211], v9 offset:18432
    v_exp_f32 v107, v43
    v_mfma_f32_32x32x16_bf16 v[144:159], v[116:119], a[124:127], v[144:159]
    ds_read_b128 v[232:235], v3 offset:49152
    s_add_u32 m0, s24, 98304
    s_mov_b32 s27, 131072
    v_cvt_pk_bf16_f32 v88, v104, v105
    v_exp_f32 v108, v44
    v_mfma_f32_32x32x16_bf16 a[160:175], a[212:215], v[96:99], a[160:175]
    ds_read_b64_tr_b16 v[116:117], v14 offset:20480
    ds_read_b64_tr_b16 v[118:119], v14 offset:21504
    v_add_f32 v30, v104, v106
    v_exp_f32 v109, v45
    v_add_f32 v31, v105, v107
    v_mfma_f32_32x32x16_bf16 v[160:175], v[120:123], a[124:127], v[160:175]
    ds_read_b64_tr_b16 a[212:213], v10 offset:16384
    ds_read_b64_tr_b16 a[214:215], v10 offset:18432
    ds_read_b64_tr_b16 v[120:121], v15 offset:20480
    buffer_load_dwordx4 v21, s[16:19], s27 offen offset:0 nt lds
    v_cvt_pk_bf16_f32 v89, v106, v107
    v_mfma_f32_32x32x16_bf16 v[56:71], v[236:239], v[204:207], v[56:71]
    ds_read_b64_tr_b16 v[122:123], v15 offset:21504
    ds_read_b128 v[236:239], v4 offset:49152
    v_exp_f32 v110, v46
    v_add_f32 v30, v30, v108
    v_mfma_f32_32x32x16_bf16 a[176:191], a[216:219], v[96:99], a[176:191]
    ds_read_b64_tr_b16 a[216:217], v11 offset:16384
    ds_read_b64_tr_b16 a[218:219], v11 offset:18432
    buffer_load_dwordx4 v21, s[16:19], s27 offen offset:1024 nt lds
    v_exp_f32 v111, v47
    v_mfma_f32_32x32x16_bf16 v[176:191], v[124:127], a[124:127], v[176:191]
    ds_read_b64_tr_b16 v[124:125], v16 offset:20480
    ds_read_b64_tr_b16 v[126:127], v16 offset:21504
    v_add_f32 v31, v31, v109
    v_cvt_pk_bf16_f32 v90, v108, v109
    v_exp_f32 v104, v48
    v_mfma_f32_32x32x16_bf16 v[56:71], v[240:243], v[208:211], v[56:71]
    ds_read_b128 v[240:243], v5 offset:49152
    buffer_load_dwordx4 v21, s[16:19], s27 offen offset:2048 nt lds
    v_add_f32 v30, v30, v110
    v_exp_f32 v105, v49
    s_waitcnt lgkmcnt(14)
    v_mfma_f32_32x32x16_bf16 v[128:143], a[240:243], a[128:131], v[128:143]
    ds_read_b64_tr_b16 a[240:241], v13 offset:24576
    ds_read_b64_tr_b16 a[242:243], v13 offset:25600
    buffer_load_dwordx4 v21, s[16:19], s27 offen offset:3072 nt lds
    v_add_f32 v31, v31, v111
    v_cvt_pk_bf16_f32 v91, v110, v111
    v_mfma_f32_32x32x16_bf16 a[192:207], a[220:223], v[96:99], a[192:207]
    ds_read_b64_tr_b16 a[220:221], v12 offset:16384
    ds_read_b64_tr_b16 a[222:223], v12 offset:18432
    v_exp_f32 v106, v50
    v_add_f32 v30, v30, v104
    v_mfma_f32_32x32x16_bf16 v[56:71], v[244:247], v[212:215], v[56:71]
    ds_read_b128 v[244:247], v6 offset:49152
    s_add_u32 m0, s24, 32768
    v_exp_f32 v107, v51
    v_add_f32 v31, v31, v105
    v_mfma_f32_32x32x16_bf16 v[144:159], a[244:247], a[128:131], v[144:159]
    ds_read_b64_tr_b16 a[244:245], v14 offset:24576
    ds_read_b64_tr_b16 a[246:247], v14 offset:25600
    s_mov_b32 s27, 163840
    v_cvt_pk_bf16_f32 v92, v104, v105
    v_mfma_f32_32x32x16_bf16 a[144:159], a[224:227], v[100:103], a[144:159]
    ds_read_b64_tr_b16 a[224:225], v9 offset:20480
    ds_read_b64_tr_b16 a[226:227], v9 offset:22528
    v_exp_f32 v108, v52
    v_add_f32 v30, v30, v106
    v_mfma_f32_32x32x16_bf16 v[56:71], v[248:251], v[216:219], v[56:71]
    ds_read_b128 v[248:251], v7 offset:49152
    buffer_load_dwordx4 v17, s[12:15], s27 offen offset:0 nt lds
    v_exp_f32 v109, v53
    v_mfma_f32_32x32x16_bf16 v[160:175], a[248:251], a[128:131], v[160:175]
    ds_read_b64_tr_b16 a[248:249], v15 offset:24576
    ds_read_b64_tr_b16 a[250:251], v15 offset:25600
    v_add_f32 v31, v31, v107
    v_cvt_pk_bf16_f32 v93, v106, v107
    v_mfma_f32_32x32x16_bf16 a[160:175], a[228:231], v[100:103], a[160:175]
    ds_read_b64_tr_b16 a[228:229], v10 offset:20480
    ds_read_b64_tr_b16 a[230:231], v10 offset:22528
    buffer_load_dwordx4 v18, s[12:15], s27 offen offset:1024 nt lds
    v_exp_f32 v110, v54
    v_mfma_f32_32x32x16_bf16 v[176:191], a[252:255], a[128:131], v[176:191]
    ds_read_b64_tr_b16 a[252:253], v16 offset:24576
    ds_read_b64_tr_b16 a[254:255], v16 offset:25600
    v_add_f32 v30, v30, v108
    v_exp_f32 v111, v55
    v_mfma_f32_32x32x16_bf16 v[56:71], v[252:255], v[220:223], v[56:71]
    ds_read_b128 v[252:255], v8 offset:49152
    buffer_load_dwordx4 v19, s[12:15], s27 offen offset:2048 nt lds
    v_add_f32 v31, v31, v109
    v_cvt_pk_bf16_f32 v94, v108, v109
    v_mfma_f32_32x32x16_bf16 a[176:191], a[232:235], v[100:103], a[176:191]
    ds_read_b64_tr_b16 a[232:233], v11 offset:20480
    ds_read_b64_tr_b16 a[234:235], v11 offset:22528
    v_add_f32 v30, v30, v110
    v_add_f32 v31, v31, v111
    v_cvt_pk_bf16_f32 v95, v110, v111
    v_mfma_f32_32x32x16_bf16 v[128:143], v[112:115], a[132:135], v[128:143]
    ds_read_b64_tr_b16 v[112:113], v13 offset:28672
    ds_read_b64_tr_b16 v[114:115], v13 offset:29696
    buffer_load_dwordx4 v20, s[12:15], s27 offen offset:3072 nt lds
    v_add_f32 v30, v30, v31
    v_cmp_nge_f32 vcc, s28, v30
    v_mfma_f32_32x32x16_bf16 a[192:207], a[236:239], v[100:103], a[192:207]
    ds_read_b64_tr_b16 a[236:237], v12 offset:20480
    ds_read_b64_tr_b16 a[238:239], v12 offset:22528
    s_cbranch_vccnz K1_STUB_12
K1_BACK_12:
    v_add_f32 v28, v28, v30
    s_waitcnt lgkmcnt(14)
    v_mfma_f32_32x32x16_bf16 v[144:159], v[116:119], a[132:135], v[144:159]
    ds_read_b64_tr_b16 v[116:117], v14 offset:28672
    ds_read_b64_tr_b16 v[118:119], v14 offset:29696
    v_mfma_f32_32x32x16_bf16 v[40:55], v[224:227], v[192:195], v[72:87]
    ds_read_b128 v[224:227], v1 offset:57344
    v_exp_f32 v104, v56
    v_exp_f32 v105, v57
    v_mfma_f32_32x32x16_bf16 v[40:55], v[228:231], v[196:199], v[40:55]
    ds_read_b128 v[228:231], v2 offset:57344
    v_exp_f32 v106, v58
    v_mfma_f32_32x32x16_bf16 v[160:175], v[120:123], a[132:135], v[160:175]
    s_cmp_eq_u32 s38, 0
    s_cselect_b32 s4, s84, s86
    s_cselect_b32 s5, s85, s87
    s_mul_i32 s95, s97, 1179648
    s_add_u32 s4, s4, s95
    s_addc_u32 s5, s5, 0
    s_sub_u32 s6, 4718592, s95
    v_mfma_f32_32x32x16_bf16 a[144:159], a[208:211], v[88:91], a[144:159]
    ds_read_b64_tr_b16 v[120:121], v15 offset:28672
    ds_read_b64_tr_b16 v[122:123], v15 offset:29696
    ds_read_b64_tr_b16 a[208:209], v9 offset:24576
    ds_read_b64_tr_b16 a[210:211], v9 offset:26624
    v_exp_f32 v107, v59
    v_mfma_f32_32x32x16_bf16 v[40:55], v[232:235], v[200:203], v[40:55]
    ds_read_b128 v[232:235], v3 offset:57344
    v_cvt_pk_bf16_f32 v96, v104, v105
    v_exp_f32 v108, v60
    v_add_f32 v30, v104, v106
    v_mfma_f32_32x32x16_bf16 v[176:191], v[124:127], a[132:135], v[176:191]
    ds_read_b64_tr_b16 v[124:125], v16 offset:28672
    ds_read_b64_tr_b16 v[126:127], v16 offset:29696
    s_lshl_b32 s95, s96, 15
    s_sub_u32 s8, s20, s95
    s_subb_u32 s9, s21, 0
    s_mov_b32 s10, 655360
    v_mfma_f32_32x32x16_bf16 a[160:175], a[212:215], v[88:91], a[160:175]
    ds_read_b64_tr_b16 a[212:213], v10 offset:24576
    ds_read_b64_tr_b16 a[214:215], v10 offset:26624
    v_exp_f32 v109, v61
    v_add_f32 v31, v105, v107
    v_cvt_pk_bf16_f32 v97, v106, v107
    v_mfma_f32_32x32x16_bf16 v[128:143], a[240:243], a[136:139], v[128:143]
    v_exp_f32 v110, v62
    v_add_f32 v30, v30, v108
    v_exp_f32 v111, v63
    v_mfma_f32_32x32x16_bf16 v[40:55], v[236:239], v[204:207], v[40:55]
    ds_read_b128 v[236:239], v4 offset:57344
    v_add_f32 v31, v31, v109
    v_mfma_f32_32x32x16_bf16 a[176:191], a[216:219], v[88:91], a[176:191]
    ds_read_b64_tr_b16 a[216:217], v11 offset:24576
    ds_read_b64_tr_b16 a[218:219], v11 offset:26624
    v_cvt_pk_bf16_f32 v98, v108, v109
    v_exp_f32 v104, v64
    v_mfma_f32_32x32x16_bf16 v[144:159], a[244:247], a[136:139], v[144:159]
    s_lshr_b32 s95, s35, 1
    s_add_u32 s95, s95, s96
    s_and_b32 s95, s95, 3
    s_lshl_b32 s95, s95, 2
    s_and_b32 s98, s35, 1
    s_add_u32 s95, s95, s98
    s_mul_i32 s95, s95, 73728
    s_and_b32 s98, s96, 1
    s_lshl_b32 s98, s98, 6
    s_add_u32 s98, s98, s95
    s_add_u32 s98, s98, 1024
    s_lshl_b32 s99, s96, 8
    v_mfma_f32_32x32x16_bf16 v[40:55], v[240:243], v[208:211], v[40:55]
    ds_read_b128 v[240:243], v5 offset:57344
    v_add_f32 v30, v30, v110
    v_exp_f32 v105, v65
    v_add_f32 v31, v31, v111
    s_waitcnt lgkmcnt(14)
    v_mfma_f32_32x32x16_bf16 v[160:175], a[248:251], a[136:139], v[160:175]
    v_cvt_pk_bf16_f32 v99, v110, v111
    v_exp_f32 v106, v66
    v_mfma_f32_32x32x16_bf16 a[192:207], a[220:223], v[88:91], a[192:207]
    ds_read_b64_tr_b16 a[220:221], v12 offset:24576
    ds_read_b64_tr_b16 a[222:223], v12 offset:26624
    v_lshrrev_b32 v23, 13, v22
    v_add_f32 v30, v30, v104
    v_mfma_f32_32x32x16_bf16 v[40:55], v[244:247], v[212:215], v[40:55]
    ds_read_b128 v[244:247], v6 offset:57344
    v_exp_f32 v107, v67
    v_and_b32 v22, 0xff, v22
    v_mul_u32_u24 v23, 1152, v23
    v_add_f32 v31, v31, v105
    v_mfma_f32_32x32x16_bf16 v[176:191], a[252:255], a[136:139], v[176:191]
    v_cvt_pk_bf16_f32 v100, v104, v105
    v_add3_u32 v22, v22, v23, s99
    v_mfma_f32_32x32x16_bf16 a[144:159], a[224:227], v[92:95], a[144:159]
    ds_read_b64_tr_b16 a[224:225], v9 offset:28672
    ds_read_b64_tr_b16 a[226:227], v9 offset:30720
    v_exp_f32 v108, v68
    v_add_u32 v23, 3584, v22
    v_add_u32 v24, 7168, v22
    v_mfma_f32_32x32x16_bf16 v[40:55], v[248:251], v[216:219], v[40:55]
    ds_read_b128 v[248:251], v7 offset:57344
    v_add_f32 v30, v30, v106
    v_exp_f32 v109, v69
    v_add_u32 v25, 10752, v22
    v_bfe_u32 v38, v0, 6, 4
    v_mfma_f32_32x32x16_bf16 v[128:143], v[112:115], a[140:143], v[128:143]
    v_add_f32 v31, v31, v107
    v_cvt_pk_bf16_f32 v101, v106, v107
    v_mul_u32_u24 v38, 1152, v38
    v_mfma_f32_32x32x16_bf16 a[160:175], a[228:231], v[92:95], a[160:175]
    ds_read_b64_tr_b16 a[228:229], v10 offset:28672
    ds_read_b64_tr_b16 a[230:231], v10 offset:30720
    v_exp_f32 v110, v70
    v_and_b32 v37, 0x30, v0
    v_add_u32 v38, v38, v37
    v_mfma_f32_32x32x16_bf16 v[144:159], v[116:119], a[140:143], v[144:159]
    v_add_f32 v30, v30, v108
    v_exp_f32 v111, v71
    v_and_b32 v39, 0x2d0, v0
    v_and_b32 v37, 0x20, v0
    v_mfma_f32_32x32x16_bf16 v[40:55], v[252:255], v[220:223], v[40:55]
    ds_read_b128 v[252:255], v8 offset:57344
    v_add_f32 v31, v31, v109
    v_lshrrev_b32 v37, 2, v37
    v_cvt_pk_bf16_f32 v102, v108, v109
    v_mfma_f32_32x32x16_bf16 a[176:191], a[232:235], v[92:95], a[176:191]
    ds_read_b64_tr_b16 a[232:233], v11 offset:28672
    ds_read_b64_tr_b16 a[234:235], v11 offset:30720
    v_add_f32 v30, v30, v110
    v_add_u32 v39, v39, v37
    v_add_f32 v31, v31, v111
    v_and_b32 v37, 0x100, v0
    s_waitcnt lgkmcnt(14)
    v_mfma_f32_32x32x16_bf16 v[160:175], v[120:123], a[140:143], v[160:175]
    v_cvt_pk_bf16_f32 v103, v110, v111
    v_add_f32 v30, v30, v31
    v_lshrrev_b32 v37, 3, v37
    v_cmp_nge_f32 vcc, s28, v30
    v_mfma_f32_32x32x16_bf16 a[192:207], a[236:239], v[92:95], a[192:207]
    ds_read_b64_tr_b16 a[236:237], v12 offset:28672
    ds_read_b64_tr_b16 a[238:239], v12 offset:30720
    s_cbranch_vccnz K1_STUB_13
K1_BACK_13:
    v_add_u32 v39, v39, v37
    v_add_u32 v39, 98304, v39
    v_add_f32 v28, v28, v30
    v_mfma_f32_32x32x16_bf16 v[176:191], v[124:127], a[140:143], v[176:191]
    v_mfma_f32_32x32x16_bf16 v[56:71], v[224:227], v[192:195], v[72:87]
    v_exp_f32 v104, v40
    v_exp_f32 v105, v41
    v_exp_f32 v106, v42
    v_exp_f32 v107, v43
    v_mfma_f32_32x32x16_bf16 v[56:71], v[228:231], v[196:199], v[56:71]
    v_cvt_pk_bf16_f32 v88, v104, v105
    v_exp_f32 v108, v44
    v_mfma_f32_32x32x16_bf16 a[144:159], a[208:211], v[96:99], a[144:159]
    s_waitcnt lgkmcnt(0)
    s_waitcnt vmcnt(12)
    s_barrier
    ds_read_b128 v[224:227], v1 offset:0
    ds_read_b128 v[228:231], v2 offset:0
    ds_read_b64_tr_b16 a[208:209], v9 offset:32768
    ds_read_b64_tr_b16 a[210:211], v9 offset:34816
    v_pk_mul_f32 v[128:129], v[128:129], s[32:33]
    v_pk_mul_f32 v[130:131], v[130:131], s[32:33]
    v_pk_mul_f32 v[132:133], v[132:133], s[32:33]
    v_cvt_pk_bf16_f32 v128, v128, v129
    v_pk_mul_f32 v[134:135], v[134:135], s[32:33]
    v_mfma_f32_32x32x16_bf16 v[56:71], v[232:235], v[200:203], v[56:71]
    ds_read_b128 v[232:235], v3 offset:0
    s_add_u32 m0, s24, 65536
    s_mov_b32 s27, 147456
    v_add_f32 v30, v104, v106
    v_exp_f32 v109, v45
    v_cvt_pk_bf16_f32 v129, v130, v131
    v_pk_mul_f32 v[136:137], v[136:137], s[32:33]
    v_cvt_pk_bf16_f32 v130, v132, v133
    v_pk_mul_f32 v[138:139], v[138:139], s[32:33]
    v_add_f32 v31, v105, v107
    v_mfma_f32_32x32x16_bf16 a[160:175], a[212:215], v[96:99], a[160:175]
    ds_read_b64_tr_b16 a[212:213], v10 offset:32768
    ds_read_b64_tr_b16 a[214:215], v10 offset:34816
    buffer_load_dwordx4 v21, s[16:19], s27 offen offset:0 nt lds
    v_cvt_pk_bf16_f32 v131, v134, v135
    v_cvt_pk_bf16_f32 v89, v106, v107
    v_exp_f32 v110, v46
    v_pk_mul_f32 v[140:141], v[140:141], s[32:33]
    v_cvt_pk_bf16_f32 v132, v136, v137
    v_pk_mul_f32 v[142:143], v[142:143], s[32:33]
    v_mfma_f32_32x32x16_bf16 v[56:71], v[236:239], v[204:207], v[56:71]
    s_branch K1_TJ5
K1_TP5:
    s_setpc_b64 s[30:31]
K1_TJ5:
    ds_read_b128 v[236:239], v4 offset:0
    buffer_load_dwordx4 v21, s[16:19], s27 offen offset:1024 nt lds
    v_cvt_pk_bf16_f32 v133, v138, v139
    v_add_f32 v30, v30, v108
    v_exp_f32 v111, v47
    v_pk_mul_f32 v[144:145], v[144:145], s[32:33]
    v_cvt_pk_bf16_f32 v134, v140, v141
    v_pk_mul_f32 v[146:147], v[146:147], s[32:33]
    v_cvt_pk_bf16_f32 v135, v142, v143
    v_mfma_f32_32x32x16_bf16 a[176:191], a[216:219], v[96:99], a[176:191]
    ds_read_b64_tr_b16 a[216:217], v11 offset:32768
    ds_read_b64_tr_b16 a[218:219], v11 offset:34816
    buffer_load_dwordx4 v21, s[16:19], s27 offen offset:2048 nt lds
    buffer_load_dwordx4 v21, s[16:19], s27 offen offset:3072 nt lds
    v_add_f32 v31, v31, v109
    v_pk_mul_f32 v[148:149], v[148:149], s[32:33]
    v_cvt_pk_bf16_f32 v90, v108, v109
    v_cvt_pk_bf16_f32 v136, v144, v145
    v_pk_mul_f32 v[150:151], v[150:151], s[32:33]
    v_mfma_f32_32x32x16_bf16 v[56:71], v[240:243], v[208:211], v[56:71]
    ds_read_b128 v[240:243], v5 offset:0
    s_add_u32 m0, s24, 49152
    v_exp_f32 v104, v48
    v_cvt_pk_bf16_f32 v137, v146, v147
    v_pk_mul_f32 v[152:153], v[152:153], s[32:33]
    v_add_f32 v30, v30, v110
    v_exp_f32 v105, v49
    v_cvt_pk_bf16_f32 v138, v148, v149
    v_pk_mul_f32 v[154:155], v[154:155], s[32:33]
    v_mfma_f32_32x32x16_bf16 a[192:207], a[220:223], v[96:99], a[192:207]
    ds_read_b64_tr_b16 a[220:221], v12 offset:32768
    s_mov_b32 s27, 180224
    buffer_load_dwordx4 v17, s[12:15], s27 offen offset:0 nt lds
    v_cvt_pk_bf16_f32 v139, v150, v151
    v_pk_mul_f32 v[156:157], v[156:157], s[32:33]
    v_add_f32 v31, v31, v111
    v_cvt_pk_bf16_f32 v140, v152, v153
    v_cvt_pk_bf16_f32 v91, v110, v111
    v_pk_mul_f32 v[158:159], v[158:159], s[32:33]
    v_cvt_pk_bf16_f32 v141, v154, v155
    v_mfma_f32_32x32x16_bf16 v[56:71], v[244:247], v[212:215], v[56:71]
    ds_read_b64_tr_b16 a[222:223], v12 offset:34816
    ds_read_b128 v[244:247], v6 offset:0
    buffer_load_dwordx4 v18, s[12:15], s27 offen offset:1024 nt lds
    v_exp_f32 v106, v50
    v_pk_mul_f32 v[160:161], v[160:161], s[32:33]
    v_cvt_pk_bf16_f32 v142, v156, v157
    v_add_f32 v30, v30, v104
    v_pk_mul_f32 v[162:163], v[162:163], s[32:33]
    v_cvt_pk_bf16_f32 v143, v158, v159
    v_mfma_f32_32x32x16_bf16 a[144:159], a[224:227], v[100:103], a[144:159]
    buffer_load_dwordx4 v19, s[12:15], s27 offen offset:2048 nt lds
    v_exp_f32 v107, v51
    v_pk_mul_f32 v[164:165], v[164:165], s[32:33]
    v_cvt_pk_bf16_f32 v144, v160, v161
    v_add_f32 v31, v31, v105
    v_pk_mul_f32 v[166:167], v[166:167], s[32:33]
    v_cvt_pk_bf16_f32 v92, v104, v105
    v_cvt_pk_bf16_f32 v145, v162, v163
    v_pk_mul_f32 v[168:169], v[168:169], s[32:33]
    v_mfma_f32_32x32x16_bf16 v[56:71], v[248:251], v[216:219], v[56:71]
    ds_read_b64_tr_b16 a[224:225], v9 offset:36864
    ds_read_b64_tr_b16 a[226:227], v9 offset:38912
    buffer_load_dwordx4 v20, s[12:15], s27 offen offset:3072 nt lds
    v_exp_f32 v108, v52
    v_cvt_pk_bf16_f32 v146, v164, v165
    v_pk_mul_f32 v[170:171], v[170:171], s[32:33]
    v_add_f32 v30, v30, v106
    v_cvt_pk_bf16_f32 v147, v166, v167
    v_pk_mul_f32 v[172:173], v[172:173], s[32:33]
    v_mfma_f32_32x32x16_bf16 a[160:175], a[228:231], v[100:103], a[160:175]
    ds_read_b128 v[248:251], v7 offset:0
    ds_read_b64_tr_b16 a[228:229], v10 offset:36864
    v_exp_f32 v109, v53
    v_cvt_pk_bf16_f32 v148, v168, v169
    v_add_f32 v31, v31, v107
    v_pk_mul_f32 v[174:175], v[174:175], s[32:33]
    v_cvt_pk_bf16_f32 v149, v170, v171
    v_cvt_pk_bf16_f32 v93, v106, v107
    v_pk_mul_f32 v[176:177], v[176:177], s[32:33]
    v_cvt_pk_bf16_f32 v150, v172, v173
    v_mfma_f32_32x32x16_bf16 v[56:71], v[252:255], v[220:223], v[56:71]
    ds_read_b64_tr_b16 a[230:231], v10 offset:38912
    v_exp_f32 v110, v54
    v_pk_mul_f32 v[178:179], v[178:179], s[32:33]
    v_add_f32 v30, v30, v108
    v_exp_f32 v111, v55
    v_cvt_pk_bf16_f32 v151, v174, v175
    v_pk_mul_f32 v[180:181], v[180:181], s[32:33]
    v_cvt_pk_bf16_f32 v152, v176, v177
    v_pk_mul_f32 v[182:183], v[182:183], s[32:33]
    v_mfma_f32_32x32x16_bf16 a[176:191], a[232:235], v[100:103], a[176:191]
    s_lshl_b32 s95, s96, 4
    s_add_u32 s95, s95, s37
    s_lshl2_add_u32 s95, s95, s35
    s_mul_i32 s27, s95, 4608
    s_add_u32 s27, s27, 0
    v_and_b32 v29, 0x3f0, v0
    v_min_u32 v29, 560, v29
    v_lshlrev_b32 v29, 3, v29
    buffer_load_dword a143, v29, s[4:7], s27 offen
    v_mfma_f32_32x32x16_bf16 a[192:207], a[236:239], v[100:103], a[192:207]
    ds_read_b128 v[252:255], v8 offset:0
    ds_read_b64_tr_b16 a[232:233], v11 offset:36864
    ds_read_b64_tr_b16 a[234:235], v11 offset:38912
    ds_read_b64_tr_b16 a[236:237], v12 offset:36864
    ds_read_b64_tr_b16 a[238:239], v12 offset:38912
    v_add_f32 v31, v31, v109
    v_cvt_pk_bf16_f32 v153, v178, v179
    v_pk_mul_f32 v[184:185], v[184:185], s[32:33]
    v_cvt_pk_bf16_f32 v94, v108, v109
    v_cvt_pk_bf16_f32 v154, v180, v181
    v_add_f32 v30, v30, v110
    v_pk_mul_f32 v[186:187], v[186:187], s[32:33]
    v_add_f32 v31, v31, v111
    v_cvt_pk_bf16_f32 v155, v182, v183
    v_cvt_pk_bf16_f32 v95, v110, v111
    v_pk_mul_f32 v[188:189], v[188:189], s[32:33]
    v_cvt_pk_bf16_f32 v156, v184, v185
    v_add_f32 v30, v30, v31
    v_pk_mul_f32 v[190:191], v[190:191], s[32:33]
    v_cmp_nge_f32 vcc, s28, v30
    s_cbranch_vccnz K1_STUB_14
K1_BACK_14:
    v_cvt_pk_bf16_f32 v157, v186, v187
    v_cvt_pk_bf16_f32 v158, v188, v189
    v_add_f32 v28, v28, v30
    v_cvt_pk_bf16_f32 v159, v190, v191
    s_waitcnt lgkmcnt(14)
    v_mfma_f32_32x32x16_bf16 v[40:55], v[224:227], v[128:131], 0
    ds_read_b128 v[224:227], v1 offset:8192
    v_exp_f32 v104, v56
    v_exp_f32 v105, v57
    v_mfma_f32_32x32x16_bf16 v[40:55], v[228:231], v[132:135], v[40:55]
    ds_read_b128 v[228:231], v2 offset:8192
    v_exp_f32 v106, v58
    v_exp_f32 v107, v59
    v_cvt_pk_bf16_f32 v96, v104, v105
    v_mfma_f32_32x32x16_bf16 a[144:159], a[208:211], v[88:91], a[144:159]
    ds_read_b64_tr_b16 a[208:209], v9 offset:40960
    ds_read_b64_tr_b16 a[210:211], v9 offset:43008
    v_exp_f32 v108, v60
    v_add_f32 v30, v104, v106
    v_mfma_f32_32x32x16_bf16 v[40:55], v[232:235], v[136:139], v[40:55]
    ds_read_b128 v[232:235], v3 offset:8192
    v_exp_f32 v109, v61
    v_add_f32 v31, v105, v107
    v_cvt_pk_bf16_f32 v97, v106, v107
    v_mfma_f32_32x32x16_bf16 a[160:175], a[212:215], v[88:91], a[160:175]
    ds_read_b64_tr_b16 a[212:213], v9 offset:45056
    ds_read_b64_tr_b16 a[214:215], v9 offset:47104
    v_exp_f32 v110, v62
    v_add_f32 v30, v30, v108
    v_mfma_f32_32x32x16_bf16 v[40:55], v[236:239], v[140:143], v[40:55]
    s_lshl_b32 s95, s97, 6
    v_xor_b32 v13, s95, v13
    v_xor_b32 v14, s95, v14
    v_xor_b32 v15, s95, v15
    v_xor_b32 v16, s95, v16
    s_and_b32 s95, s96, 2
    s_lshl_b32 s95, s95, 4
    v_xor_b32 v39, s95, v39
    v_mfma_f32_32x32x16_bf16 a[176:191], a[216:219], v[88:91], a[176:191]
    ds_read_b128 v[236:239], v4 offset:8192
    ds_read_b64_tr_b16 a[216:217], v10 offset:40960
    v_exp_f32 v111, v63
    v_add_f32 v31, v31, v109
    v_cvt_pk_bf16_f32 v98, v108, v109
    s_waitcnt lgkmcnt(14)
    v_mfma_f32_32x32x16_bf16 v[40:55], v[240:243], v[144:147], v[40:55]
    ds_read_b64_tr_b16 a[218:219], v10 offset:43008
    v_exp_f32 v104, v64
    v_add_f32 v30, v30, v110
    v_exp_f32 v105, v65
    v_mfma_f32_32x32x16_bf16 a[192:207], a[220:223], v[88:91], a[192:207]
    ds_read_b128 v[240:243], v5 offset:8192
    ds_read_b64_tr_b16 a[220:221], v10 offset:45056
    ds_read_b64_tr_b16 a[222:223], v10 offset:47104
    v_add_f32 v31, v31, v111
    v_cvt_pk_bf16_f32 v99, v110, v111
    v_mfma_f32_32x32x16_bf16 v[40:55], v[244:247], v[148:151], v[40:55]
    ds_read_b128 v[244:247], v6 offset:8192
    v_exp_f32 v106, v66
    v_add_f32 v30, v30, v104
    v_exp_f32 v107, v67
    v_mfma_f32_32x32x16_bf16 a[144:159], a[224:227], v[92:95], a[144:159]
    ds_read_b64_tr_b16 a[224:225], v11 offset:40960
    ds_read_b64_tr_b16 a[226:227], v11 offset:43008
    v_add_f32 v31, v31, v105
    v_cvt_pk_bf16_f32 v100, v104, v105
    v_exp_f32 v108, v68
    v_mfma_f32_32x32x16_bf16 v[40:55], v[248:251], v[152:155], v[40:55]
    ds_read_b128 v[248:251], v7 offset:8192
    v_add_f32 v30, v30, v106
    v_exp_f32 v109, v69
    v_subrev_u32 v32, 98304, v13
    v_add_f32 v31, v31, v107
    v_mfma_f32_32x32x16_bf16 a[160:175], a[228:231], v[92:95], a[160:175]
    ds_read_b64_tr_b16 a[228:229], v11 offset:45056
    ds_read_b64_tr_b16 a[230:231], v11 offset:47104
    v_cvt_pk_bf16_f32 v101, v106, v107
    v_exp_f32 v110, v70
    v_subrev_u32 v33, 98304, v14
    s_waitcnt lgkmcnt(14)
    v_mfma_f32_32x32x16_bf16 v[40:55], v[252:255], v[156:159], v[40:55]
    ds_read_b128 v[252:255], v8 offset:8192
    v_add_f32 v30, v30, v108
    v_exp_f32 v111, v71
    v_add_f32 v31, v31, v109
    v_cvt_pk_bf16_f32 v102, v108, v109
    v_mfma_f32_32x32x16_bf16 a[176:191], a[232:235], v[92:95], a[176:191]
    ds_read_b64_tr_b16 a[232:233], v12 offset:40960
    ds_read_b64_tr_b16 a[234:235], v12 offset:43008
    v_subrev_u32 v34, 98304, v15
    v_add_f32 v30, v30, v110
    v_add_f32 v31, v31, v111
    v_cvt_pk_bf16_f32 v103, v110, v111
    v_mfma_f32_32x32x16_bf16 a[192:207], a[236:239], v[92:95], a[192:207]
    ds_read_b64_tr_b16 a[236:237], v12 offset:45056
    ds_read_b64_tr_b16 a[238:239], v12 offset:47104
    v_add_f32 v30, v30, v31
    v_cmp_nge_f32 vcc, s28, v30
    s_cbranch_vccnz K1_STUB_15
K1_BACK_15:
    v_subrev_u32 v35, 98304, v16
    v_add_f32 v28, v28, v30
    v_mfma_f32_32x32x16_bf16 a[144:159], a[208:211], v[96:99], a[144:159]
    v_mov_b32 v27, v28
    v_mov_b32 v26, v28
    s_nop 1
    v_permlane32_swap_b32 v26, v27
    v_add_f32 v26, v26, v27
    v_rcp_f32 v26, v26
    v_max3_f32 v30, v40, v41, v42
    v_max3_f32 v31, v43, v44, v45
    v_max3_f32 v30, v30, v46, v47
    s_waitcnt lgkmcnt(14)
    v_mfma_f32_32x32x16_bf16 a[144:159], a[212:215], v[100:103], a[144:159]
    v_max3_f32 v31, v31, v48, v49
    v_max3_f32 v30, v30, v50, v51
    v_max3_f32 v31, v31, v52, v53
    v_max3_f32 v30, v30, v54, v55
    v_max_f32 v30, v30, v31
    v_mov_b32 v31, v30
    s_nop 1
    v_permlane32_swap_b32 v30, v31
    v_mfma_f32_32x32x16_bf16 a[160:175], a[216:219], v[96:99], a[160:175]
    s_waitcnt lgkmcnt(0)
    s_waitcnt vmcnt(13)
    s_barrier
    ds_read_b64_tr_b16 a[208:209], v9 offset:49152
    ds_read_b64_tr_b16 a[210:211], v9 offset:51200
    ds_read_b64_tr_b16 a[212:213], v10 offset:49152
    ds_read_b64_tr_b16 a[214:215], v10 offset:51200
    ds_read_b64_tr_b16 a[216:217], v11 offset:49152
    ds_read_b64_tr_b16 a[218:219], v11 offset:51200
    v_max_f32 v30, v30, v31
    v_sub_f32 v72, 0, v30
    v_mov_b32 v73, v72
    v_mfma_f32_32x32x16_bf16 a[160:175], a[220:223], v[100:103], a[160:175]
    ds_read_b64_tr_b16 a[220:221], v12 offset:49152
    ds_read_b64_tr_b16 a[222:223], v12 offset:51200
    s_add_u32 m0, s24, 81920
    s_mov_b32 s27, 163840
    v_mov_b32 v74, v72
    v_mov_b32 v75, v72
    v_mov_b32 v76, v72
    v_mov_b32 v77, v72
    v_mov_b32 v78, v72
    v_mov_b32 v79, v72
    v_mov_b32 v80, v72
    v_mfma_f32_32x32x16_bf16 a[176:191], a[224:227], v[96:99], a[176:191]
    ds_read_b64_tr_b16 a[224:225], v9 offset:53248
    ds_read_b64_tr_b16 a[226:227], v9 offset:55296
    buffer_load_dwordx4 v21, s[16:19], s27 offen offset:0 nt lds
    v_mov_b32 v81, v72
    v_mov_b32 v82, v72
    v_mov_b32 v83, v72
    v_mov_b32 v84, v72
    v_mov_b32 v85, v72
    v_mov_b32 v86, v72
    v_mov_b32 v87, v72
    v_mfma_f32_32x32x16_bf16 a[176:191], a[228:231], v[100:103], a[176:191]
    ds_read_b64_tr_b16 a[228:229], v10 offset:53248
    ds_read_b64_tr_b16 a[230:231], v10 offset:55296
    buffer_load_dwordx4 v21, s[16:19], s27 offen offset:1024 nt lds
    v_sub_f32 v40, v40, v30
    v_sub_f32 v41, v41, v30
    v_sub_f32 v42, v42, v30
    v_sub_f32 v43, v43, v30
    v_sub_f32 v44, v44, v30
    v_sub_f32 v45, v45, v30
    v_sub_f32 v46, v46, v30
    v_mfma_f32_32x32x16_bf16 a[192:207], a[232:235], v[96:99], a[192:207]
    ds_read_b64_tr_b16 a[232:233], v11 offset:53248
    ds_read_b64_tr_b16 a[234:235], v11 offset:55296
    buffer_load_dwordx4 v21, s[16:19], s27 offen offset:2048 nt lds
    v_sub_f32 v47, v47, v30
    v_sub_f32 v48, v48, v30
    v_sub_f32 v49, v49, v30
    v_sub_f32 v50, v50, v30
    v_sub_f32 v51, v51, v30
    v_sub_f32 v52, v52, v30
    v_sub_f32 v53, v53, v30
    v_mfma_f32_32x32x16_bf16 a[192:207], a[236:239], v[100:103], a[192:207]
    ds_read_b64_tr_b16 a[236:237], v12 offset:53248
    ds_read_b64_tr_b16 a[238:239], v12 offset:55296
    buffer_load_dwordx4 v21, s[16:19], s27 offen offset:3072 nt lds
    v_sub_f32 v54, v54, v30
    v_sub_f32 v55, v55, v30
    v_exp_f32 v104, v40
    v_exp_f32 v105, v41
    v_mfma_f32_32x32x16_bf16 v[56:71], v[224:227], v[128:131], v[72:87]
    ds_read_b128 v[224:227], v1 offset:16384
    v_exp_f32 v106, v42
    v_exp_f32 v107, v43
    v_accvgpr_read_b32 v120, a144
    v_accvgpr_read_b32 v121, a145
    v_accvgpr_read_b32 v122, a146
    v_cvt_pk_bf16_f32 v88, v104, v105
    v_accvgpr_read_b32 v123, a147
    v_accvgpr_read_b32 v124, a148
    v_mfma_f32_32x32x16_bf16 v[56:71], v[228:231], v[132:135], v[56:71]
    ds_read_b128 v[228:231], v2 offset:16384
    v_exp_f32 v108, v44
    v_add_f32 v30, v104, v106
    v_exp_f32 v109, v45
    v_add_f32 v31, v105, v107
    v_accvgpr_read_b32 v125, a149
    v_cvt_pk_bf16_f32 v89, v106, v107
    v_accvgpr_read_b32 v126, a150
    v_accvgpr_read_b32 v127, a151
    v_mfma_f32_32x32x16_bf16 v[56:71], v[232:235], v[136:139], v[56:71]
    ds_read_b128 v[232:235], v3 offset:16384
    s_add_u32 s95, s96, 0
    s_and_b32 s95, s95, 3
    s_mul_i32 s27, s95, 294912
    s_add_u32 s27, s27, 0
    s_add_u32 m0, s24, 114688
    v_exp_f32 v110, v46
    v_add_f32 v30, v30, v108
    v_exp_f32 v111, v47
    v_mfma_f32_32x32x16_bf16 v[56:71], v[236:239], v[140:143], v[56:71]
    ds_read_b128 v[236:239], v4 offset:16384
    v_add_f32 v31, v31, v109
    v_pk_mul_f32 v[120:121], v[120:121], v[26:27] op_sel_hi:[1,0]
    v_cvt_pk_bf16_f32 v90, v108, v109
    v_exp_f32 v104, v48
    v_pk_mul_f32 v[122:123], v[122:123], v[26:27] op_sel_hi:[1,0]
    v_add_f32 v30, v30, v110
    v_exp_f32 v105, v49
    v_pk_mul_f32 v[124:125], v[124:125], v[26:27] op_sel_hi:[1,0]
    v_mfma_f32_32x32x16_bf16 v[56:71], v[240:243], v[144:147], v[56:71]
    ds_read_b128 v[240:243], v5 offset:16384
    buffer_load_dwordx4 v22, s[4:7], s27 offen offset:0  lds
    v_add_f32 v31, v31, v111
    v_pk_mul_f32 v[126:127], v[126:127], v[26:27] op_sel_hi:[1,0]
    v_cvt_pk_bf16_f32 v91, v110, v111
    v_exp_f32 v106, v50
    v_cvt_pk_bf16_f32 v120, v120, v121
    v_add_f32 v30, v30, v104
    v_cvt_pk_bf16_f32 v121, v122, v123
    v_mfma_f32_32x32x16_bf16 v[56:71], v[244:247], v[148:151], v[56:71]
    ds_read_b128 v[244:247], v6 offset:16384
    buffer_load_dwordx4 v23, s[4:7], s27 offen offset:1024  lds
    v_exp_f32 v107, v51
    v_add_f32 v31, v31, v105
    v_cvt_pk_bf16_f32 v92, v104, v105
    v_exp_f32 v108, v52
    v_cvt_pk_bf16_f32 v122, v124, v125
    v_cvt_pk_bf16_f32 v123, v126, v127
    v_mfma_f32_32x32x16_bf16 v[56:71], v[248:251], v[152:155], v[56:71]
    ds_read_b128 v[248:251], v7 offset:16384
    buffer_load_dwordx4 v24, s[4:7], s27 offen offset:2048  lds
    v_add_f32 v30, v30, v106
    v_exp_f32 v109, v53
    v_and_b32 v120, -2, v120
    v_add_f32 v31, v31, v107
    v_cvt_pk_bf16_f32 v93, v106, v107
    v_and_b32 v122, -2, v122
    v_accvgpr_write_b32 a80, v120
    v_mfma_f32_32x32x16_bf16 v[56:71], v[252:255], v[156:159], v[56:71]
    ds_read_b128 v[252:255], v8 offset:16384
    buffer_load_dwordx4 v25, s[4:7], s27 offen offset:3072  lds
    v_exp_f32 v110, v54
    v_add_f32 v30, v30, v108
    v_exp_f32 v111, v55
    v_accvgpr_write_b32 a81, v121
    v_add_f32 v31, v31, v109
    v_cvt_pk_bf16_f32 v94, v108, v109
    v_accvgpr_write_b32 a82, v122
    v_add_f32 v30, v30, v110
    v_add_f32 v31, v31, v111
    v_cvt_pk_bf16_f32 v95, v110, v111
    v_accvgpr_write_b32 a83, v123
    v_add_f32 v29, v30, v31
    s_waitcnt lgkmcnt(7)
    v_mfma_f32_32x32x16_bf16 v[40:55], v[224:227], v[128:131], v[72:87]
    ds_read_b128 v[224:227], v1 offset:24576
    s_add_u32 m0, s24, 0
    v_exp_f32 v104, v56
    v_exp_f32 v105, v57
    v_accvgpr_read_b32 v120, a152
    v_accvgpr_read_b32 v121, a153
    v_accvgpr_read_b32 v122, a154
    v_accvgpr_read_b32 v123, a155
    s_waitcnt lgkmcnt(7)
    v_mfma_f32_32x32x16_bf16 v[40:55], v[228:231], v[132:135], v[40:55]
    ds_read_b128 v[228:231], v2 offset:24576
    s_mov_b32 s27, 196608
    v_exp_f32 v106, v58
    v_exp_f32 v107, v59
    v_accvgpr_read_b32 v124, a156
    v_accvgpr_read_b32 v125, a157
    v_accvgpr_read_b32 v126, a158
    v_accvgpr_read_b32 v127, a159
    v_pk_mul_f32 v[120:121], v[120:121], v[26:27] op_sel_hi:[1,0]
    v_mfma_f32_32x32x16_bf16 v[160:175], a[208:211], v[88:91], 0
    ds_read_b64_tr_b16 a[208:209], v9 offset:57344
    ds_read_b64_tr_b16 a[210:211], v9 offset:59392
    buffer_load_dwordx4 v17, s[12:15], s27 offen offset:0 nt lds
    v_pk_mul_f32 v[122:123], v[122:123], v[26:27] op_sel_hi:[1,0]
    v_cvt_pk_bf16_f32 v96, v104, v105
    v_exp_f32 v108, v60
    v_pk_mul_f32 v[124:125], v[124:125], v[26:27] op_sel_hi:[1,0]
    v_pk_mul_f32 v[126:127], v[126:127], v[26:27] op_sel_hi:[1,0]
    v_cvt_pk_bf16_f32 v120, v120, v121
    s_waitcnt lgkmcnt(9)
    v_mfma_f32_32x32x16_bf16 v[40:55], v[232:235], v[136:139], v[40:55]
    ds_read_b128 v[232:235], v3 offset:24576
    buffer_load_dwordx4 v18, s[12:15], s27 offen offset:1024 nt lds
    v_add_f32 v30, v104, v106
    v_exp_f32 v109, v61
    v_cvt_pk_bf16_f32 v121, v122, v123
    v_cvt_pk_bf16_f32 v122, v124, v125
    v_cvt_pk_bf16_f32 v123, v126, v127
    v_add_f32 v31, v105, v107
    v_mfma_f32_32x32x16_bf16 v[176:191], a[212:215], v[88:91], 0
    ds_read_b64_tr_b16 a[212:213], v10 offset:57344
    ds_read_b64_tr_b16 a[214:215], v10 offset:59392
    buffer_load_dwordx4 v19, s[12:15], s27 offen offset:2048 nt lds
    v_and_b32 v120, -2, v120
    v_and_b32 v122, -2, v122
    v_cvt_pk_bf16_f32 v97, v106, v107
    v_exp_f32 v110, v62
    v_accvgpr_write_b32 a84, v120
    v_accvgpr_write_b32 a85, v121
    s_waitcnt lgkmcnt(11)
    v_mfma_f32_32x32x16_bf16 v[40:55], v[236:239], v[140:143], v[40:55]
    ds_read_b128 v[236:239], v4 offset:24576
    v_accvgpr_write_b32 a86, v122
    v_add_f32 v30, v30, v108
    v_exp_f32 v111, v63
    v_accvgpr_write_b32 a87, v123
    v_accvgpr_read_b32 v120, a160
    v_accvgpr_read_b32 v121, a161
    v_add_f32 v31, v31, v109
    v_accvgpr_read_b32 v122, a162
    v_accvgpr_read_b32 v123, a163
    v_mfma_f32_32x32x16_bf16 v[192:207], a[216:219], v[88:91], 0
    ds_read_b64_tr_b16 a[216:217], v11 offset:57344
    ds_read_b64_tr_b16 a[218:219], v11 offset:59392
    buffer_load_dwordx4 v20, s[12:15], s27 offen offset:3072 nt lds
    v_cvt_pk_bf16_f32 v98, v108, v109
    v_exp_f32 v104, v64
    v_accvgpr_read_b32 v124, a164
    v_accvgpr_read_b32 v125, a165
    v_accvgpr_read_b32 v126, a166
    s_waitcnt lgkmcnt(13)
    v_mfma_f32_32x32x16_bf16 v[40:55], v[240:243], v[144:147], v[40:55]
    ds_read_b128 v[240:243], v5 offset:24576
    s_add_u32 m0, s24, 147456
    s_add_u32 s27, s98, 0
    v_add_f32 v30, v30, v110
    v_exp_f32 v105, v65
    v_accvgpr_read_b32 v127, a167
    v_pk_mul_f32 v[120:121], v[120:121], v[26:27] op_sel_hi:[1,0]
    v_pk_mul_f32 v[122:123], v[122:123], v[26:27] op_sel_hi:[1,0]
    v_add_f32 v31, v31, v111
    v_pk_mul_f32 v[124:125], v[124:125], v[26:27] op_sel_hi:[1,0]
    v_mfma_f32_32x32x16_bf16 v[208:223], a[220:223], v[88:91], 0
    ds_read_b64_tr_b16 a[220:221], v12 offset:57344
    ds_read_b64_tr_b16 a[222:223], v12 offset:59392
    v_pk_mul_f32 v[126:127], v[126:127], v[26:27] op_sel_hi:[1,0]
    v_cvt_pk_bf16_f32 v99, v110, v111
    v_exp_f32 v106, v66
    v_cvt_pk_bf16_f32 v120, v120, v121
    v_cvt_pk_bf16_f32 v121, v122, v123
    v_cvt_pk_bf16_f32 v122, v124, v125
    v_add_f32 v30, v30, v104
    v_cvt_pk_bf16_f32 v123, v126, v127
    s_waitcnt lgkmcnt(14)
    v_mfma_f32_32x32x16_bf16 v[40:55], v[244:247], v[148:151], v[40:55]
    ds_read_b128 v[244:247], v6 offset:24576
    buffer_load_dwordx4 v38, s[4:7], s27 offen offset:0  lds
    v_exp_f32 v107, v67
    v_and_b32 v120, -2, v120
    v_and_b32 v122, -2, v122
    v_add_f32 v31, v31, v105
    v_accvgpr_write_b32 a88, v120
    v_accvgpr_write_b32 a89, v121
    v_mfma_f32_32x32x16_bf16 v[160:175], a[224:227], v[92:95], v[160:175]
    ds_read_b64_tr_b16 a[224:225], v9 offset:61440
    ds_read_b64_tr_b16 a[226:227], v9 offset:63488
    s_add_u32 s27, s98, 17408
    v_cvt_pk_bf16_f32 v100, v104, v105
    v_exp_f32 v108, v68
    v_accvgpr_write_b32 a90, v122
    v_accvgpr_write_b32 a91, v123
    v_accvgpr_read_b32 v120, a168
    v_add_f32 v30, v30, v106
    v_accvgpr_read_b32 v121, a169
    v_mfma_f32_32x32x16_bf16 v[40:55], v[248:251], v[152:155], v[40:55]
    ds_read_b128 v[248:251], v7 offset:24576
    buffer_load_dwordx4 v38, s[4:7], s27 offen offset:1024  lds
    v_exp_f32 v109, v69
    v_accvgpr_read_b32 v122, a170
    v_accvgpr_read_b32 v123, a171
    v_add_f32 v31, v31, v107
    v_accvgpr_read_b32 v124, a172
    v_cvt_pk_bf16_f32 v101, v106, v107
    v_accvgpr_read_b32 v125, a173
    v_mfma_f32_32x32x16_bf16 v[176:191], a[228:231], v[92:95], v[176:191]
    ds_read_b64_tr_b16 a[228:229], v10 offset:61440
    ds_read_b64_tr_b16 a[230:231], v10 offset:63488
    s_add_u32 s27, s98, 34816
    v_exp_f32 v110, v70
    v_accvgpr_read_b32 v126, a174
    v_accvgpr_read_b32 v127, a175
    v_pk_mul_f32 v[120:121], v[120:121], v[26:27] op_sel_hi:[1,0]
    v_add_f32 v30, v30, v108
    v_pk_mul_f32 v[122:123], v[122:123], v[26:27] op_sel_hi:[1,0]
    s_waitcnt lgkmcnt(14)
    v_mfma_f32_32x32x16_bf16 v[40:55], v[252:255], v[156:159], v[40:55]
    ds_read_b128 v[252:255], v8 offset:24576
    buffer_load_dwordx4 v38, s[4:7], s27 offen offset:2048  lds
    v_exp_f32 v111, v71
    v_pk_mul_f32 v[124:125], v[124:125], v[26:27] op_sel_hi:[1,0]
    v_pk_mul_f32 v[126:127], v[126:127], v[26:27] op_sel_hi:[1,0]
    v_add_f32 v31, v31, v109
    v_cvt_pk_bf16_f32 v120, v120, v121
    v_cvt_pk_bf16_f32 v102, v108, v109
    v_cvt_pk_bf16_f32 v121, v122, v123
    v_mfma_f32_32x32x16_bf16 v[192:207], a[232:235], v[92:95], v[192:207]
    ds_read_b64_tr_b16 a[232:233], v11 offset:61440
    ds_read_b64_tr_b16 a[234:235], v11 offset:63488
    s_add_u32 s27, s98, 52224
    v_cvt_pk_bf16_f32 v122, v124, v125
    v_add_f32 v30, v30, v110
    v_cvt_pk_bf16_f32 v123, v126, v127
    v_add_f32 v31, v31, v111
    v_and_b32 v120, -2, v120
    v_cvt_pk_bf16_f32 v103, v110, v111
    v_and_b32 v122, -2, v122
    v_add_f32 v30, v30, v31
    v_mfma_f32_32x32x16_bf16 v[208:223], a[236:239], v[92:95], v[208:223]
    ds_read_b64_tr_b16 a[236:237], v12 offset:61440
    ds_read_b64_tr_b16 a[238:239], v12 offset:63488
    buffer_load_dwordx4 v38, s[4:7], s27 offen offset:3072  lds
    v_accvgpr_write_b32 a92, v120
    v_cmp_nge_f32 vcc, s28, v30
    s_cbranch_vccnz K1_STUB_17
K1_BACK_17:
    v_accvgpr_write_b32 a93, v121
    v_accvgpr_write_b32 a94, v122
    v_add_f32 v29, v29, v30
    v_accvgpr_write_b32 a95, v123
    v_mfma_f32_32x32x16_bf16 v[56:71], v[224:227], v[128:131], v[72:87]
    v_exp_f32 v104, v40
    v_exp_f32 v105, v41
    v_accvgpr_read_b32 v120, a176
    v_accvgpr_read_b32 v121, a177
    v_accvgpr_read_b32 v122, a178
    v_accvgpr_read_b32 v123, a179
    v_accvgpr_read_b32 v124, a180
    v_mfma_f32_32x32x16_bf16 v[56:71], v[228:231], v[132:135], v[56:71]
    v_exp_f32 v106, v42
    v_exp_f32 v107, v43
    v_accvgpr_read_b32 v125, a181
    v_cvt_pk_bf16_f32 v88, v104, v105
    v_accvgpr_read_b32 v126, a182
    v_accvgpr_read_b32 v127, a183
    v_mfma_f32_32x32x16_bf16 v[160:175], a[208:211], v[96:99], v[160:175]
    s_waitcnt lgkmcnt(0)
    s_waitcnt vmcnt(21)
    s_barrier
    ds_read_b128 v[224:227], v1 offset:32768
    ds_read_b128 v[228:231], v2 offset:32768
    ds_read_b64_tr_b16 a[208:209], v9 offset:16384
    ds_read_b64_tr_b16 a[210:211], v9 offset:18432
    v_exp_f32 v108, v44
    v_pk_mul_f32 v[120:121], v[120:121], v[26:27] op_sel_hi:[1,0]
    v_mfma_f32_32x32x16_bf16 v[56:71], v[232:235], v[136:139], v[56:71]
    ds_read_b128 v[232:235], v3 offset:32768
    s_add_u32 m0, s24, 98304
    s_mov_b32 s27, 180224
    v_add_f32 v30, v104, v106
    v_exp_f32 v109, v45
    v_pk_mul_f32 v[122:123], v[122:123], v[26:27] op_sel_hi:[1,0]
    v_pk_mul_f32 v[124:125], v[124:125], v[26:27] op_sel_hi:[1,0]
    v_add_f32 v31, v105, v107
    v_mfma_f32_32x32x16_bf16 v[176:191], a[212:215], v[96:99], v[176:191]
    ds_read_b64_tr_b16 a[212:213], v10 offset:16384
    ds_read_b64_tr_b16 a[214:215], v10 offset:18432
    buffer_load_dwordx4 v21, s[16:19], s27 offen offset:0 nt lds
    v_pk_mul_f32 v[126:127], v[126:127], v[26:27] op_sel_hi:[1,0]
    v_cvt_pk_bf16_f32 v89, v106, v107
    v_exp_f32 v110, v46
    v_cvt_pk_bf16_f32 v120, v120, v121
    v_mfma_f32_32x32x16_bf16 v[56:71], v[236:239], v[140:143], v[56:71]
    ds_read_b128 v[236:239], v4 offset:32768
    buffer_load_dwordx4 v21, s[16:19], s27 offen offset:1024 nt lds
    v_cvt_pk_bf16_f32 v121, v122, v123
    v_add_f32 v30, v30, v108
    v_exp_f32 v111, v47
    v_cvt_pk_bf16_f32 v122, v124, v125
    v_cvt_pk_bf16_f32 v123, v126, v127
    v_mfma_f32_32x32x16_bf16 v[192:207], a[216:219], v[96:99], v[192:207]
    ds_read_b64_tr_b16 a[216:217], v11 offset:16384
    ds_read_b64_tr_b16 a[218:219], v11 offset:18432
    v_add_f32 v31, v31, v109
    v_and_b32 v120, -2, v120
    v_cvt_pk_bf16_f32 v90, v108, v109
    v_exp_f32 v104, v48
    v_and_b32 v122, -2, v122
    v_accvgpr_write_b32 a96, v120
    v_mfma_f32_32x32x16_bf16 v[56:71], v[240:243], v[144:147], v[56:71]
    s_branch K1_TJ6
K1_TP6:
    s_setpc_b64 s[30:31]
K1_TJ6:
    ds_read_b128 v[240:243], v5 offset:32768
    buffer_load_dwordx4 v21, s[16:19], s27 offen offset:2048 nt lds
    v_add_f32 v30, v30, v110
    v_exp_f32 v105, v49
    v_accvgpr_write_b32 a97, v121
    v_accvgpr_write_b32 a98, v122
    v_accvgpr_write_b32 a99, v123
    v_mfma_f32_32x32x16_bf16 v[208:223], a[220:223], v[96:99], v[208:223]
    ds_read_b64_tr_b16 a[220:221], v12 offset:16384
    ds_read_b64_tr_b16 a[222:223], v12 offset:18432
    buffer_load_dwordx4 v21, s[16:19], s27 offen offset:3072 nt lds
    v_add_f32 v31, v31, v111
    v_cvt_pk_bf16_f32 v91, v110, v111
    v_accvgpr_read_b32 v120, a184
    v_accvgpr_read_b32 v121, a185
    v_accvgpr_read_b32 v122, a186
    v_mfma_f32_32x32x16_bf16 v[56:71], v[244:247], v[148:151], v[56:71]
    ds_read_b128 v[244:247], v6 offset:32768
    v_exp_f32 v106, v50
    v_add_f32 v30, v30, v104
    v_exp_f32 v107, v51
    v_accvgpr_read_b32 v123, a187
    v_accvgpr_read_b32 v124, a188
    v_add_f32 v31, v31, v105
    v_mfma_f32_32x32x16_bf16 v[160:175], a[224:227], v[100:103], v[160:175]
    ds_read_b64_tr_b16 a[224:225], v9 offset:20480
    s_add_u32 s95, s96, 0
    s_and_b32 s95, s95, 3
    s_mul_i32 s27, s95, 294912
    s_add_u32 s27, s27, 73728
    s_add_u32 m0, s24, 131072
    v_accvgpr_read_b32 v125, a189
    v_cvt_pk_bf16_f32 v92, v104, v105
    v_accvgpr_read_b32 v126, a190
    v_mfma_f32_32x32x16_bf16 v[56:71], v[248:251], v[152:155], v[56:71]
    ds_read_b64_tr_b16 a[226:227], v9 offset:22528
    v_exp_f32 v108, v52
    v_accvgpr_read_b32 v127, a191
    v_add_f32 v30, v30, v106
    v_exp_f32 v109, v53
    v_pk_mul_f32 v[120:121], v[120:121], v[26:27] op_sel_hi:[1,0]
    v_pk_mul_f32 v[122:123], v[122:123], v[26:27] op_sel_hi:[1,0]
    v_mfma_f32_32x32x16_bf16 v[176:191], a[228:231], v[100:103], v[176:191]
    ds_read_b128 v[248:251], v7 offset:32768
    buffer_load_dwordx4 v22, s[4:7], s27 offen offset:0  lds
    v_add_f32 v31, v31, v107
    v_pk_mul_f32 v[124:125], v[124:125], v[26:27] op_sel_hi:[1,0]
    v_cvt_pk_bf16_f32 v93, v106, v107
    v_exp_f32 v110, v54
    v_pk_mul_f32 v[126:127], v[126:127], v[26:27] op_sel_hi:[1,0]
    v_mfma_f32_32x32x16_bf16 v[56:71], v[252:255], v[156:159], v[56:71]
    ds_read_b64_tr_b16 a[228:229], v10 offset:20480
    ds_read_b64_tr_b16 a[230:231], v10 offset:22528
    buffer_load_dwordx4 v23, s[4:7], s27 offen offset:1024  lds
    v_cvt_pk_bf16_f32 v120, v120, v121
    v_add_f32 v30, v30, v108
    v_exp_f32 v111, v55
    v_cvt_pk_bf16_f32 v121, v122, v123
    v_mfma_f32_32x32x16_bf16 v[192:207], a[232:235], v[100:103], v[192:207]
    ds_read_b128 v[252:255], v8 offset:32768
    buffer_load_dwordx4 v24, s[4:7], s27 offen offset:2048  lds
    v_cvt_pk_bf16_f32 v122, v124, v125
    v_cvt_pk_bf16_f32 v123, v126, v127
    v_add_f32 v31, v31, v109
    v_cvt_pk_bf16_f32 v94, v108, v109
    v_and_b32 v120, -2, v120
    v_add_f32 v30, v30, v110
    v_mfma_f32_32x32x16_bf16 v[208:223], a[236:239], v[100:103], v[208:223]
    ds_read_b64_tr_b16 a[232:233], v11 offset:20480
    ds_read_b64_tr_b16 a[234:235], v11 offset:22528
    ds_read_b64_tr_b16 a[236:237], v12 offset:20480
    ds_read_b64_tr_b16 a[238:239], v12 offset:22528
    buffer_load_dwordx4 v25, s[4:7], s27 offen offset:3072  lds
    v_and_b32 v122, -2, v122
    v_add_f32 v31, v31, v111
    v_accvgpr_write_b32 a100, v120
    v_cvt_pk_bf16_f32 v95, v110, v111
    v_add_f32 v30, v30, v31
    v_accvgpr_write_b32 a101, v121
    v_cmp_nge_f32 vcc, s28, v30
    s_cbranch_vccnz K1_STUB_18
K1_BACK_18:
    v_accvgpr_write_b32 a102, v122
    v_accvgpr_write_b32 a103, v123
    v_add_f32 v29, v29, v30
    s_waitcnt lgkmcnt(14)
    v_mfma_f32_32x32x16_bf16 v[40:55], v[224:227], v[128:131], v[72:87]
    ds_read_b128 v[224:227], v1 offset:40960
    s_add_u32 m0, s24, 16384
    v_exp_f32 v104, v56
    v_exp_f32 v105, v57
    v_accvgpr_read_b32 v120, a192
    v_accvgpr_read_b32 v121, a193
    v_mfma_f32_32x32x16_bf16 v[40:55], v[228:231], v[132:135], v[40:55]
    ds_read_b128 v[228:231], v2 offset:40960
    v_exp_f32 v106, v58
    v_exp_f32 v107, v59
    v_accvgpr_read_b32 v122, a194
    v_accvgpr_read_b32 v123, a195
    v_accvgpr_read_b32 v124, a196
    v_accvgpr_read_b32 v125, a197
    v_mfma_f32_32x32x16_bf16 v[160:175], a[208:211], v[88:91], v[160:175]
    ds_read_b64_tr_b16 a[208:209], v9 offset:24576
    ds_read_b64_tr_b16 a[210:211], v9 offset:26624
    s_mov_b32 s27, 212992
    v_cvt_pk_bf16_f32 v96, v104, v105
    v_exp_f32 v108, v60
    v_accvgpr_read_b32 v126, a198
    v_accvgpr_read_b32 v127, a199
    v_mfma_f32_32x32x16_bf16 v[40:55], v[232:235], v[136:139], v[40:55]
    ds_read_b128 v[232:235], v3 offset:40960
    v_pk_mul_f32 v[120:121], v[120:121], v[26:27] op_sel_hi:[1,0]
    v_add_f32 v30, v104, v106
    v_exp_f32 v109, v61
    v_pk_mul_f32 v[122:123], v[122:123], v[26:27] op_sel_hi:[1,0]
    v_pk_mul_f32 v[124:125], v[124:125], v[26:27] op_sel_hi:[1,0]
    v_add_f32 v31, v105, v107
    v_pk_mul_f32 v[126:127], v[126:127], v[26:27] op_sel_hi:[1,0]
    v_mfma_f32_32x32x16_bf16 v[176:191], a[212:215], v[88:91], v[176:191]
    ds_read_b64_tr_b16 a[212:213], v10 offset:24576
    ds_read_b64_tr_b16 a[214:215], v10 offset:26624
    buffer_load_dwordx4 v17, s[12:15], s27 offen offset:0 nt lds
    v_cvt_pk_bf16_f32 v97, v106, v107
    v_exp_f32 v110, v62
    v_cvt_pk_bf16_f32 v120, v120, v121
    v_mfma_f32_32x32x16_bf16 v[40:55], v[236:239], v[140:143], v[40:55]
    ds_read_b128 v[236:239], v4 offset:40960
    v_cvt_pk_bf16_f32 v121, v122, v123
    v_add_f32 v30, v30, v108
    v_exp_f32 v111, v63
    v_cvt_pk_bf16_f32 v122, v124, v125
    v_cvt_pk_bf16_f32 v123, v126, v127
    v_add_f32 v31, v31, v109
    v_and_b32 v120, -2, v120
    v_mfma_f32_32x32x16_bf16 v[192:207], a[216:219], v[88:91], v[192:207]
    ds_read_b64_tr_b16 a[216:217], v11 offset:24576
    ds_read_b64_tr_b16 a[218:219], v11 offset:26624
    v_cvt_pk_bf16_f32 v98, v108, v109
    v_exp_f32 v104, v64
    v_and_b32 v122, -2, v122
    v_accvgpr_write_b32 a104, v120
    v_add_f32 v30, v30, v110
    s_waitcnt lgkmcnt(14)
    v_mfma_f32_32x32x16_bf16 v[40:55], v[240:243], v[144:147], v[40:55]
    ds_read_b128 v[240:243], v5 offset:40960
    buffer_load_dwordx4 v18, s[12:15], s27 offen offset:1024 nt lds
    v_exp_f32 v105, v65
    v_accvgpr_write_b32 a105, v121
    v_accvgpr_write_b32 a106, v122
    v_accvgpr_write_b32 a107, v123
    v_add_f32 v31, v31, v111
    v_mfma_f32_32x32x16_bf16 v[208:223], a[220:223], v[88:91], v[208:223]
    ds_read_b64_tr_b16 a[220:221], v12 offset:24576
    ds_read_b64_tr_b16 a[222:223], v12 offset:26624
    v_cvt_pk_bf16_f32 v99, v110, v111
    v_exp_f32 v106, v66
    v_accvgpr_read_b32 v120, a200
    v_accvgpr_read_b32 v121, a201
    v_accvgpr_read_b32 v122, a202
    v_mfma_f32_32x32x16_bf16 v[40:55], v[244:247], v[148:151], v[40:55]
    ds_read_b128 v[244:247], v6 offset:40960
    v_add_f32 v30, v30, v104
    v_exp_f32 v107, v67
    v_accvgpr_read_b32 v123, a203
    v_accvgpr_read_b32 v124, a204
    v_add_f32 v31, v31, v105
    v_accvgpr_read_b32 v125, a205
    v_cvt_pk_bf16_f32 v100, v104, v105
    v_mfma_f32_32x32x16_bf16 v[160:175], a[224:227], v[92:95], v[160:175]
    ds_read_b64_tr_b16 a[224:225], v9 offset:28672
    ds_read_b64_tr_b16 a[226:227], v9 offset:30720
    v_exp_f32 v108, v68
    v_accvgpr_read_b32 v126, a206
    v_accvgpr_read_b32 v127, a207
    v_add_f32 v30, v30, v106
    v_pk_mul_f32 v[120:121], v[120:121], v[26:27] op_sel_hi:[1,0]
    v_mfma_f32_32x32x16_bf16 v[40:55], v[248:251], v[152:155], v[40:55]
    ds_read_b128 v[248:251], v7 offset:40960
    buffer_load_dwordx4 v19, s[12:15], s27 offen offset:2048 nt lds
    v_exp_f32 v109, v69
    v_pk_mul_f32 v[122:123], v[122:123], v[26:27] op_sel_hi:[1,0]
    v_add_f32 v31, v31, v107
    v_pk_mul_f32 v[124:125], v[124:125], v[26:27] op_sel_hi:[1,0]
    v_cvt_pk_bf16_f32 v101, v106, v107
    v_mfma_f32_32x32x16_bf16 v[176:191], a[228:231], v[92:95], v[176:191]
    ds_read_b64_tr_b16 a[228:229], v10 offset:28672
    ds_read_b64_tr_b16 a[230:231], v10 offset:30720
    v_exp_f32 v110, v70
    v_pk_mul_f32 v[126:127], v[126:127], v[26:27] op_sel_hi:[1,0]
    v_cvt_pk_bf16_f32 v120, v120, v121
    v_add_f32 v30, v30, v108
    v_cvt_pk_bf16_f32 v121, v122, v123
    v_mfma_f32_32x32x16_bf16 v[40:55], v[252:255], v[156:159], v[40:55]
    ds_read_b128 v[252:255], v8 offset:40960
    v_exp_f32 v111, v71
    v_cvt_pk_bf16_f32 v122, v124, v125
    v_cvt_pk_bf16_f32 v123, v126, v127
    v_add_f32 v31, v31, v109
    v_cvt_pk_bf16_f32 v102, v108, v109
    v_and_b32 v120, -2, v120
    v_add_f32 v30, v30, v110
    s_waitcnt lgkmcnt(14)
    v_mfma_f32_32x32x16_bf16 v[192:207], a[232:235], v[92:95], v[192:207]
    ds_read_b64_tr_b16 a[232:233], v11 offset:28672
    ds_read_b64_tr_b16 a[234:235], v11 offset:30720
    buffer_load_dwordx4 v20, s[12:15], s27 offen offset:3072 nt lds
    v_and_b32 v122, -2, v122
    v_add_f32 v31, v31, v111
    v_accvgpr_write_b32 a108, v120
    v_cvt_pk_bf16_f32 v103, v110, v111
    v_mfma_f32_32x32x16_bf16 v[208:223], a[236:239], v[92:95], v[208:223]
    ds_read_b64_tr_b16 a[236:237], v12 offset:28672
    ds_read_b64_tr_b16 a[238:239], v12 offset:30720
    v_add_f32 v30, v30, v31
    v_accvgpr_write_b32 a109, v121
    v_cmp_nge_f32 vcc, s28, v30
    s_cbranch_vccnz K1_STUB_19
K1_BACK_19:
    v_accvgpr_write_b32 a110, v122
    v_accvgpr_write_b32 a111, v123
    v_add_f32 v29, v29, v30
    v_mfma_f32_32x32x16_bf16 v[56:71], v[224:227], v[128:131], v[72:87]
    v_exp_f32 v104, v40
    v_exp_f32 v105, v41
    v_exp_f32 v106, v42
    v_mfma_f32_32x32x16_bf16 v[56:71], v[228:231], v[132:135], v[56:71]
    v_exp_f32 v107, v43
    v_cvt_pk_bf16_f32 v88, v104, v105
    v_mfma_f32_32x32x16_bf16 v[160:175], a[208:211], v[96:99], v[160:175]
    s_waitcnt lgkmcnt(0)
    s_waitcnt vmcnt(4)
    s_barrier
    ds_read_b128 v[224:227], v1 offset:49152
    ds_read_b128 v[228:231], v2 offset:49152
    ds_read_b64_tr_b16 a[208:209], v9 offset:32768
    ds_read_b64_tr_b16 a[210:211], v9 offset:34816
    v_mfma_f32_32x32x16_bf16 v[56:71], v[232:235], v[136:139], v[56:71]
    ds_read_b64_tr_b16 a[240:241], v13 offset:16384
    ds_read_b64_tr_b16 a[242:243], v13 offset:17408
    ds_read_b64_tr_b16 a[244:245], v14 offset:16384
    ds_read_b64_tr_b16 a[246:247], v14 offset:17408
    ds_read_b64_tr_b16 a[248:249], v15 offset:16384
    ds_read_b64_tr_b16 a[250:251], v15 offset:17408
    v_mfma_f32_32x32x16_bf16 v[176:191], a[212:215], v[96:99], v[176:191]
    ds_read_b64_tr_b16 a[252:253], v16 offset:16384
    ds_read_b64_tr_b16 a[254:255], v16 offset:17408
    ds_read_b64_tr_b16 v[112:113], v39 offset:49152
    ds_read_b64_tr_b16 v[114:115], v39 offset:49408
    ds_read_b64_tr_b16 v[116:117], v13 offset:20480
    ds_read_b64_tr_b16 v[118:119], v13 offset:21504
    v_mfma_f32_32x32x16_bf16 v[56:71], v[236:239], v[140:143], v[56:71]
    ds_read_b64_tr_b16 v[120:121], v14 offset:20480
    ds_read_b64_tr_b16 v[122:123], v14 offset:21504
    ds_read_b64_tr_b16 v[124:125], v15 offset:20480
    ds_read_b64_tr_b16 v[126:127], v15 offset:21504
    v_exp_f32 v108, v44
    v_mfma_f32_32x32x16_bf16 v[192:207], a[216:219], v[96:99], v[192:207]
    ds_read_b128 v[232:235], v3 offset:49152
    ds_read_b64_tr_b16 a[212:213], v10 offset:32768
    s_add_u32 m0, s24, 65536
    v_add_f32 v30, v104, v106
    v_exp_f32 v109, v45
    v_mfma_f32_32x32x16_bf16 v[56:71], v[240:243], v[144:147], v[56:71]
    ds_read_b64_tr_b16 a[214:215], v10 offset:34816
    ds_read_b128 v[236:239], v4 offset:49152
    ds_read_b64_tr_b16 a[216:217], v11 offset:32768
    s_mov_b32 s27, 196608
    v_add_f32 v31, v105, v107
    v_cvt_pk_bf16_f32 v89, v106, v107
    s_waitcnt lgkmcnt(14)
    v_mfma_f32_32x32x16_bf16 a[0:15], a[240:243], a[80:83], 0
    ds_read_b64_tr_b16 a[218:219], v11 offset:34816
    v_exp_f32 v110, v46
    v_add_f32 v30, v30, v108
    v_exp_f32 v111, v47
    v_mfma_f32_32x32x16_bf16 v[208:223], a[220:223], v[96:99], v[208:223]
    ds_read_b128 v[240:243], v5 offset:49152
    ds_read_b64_tr_b16 a[240:241], v16 offset:20480
    buffer_load_dwordx4 v21, s[16:19], s27 offen offset:0 nt lds
    v_add_f32 v31, v31, v109
    v_cvt_pk_bf16_f32 v90, v108, v109
    v_mfma_f32_32x32x16_bf16 v[56:71], v[244:247], v[148:151], v[56:71]
    ds_read_b64_tr_b16 a[242:243], v16 offset:21504
    v_exp_f32 v104, v48
    v_add_f32 v30, v30, v110
    v_exp_f32 v105, v49
    v_mfma_f32_32x32x16_bf16 v[160:175], a[224:227], v[100:103], v[160:175]
    ds_read_b64_tr_b16 a[220:221], v12 offset:32768
    ds_read_b64_tr_b16 a[222:223], v12 offset:34816
    ds_read_b128 v[244:247], v6 offset:49152
    ds_read_b64_tr_b16 a[224:225], v9 offset:36864
    v_add_f32 v31, v31, v111
    v_cvt_pk_bf16_f32 v91, v110, v111
    v_mfma_f32_32x32x16_bf16 a[16:31], a[244:247], a[80:83], 0
    ds_read_b64_tr_b16 a[226:227], v9 offset:38912
    buffer_load_dwordx4 v21, s[16:19], s27 offen offset:1024 nt lds
    v_exp_f32 v106, v50
    v_add_f32 v30, v30, v104
    v_mfma_f32_32x32x16_bf16 v[56:71], v[248:251], v[152:155], v[56:71]
    ds_read_b64_tr_b16 a[244:245], v39 offset:50176
    ds_read_b64_tr_b16 a[246:247], v39 offset:50432
    v_exp_f32 v107, v51
    v_add_f32 v31, v31, v105
    v_cvt_pk_bf16_f32 v92, v104, v105
    v_mfma_f32_32x32x16_bf16 v[176:191], a[228:231], v[100:103], v[176:191]
    ds_read_b128 v[248:251], v7 offset:49152
    v_exp_f32 v108, v52
    v_add_f32 v30, v30, v106
    v_exp_f32 v109, v53
    v_mfma_f32_32x32x16_bf16 v[56:71], v[252:255], v[156:159], v[56:71]
    ds_read_b64_tr_b16 a[228:229], v10 offset:36864
    ds_read_b64_tr_b16 a[230:231], v10 offset:38912
    buffer_load_dwordx4 v21, s[16:19], s27 offen offset:2048 nt lds
    v_add_f32 v31, v31, v107
    v_cvt_pk_bf16_f32 v93, v106, v107
    v_mfma_f32_32x32x16_bf16 a[32:47], a[248:251], a[80:83], 0
    ds_read_b128 v[252:255], v8 offset:49152
    ds_read_b64_tr_b16 a[248:249], v13 offset:24576
    ds_read_b64_tr_b16 a[250:251], v13 offset:25600
    v_exp_f32 v110, v54
    v_add_f32 v30, v30, v108
    v_mfma_f32_32x32x16_bf16 v[192:207], a[232:235], v[100:103], v[192:207]
    ds_read_b64_tr_b16 a[232:233], v11 offset:36864
    ds_read_b64_tr_b16 a[234:235], v11 offset:38912
    v_exp_f32 v111, v55
    v_add_f32 v31, v31, v109
    v_cvt_pk_bf16_f32 v94, v108, v109
    v_mfma_f32_32x32x16_bf16 v[208:223], a[236:239], v[100:103], v[208:223]
    ds_read_b64_tr_b16 a[236:237], v12 offset:36864
    buffer_load_dwordx4 v21, s[16:19], s27 offen offset:3072 nt lds
    v_add_f32 v30, v30, v110
    v_add_f32 v31, v31, v111
    v_cvt_pk_bf16_f32 v95, v110, v111
    s_waitcnt lgkmcnt(14)
    v_mfma_f32_32x32x16_bf16 a[48:63], a[252:255], a[80:83], 0
    ds_read_b64_tr_b16 a[238:239], v12 offset:38912
    ds_read_b64_tr_b16 a[252:253], v14 offset:24576
    ds_read_b64_tr_b16 a[254:255], v14 offset:25600
    v_add_f32 v30, v30, v31
    v_cmp_nge_f32 vcc, s28, v30
    s_cbranch_vccnz K1_STUB_20
K1_BACK_20:
    v_add_f32 v29, v29, v30
    v_mfma_f32_32x32x16_bf16 v[40:55], v[224:227], v[128:131], v[72:87]
    ds_read_b128 v[224:227], v1 offset:57344
    s_add_u32 m0, s24, 32768
    v_exp_f32 v104, v56
    v_exp_f32 v105, v57
    v_mfma_f32_32x32x16_bf16 v[40:55], v[228:231], v[132:135], v[40:55]
    ds_read_b128 v[228:231], v2 offset:57344
    s_mov_b32 s27, 229376
    v_exp_f32 v106, v58
    v_mfma_f32_32x32x16_bf16 a[64:79], v[112:115], a[80:83], 0
    ds_read_b64_tr_b16 v[112:113], v15 offset:24576
    ds_read_b64_tr_b16 v[114:115], v15 offset:25600
    s_waitcnt vmcnt(4)
    buffer_load_dwordx4 v17, s[12:15], s27 offen offset:0 nt lds
    v_exp_f32 v107, v59
    v_mfma_f32_32x32x16_bf16 v[160:175], a[208:211], v[88:91], v[160:175]
    ds_read_b64_tr_b16 a[208:209], v9 offset:40960
    ds_read_b64_tr_b16 a[210:211], v9 offset:43008
    v_cvt_pk_bf16_f32 v96, v104, v105
    v_exp_f32 v108, v60
    v_mfma_f32_32x32x16_bf16 v[40:55], v[232:235], v[136:139], v[40:55]
    ds_read_b128 v[232:235], v3 offset:57344
    s_waitcnt vmcnt(4)
    buffer_load_dwordx4 v18, s[12:15], s27 offen offset:1024 nt lds
    v_add_f32 v30, v104, v106
    v_exp_f32 v109, v61
    v_mfma_f32_32x32x16_bf16 a[0:15], v[116:119], a[84:87], a[0:15]
    ds_read_b64_tr_b16 v[116:117], v16 offset:24576
    ds_read_b64_tr_b16 v[118:119], v16 offset:25600
    v_add_f32 v31, v105, v107
    v_cvt_pk_bf16_f32 v97, v106, v107
    v_mfma_f32_32x32x16_bf16 v[176:191], a[212:215], v[88:91], v[176:191]
    ds_read_b64_tr_b16 a[212:213], v10 offset:40960
    ds_read_b64_tr_b16 a[214:215], v10 offset:43008
    v_exp_f32 v110, v62
    v_mfma_f32_32x32x16_bf16 a[16:31], v[120:123], a[84:87], a[16:31]
    ds_read_b64_tr_b16 v[120:121], v39 offset:51200
    ds_read_b64_tr_b16 v[122:123], v39 offset:51456
    s_waitcnt vmcnt(4)
    buffer_load_dwordx4 v19, s[12:15], s27 offen offset:2048 nt lds
    v_add_f32 v30, v30, v108
    v_mfma_f32_32x32x16_bf16 v[40:55], v[236:239], v[140:143], v[40:55]
    ds_read_b128 v[236:239], v4 offset:57344
    v_exp_f32 v111, v63
    v_add_f32 v31, v31, v109
    v_mfma_f32_32x32x16_bf16 v[192:207], a[216:219], v[88:91], v[192:207]
    ds_read_b64_tr_b16 a[216:217], v11 offset:40960
    ds_read_b64_tr_b16 a[218:219], v11 offset:43008
    s_waitcnt vmcnt(4)
    buffer_load_dwordx4 v20, s[12:15], s27 offen offset:3072 nt lds
    v_cvt_pk_bf16_f32 v98, v108, v109
    v_mfma_f32_32x32x16_bf16 a[32:47], v[124:127], a[84:87], a[32:47]
    ds_read_b64_tr_b16 v[124:125], v13 offset:28672
    ds_read_b64_tr_b16 v[126:127], v13 offset:29696
    v_exp_f32 v104, v64
    v_add_f32 v30, v30, v110
    v_mfma_f32_32x32x16_bf16 v[40:55], v[240:243], v[144:147], v[40:55]
    ds_read_b128 v[240:243], v5 offset:57344
    v_exp_f32 v105, v65
    v_add_f32 v31, v31, v111
    v_mfma_f32_32x32x16_bf16 a[48:63], a[240:243], a[84:87], a[48:63]
    ds_read_b64_tr_b16 a[240:241], v14 offset:28672
    ds_read_b64_tr_b16 a[242:243], v14 offset:29696
    v_cvt_pk_bf16_f32 v99, v110, v111
    v_exp_f32 v106, v66
    v_mfma_f32_32x32x16_bf16 v[208:223], a[220:223], v[88:91], v[208:223]
    ds_read_b64_tr_b16 a[220:221], v12 offset:40960
    ds_read_b64_tr_b16 a[222:223], v12 offset:43008
    v_add_f32 v30, v30, v104
    s_waitcnt lgkmcnt(14)
    v_mfma_f32_32x32x16_bf16 v[40:55], v[244:247], v[148:151], v[40:55]
    ds_read_b128 v[244:247], v6 offset:57344
    v_exp_f32 v107, v67
    v_add_f32 v31, v31, v105
    v_mfma_f32_32x32x16_bf16 a[64:79], a[244:247], a[84:87], a[64:79]
    s_mov_b32 s34, 0
    buffer_store_dwordx4 a[80:83], v0, s[20:23], s34 offen offset:0 sc1
    v_mfma_f32_32x32x16_bf16 v[160:175], a[224:227], v[92:95], v[160:175]
    ds_read_b64_tr_b16 a[244:245], v15 offset:28672
    ds_read_b64_tr_b16 a[246:247], v15 offset:29696
    ds_read_b64_tr_b16 a[224:225], v9 offset:45056
    ds_read_b64_tr_b16 a[226:227], v9 offset:47104
    v_cvt_pk_bf16_f32 v100, v104, v105
    v_mfma_f32_32x32x16_bf16 v[40:55], v[248:251], v[152:155], v[40:55]
    ds_read_b128 v[248:251], v7 offset:57344
    v_exp_f32 v108, v68
    v_add_f32 v30, v30, v106
    v_exp_f32 v109, v69
    v_mfma_f32_32x32x16_bf16 a[0:15], a[248:251], a[88:91], a[0:15]
    ds_read_b64_tr_b16 a[248:249], v16 offset:28672
    ds_read_b64_tr_b16 a[250:251], v16 offset:29696
    v_add_f32 v31, v31, v107
    v_cvt_pk_bf16_f32 v101, v106, v107
    v_mfma_f32_32x32x16_bf16 v[176:191], a[228:231], v[92:95], v[176:191]
    ds_read_b64_tr_b16 a[228:229], v10 offset:45056
    ds_read_b64_tr_b16 a[230:231], v10 offset:47104
    v_exp_f32 v110, v70
    v_add_f32 v30, v30, v108
    v_mfma_f32_32x32x16_bf16 a[16:31], a[252:255], a[88:91], a[16:31]
    ds_read_b64_tr_b16 a[252:253], v39 offset:52224
    ds_read_b64_tr_b16 a[254:255], v39 offset:52480
    v_exp_f32 v111, v71
    v_mfma_f32_32x32x16_bf16 v[40:55], v[252:255], v[156:159], v[40:55]
    ds_read_b128 v[252:255], v8 offset:57344
    v_add_f32 v31, v31, v109
    v_cvt_pk_bf16_f32 v102, v108, v109
    v_mfma_f32_32x32x16_bf16 v[192:207], a[232:235], v[92:95], v[192:207]
    s_mov_b32 s34, 0
    buffer_store_dwordx4 a[84:87], v0, s[20:23], s34 offen offset:1024 sc1
    v_mfma_f32_32x32x16_bf16 a[32:47], v[112:115], a[88:91], a[32:47]
    ds_read_b64_tr_b16 a[232:233], v11 offset:45056
    ds_read_b64_tr_b16 a[234:235], v11 offset:47104
    ds_read_b64_tr_b16 v[112:113], v13 offset:32768
    ds_read_b64_tr_b16 v[114:115], v13 offset:33792
    v_add_f32 v30, v30, v110
    v_add_f32 v31, v31, v111
    v_mfma_f32_32x32x16_bf16 v[208:223], a[236:239], v[92:95], v[208:223]
    ds_read_b64_tr_b16 a[236:237], v12 offset:45056
    ds_read_b64_tr_b16 a[238:239], v12 offset:47104
    v_cvt_pk_bf16_f32 v103, v110, v111
    v_add_f32 v30, v30, v31
    v_cmp_nge_f32 vcc, s28, v30
    s_cbranch_vccnz K1_STUB_21
K1_BACK_21:
    v_mfma_f32_32x32x16_bf16 a[48:63], v[116:119], a[88:91], a[48:63]
    ds_read_b64_tr_b16 v[116:117], v14 offset:32768
    ds_read_b64_tr_b16 v[118:119], v14 offset:33792
    v_add_f32 v29, v29, v30
    v_mfma_f32_32x32x16_bf16 v[56:71], v[224:227], v[128:131], v[72:87]
    v_exp_f32 v104, v40
    v_exp_f32 v105, v41
    v_mfma_f32_32x32x16_bf16 v[56:71], v[228:231], v[132:135], v[56:71]
    v_exp_f32 v106, v42
    s_waitcnt lgkmcnt(14)
    v_mfma_f32_32x32x16_bf16 a[64:79], v[120:123], a[88:91], a[64:79]
    s_waitcnt lgkmcnt(0)
    s_barrier
    ds_read_b128 v[224:227], v1 offset:0
    ds_read_b128 v[228:231], v2 offset:0
    ds_read_b64_tr_b16 v[120:121], v15 offset:32768
    ds_read_b64_tr_b16 v[122:123], v15 offset:33792
    v_mfma_f32_32x32x16_bf16 v[160:175], a[208:211], v[96:99], v[160:175]
    ds_read_b64_tr_b16 a[208:209], v9 offset:49152
    ds_read_b64_tr_b16 a[210:211], v9 offset:51200
    s_add_u32 m0, s24, 81920
    v_exp_f32 v107, v43
    v_cvt_pk_bf16_f32 v88, v104, v105
    v_mfma_f32_32x32x16_bf16 v[56:71], v[232:235], v[136:139], v[56:71]
    ds_read_b128 v[232:235], v3 offset:0
    s_mov_b32 s27, 212992
    v_exp_f32 v108, v44
    v_add_f32 v30, v104, v106
    v_mfma_f32_32x32x16_bf16 a[0:15], v[124:127], a[92:95], a[0:15]
    ds_read_b64_tr_b16 v[124:125], v16 offset:32768
    ds_read_b64_tr_b16 v[126:127], v16 offset:33792
    s_waitcnt vmcnt(6)
    buffer_load_dwordx4 v21, s[16:19], s27 offen offset:0 nt lds
    v_exp_f32 v109, v45
    v_mfma_f32_32x32x16_bf16 v[176:191], a[212:215], v[96:99], v[176:191]
    ds_read_b64_tr_b16 a[212:213], v10 offset:49152
    ds_read_b64_tr_b16 a[214:215], v10 offset:51200
    v_add_f32 v31, v105, v107
    v_cvt_pk_bf16_f32 v89, v106, v107
    v_exp_f32 v110, v46
    v_mfma_f32_32x32x16_bf16 a[16:31], a[240:243], a[92:95], a[16:31]
    ds_read_b64_tr_b16 a[240:241], v39 offset:53248
    ds_read_b64_tr_b16 a[242:243], v39 offset:53504
    s_waitcnt vmcnt(6)
    buffer_load_dwordx4 v21, s[16:19], s27 offen offset:1024 nt lds
    v_add_f32 v30, v30, v108
    v_mfma_f32_32x32x16_bf16 v[56:71], v[236:239], v[140:143], v[56:71]
    ds_read_b128 v[236:239], v4 offset:0
    v_exp_f32 v111, v47
    v_add_f32 v31, v31, v109
    v_mfma_f32_32x32x16_bf16 v[192:207], a[216:219], v[96:99], v[192:207]
    ds_read_b64_tr_b16 a[216:217], v11 offset:49152
    ds_read_b64_tr_b16 a[218:219], v11 offset:51200
    s_waitcnt vmcnt(6)
    buffer_load_dwordx4 v21, s[16:19], s27 offen offset:2048 nt lds
    v_cvt_pk_bf16_f32 v90, v108, v109
    v_mfma_f32_32x32x16_bf16 a[32:47], a[244:247], a[92:95], a[32:47]
    ds_read_b64_tr_b16 a[244:245], v13 offset:36864
    ds_read_b64_tr_b16 a[246:247], v13 offset:37888
    v_exp_f32 v104, v48
    v_add_f32 v30, v30, v110
    v_mfma_f32_32x32x16_bf16 v[56:71], v[240:243], v[144:147], v[56:71]
    ds_read_b128 v[240:243], v5 offset:0
    s_waitcnt vmcnt(6)
    buffer_load_dwordx4 v21, s[16:19], s27 offen offset:3072 nt lds
    v_exp_f32 v105, v49
    v_add_f32 v31, v31, v111
    v_mfma_f32_32x32x16_bf16 a[48:63], a[248:251], a[92:95], a[48:63]
    ds_read_b64_tr_b16 a[248:249], v14 offset:36864
    ds_read_b64_tr_b16 a[250:251], v14 offset:37888
    v_cvt_pk_bf16_f32 v91, v110, v111
    v_exp_f32 v106, v50
    v_mfma_f32_32x32x16_bf16 v[208:223], a[220:223], v[96:99], v[208:223]
    ds_read_b64_tr_b16 a[220:221], v12 offset:49152
    ds_read_b64_tr_b16 a[222:223], v12 offset:51200
    v_add_f32 v30, v30, v104
    v_mfma_f32_32x32x16_bf16 v[56:71], v[244:247], v[148:151], v[56:71]
    ds_read_b128 v[244:247], v6 offset:0
    v_exp_f32 v107, v51
    v_add_f32 v31, v31, v105
    v_mfma_f32_32x32x16_bf16 a[64:79], a[252:255], a[92:95], a[64:79]
    ds_read_b64_tr_b16 a[252:253], v15 offset:36864
    ds_read_b64_tr_b16 a[254:255], v15 offset:37888
    v_cvt_pk_bf16_f32 v92, v104, v105
    v_mfma_f32_32x32x16_bf16 v[160:175], a[224:227], v[100:103], v[160:175]
    ds_read_b64_tr_b16 a[224:225], v9 offset:53248
    ds_read_b64_tr_b16 a[226:227], v9 offset:55296
    v_exp_f32 v108, v52
    v_add_f32 v30, v30, v106
    v_mfma_f32_32x32x16_bf16 v[56:71], v[248:251], v[152:155], v[56:71]
    s_mov_b32 s34, 0
    buffer_store_dwordx4 a[88:91], v0, s[20:23], s34 offen offset:2048 sc1
    v_mfma_f32_32x32x16_bf16 a[0:15], v[112:115], a[96:99], a[0:15]
    ds_read_b128 v[248:251], v7 offset:0
    ds_read_b64_tr_b16 v[112:113], v16 offset:36864
    ds_read_b64_tr_b16 v[114:115], v16 offset:37888
    v_exp_f32 v109, v53
    v_add_f32 v31, v31, v107
    v_mfma_f32_32x32x16_bf16 v[176:191], a[228:231], v[100:103], v[176:191]
    ds_read_b64_tr_b16 a[228:229], v10 offset:53248
    ds_read_b64_tr_b16 a[230:231], v10 offset:55296
    v_cvt_pk_bf16_f32 v93, v106, v107
    v_exp_f32 v110, v54
    v_add_f32 v30, v30, v108
    v_mfma_f32_32x32x16_bf16 a[16:31], v[116:119], a[96:99], a[16:31]
    ds_read_b64_tr_b16 v[116:117], v39 offset:54272
    ds_read_b64_tr_b16 v[118:119], v39 offset:54528
    v_exp_f32 v111, v55
    v_mfma_f32_32x32x16_bf16 v[56:71], v[252:255], v[156:159], v[56:71]
    ds_read_b128 v[252:255], v8 offset:0
    v_add_f32 v31, v31, v109
    v_cvt_pk_bf16_f32 v94, v108, v109
    v_mfma_f32_32x32x16_bf16 v[192:207], a[232:235], v[100:103], v[192:207]
    ds_read_b64_tr_b16 a[232:233], v11 offset:53248
    ds_read_b64_tr_b16 a[234:235], v11 offset:55296
    v_add_f32 v30, v30, v110
    v_add_f32 v31, v31, v111
    v_cvt_pk_bf16_f32 v95, v110, v111
    s_waitcnt lgkmcnt(14)
    v_mfma_f32_32x32x16_bf16 a[32:47], v[120:123], a[96:99], a[32:47]
    s_mov_b32 s34, 0
    buffer_store_dwordx4 a[92:95], v0, s[20:23], s34 offen offset:3072 sc1
    v_mfma_f32_32x32x16_bf16 v[208:223], a[236:239], v[100:103], v[208:223]
    ds_read_b64_tr_b16 v[120:121], v13 offset:40960
    ds_read_b64_tr_b16 v[122:123], v13 offset:41984
    ds_read_b64_tr_b16 a[236:237], v12 offset:53248
    ds_read_b64_tr_b16 a[238:239], v12 offset:55296
    v_add_f32 v30, v30, v31
    v_cmp_nge_f32 vcc, s28, v30
    v_mfma_f32_32x32x16_bf16 a[48:63], v[124:127], a[96:99], a[48:63]
    ds_read_b64_tr_b16 v[124:125], v14 offset:40960
    ds_read_b64_tr_b16 v[126:127], v14 offset:41984
    s_cbranch_vccnz K1_STUB_22
K1_BACK_22:
    v_add_f32 v29, v29, v30
    v_mfma_f32_32x32x16_bf16 v[40:55], v[224:227], v[128:131], v[72:87]
    ds_read_b128 v[224:227], v1 offset:8192
    s_add_u32 m0, s24, 49152
    v_exp_f32 v104, v56
    v_exp_f32 v105, v57
    v_mfma_f32_32x32x16_bf16 v[40:55], v[228:231], v[132:135], v[40:55]
    ds_read_b128 v[228:231], v2 offset:8192
    s_mov_b32 s27, 245760
    v_exp_f32 v106, v58
    v_mfma_f32_32x32x16_bf16 a[64:79], a[240:243], a[96:99], a[64:79]
    s_branch K1_TJ7
K1_TP7:
    s_setpc_b64 s[30:31]
K1_TJ7:
    ds_read_b64_tr_b16 a[240:241], v15 offset:40960
    ds_read_b64_tr_b16 a[242:243], v15 offset:41984
    s_waitcnt vmcnt(8)
    buffer_load_dwordx4 v17, s[12:15], s27 offen offset:0 nt lds
    v_exp_f32 v107, v59
    v_mfma_f32_32x32x16_bf16 v[160:175], a[208:211], v[88:91], v[160:175]
    ds_read_b64_tr_b16 a[208:209], v9 offset:57344
    ds_read_b64_tr_b16 a[210:211], v9 offset:59392
    v_cvt_pk_bf16_f32 v96, v104, v105
    v_exp_f32 v108, v60
    v_mfma_f32_32x32x16_bf16 v[40:55], v[232:235], v[136:139], v[40:55]
    ds_read_b128 v[232:235], v3 offset:8192
    s_waitcnt vmcnt(6)
    buffer_load_dwordx4 v18, s[12:15], s27 offen offset:1024 nt lds
    v_add_f32 v30, v104, v106
    v_exp_f32 v109, v61
    v_mfma_f32_32x32x16_bf16 a[0:15], a[244:247], a[100:103], a[0:15]
    ds_read_b64_tr_b16 a[244:245], v16 offset:40960
    ds_read_b64_tr_b16 a[246:247], v16 offset:41984
    v_add_f32 v31, v105, v107
    v_cvt_pk_bf16_f32 v97, v106, v107
    v_mfma_f32_32x32x16_bf16 v[176:191], a[212:215], v[88:91], v[176:191]
    ds_read_b64_tr_b16 a[212:213], v10 offset:57344
    ds_read_b64_tr_b16 a[214:215], v10 offset:59392
    v_exp_f32 v110, v62
    v_mfma_f32_32x32x16_bf16 a[16:31], a[248:251], a[100:103], a[16:31]
    ds_read_b64_tr_b16 a[248:249], v39 offset:55296
    ds_read_b64_tr_b16 a[250:251], v39 offset:55552
    s_waitcnt vmcnt(6)
    buffer_load_dwordx4 v19, s[12:15], s27 offen offset:2048 nt lds
    v_add_f32 v30, v30, v108
    v_mfma_f32_32x32x16_bf16 v[40:55], v[236:239], v[140:143], v[40:55]
    ds_read_b128 v[236:239], v4 offset:8192
    v_exp_f32 v111, v63
    v_add_f32 v31, v31, v109
    v_mfma_f32_32x32x16_bf16 v[192:207], a[216:219], v[88:91], v[192:207]
    ds_read_b64_tr_b16 a[216:217], v11 offset:57344
    ds_read_b64_tr_b16 a[218:219], v11 offset:59392
    s_waitcnt vmcnt(6)
    buffer_load_dwordx4 v20, s[12:15], s27 offen offset:3072 nt lds
    v_cvt_pk_bf16_f32 v98, v108, v109
    s_waitcnt lgkmcnt(14)
    v_mfma_f32_32x32x16_bf16 a[32:47], a[252:255], a[100:103], a[32:47]
    ds_read_b64_tr_b16 a[252:253], v13 offset:45056
    ds_read_b64_tr_b16 a[254:255], v13 offset:46080
    v_exp_f32 v104, v64
    v_add_f32 v30, v30, v110
    v_mfma_f32_32x32x16_bf16 v[40:55], v[240:243], v[144:147], v[40:55]
    ds_read_b128 v[240:243], v5 offset:8192
    v_exp_f32 v105, v65
    v_add_f32 v31, v31, v111
    v_mfma_f32_32x32x16_bf16 a[48:63], v[112:115], a[100:103], a[48:63]
    ds_read_b64_tr_b16 v[112:113], v14 offset:45056
    ds_read_b64_tr_b16 v[114:115], v14 offset:46080
    v_cvt_pk_bf16_f32 v99, v110, v111
    v_exp_f32 v106, v66
    v_mfma_f32_32x32x16_bf16 v[208:223], a[220:223], v[88:91], v[208:223]
    ds_read_b64_tr_b16 a[220:221], v12 offset:57344
    ds_read_b64_tr_b16 a[222:223], v12 offset:59392
    v_add_f32 v30, v30, v104
    v_mfma_f32_32x32x16_bf16 v[40:55], v[244:247], v[148:151], v[40:55]
    ds_read_b128 v[244:247], v6 offset:8192
    v_exp_f32 v107, v67
    v_add_f32 v31, v31, v105
    v_mfma_f32_32x32x16_bf16 a[64:79], v[116:119], a[100:103], a[64:79]
    s_mov_b32 s34, 4096
    buffer_store_dwordx4 a[96:99], v0, s[20:23], s34 offen offset:0 sc1
    v_mfma_f32_32x32x16_bf16 v[160:175], a[224:227], v[92:95], v[160:175]
    ds_read_b64_tr_b16 v[116:117], v15 offset:45056
    ds_read_b64_tr_b16 v[118:119], v15 offset:46080
    ds_read_b64_tr_b16 a[224:225], v9 offset:61440
    ds_read_b64_tr_b16 a[226:227], v9 offset:63488
    v_cvt_pk_bf16_f32 v100, v104, v105
    v_mfma_f32_32x32x16_bf16 v[40:55], v[248:251], v[152:155], v[40:55]
    ds_read_b128 v[248:251], v7 offset:8192
    v_exp_f32 v108, v68
    v_add_f32 v30, v30, v106
    v_exp_f32 v109, v69
    v_mfma_f32_32x32x16_bf16 a[0:15], v[120:123], a[104:107], a[0:15]
    ds_read_b64_tr_b16 v[120:121], v16 offset:45056
    ds_read_b64_tr_b16 v[122:123], v16 offset:46080
    v_add_f32 v31, v31, v107
    v_cvt_pk_bf16_f32 v101, v106, v107
    v_mfma_f32_32x32x16_bf16 v[176:191], a[228:231], v[92:95], v[176:191]
    ds_read_b64_tr_b16 a[228:229], v10 offset:61440
    ds_read_b64_tr_b16 a[230:231], v10 offset:63488
    v_exp_f32 v110, v70
    v_add_f32 v30, v30, v108
    v_mfma_f32_32x32x16_bf16 a[16:31], v[124:127], a[104:107], a[16:31]
    ds_read_b64_tr_b16 v[124:125], v39 offset:56320
    ds_read_b64_tr_b16 v[126:127], v39 offset:56576
    v_exp_f32 v111, v71
    v_mfma_f32_32x32x16_bf16 v[40:55], v[252:255], v[156:159], v[40:55]
    ds_read_b128 v[252:255], v8 offset:8192
    v_add_f32 v31, v31, v109
    v_cvt_pk_bf16_f32 v102, v108, v109
    v_mfma_f32_32x32x16_bf16 v[192:207], a[232:235], v[92:95], v[192:207]
    s_mov_b32 s34, 4096
    buffer_store_dwordx4 a[100:103], v0, s[20:23], s34 offen offset:1024 sc1
    s_waitcnt lgkmcnt(14)
    v_mfma_f32_32x32x16_bf16 a[32:47], a[240:243], a[104:107], a[32:47]
    ds_read_b64_tr_b16 a[232:233], v11 offset:61440
    ds_read_b64_tr_b16 a[234:235], v11 offset:63488
    v_add_f32 v30, v30, v110
    v_add_f32 v31, v31, v111
    v_cvt_pk_bf16_f32 v103, v110, v111
    v_add_f32 v30, v30, v31
    v_mfma_f32_32x32x16_bf16 v[208:223], a[236:239], v[92:95], v[208:223]
    ds_read_b64_tr_b16 a[236:237], v12 offset:61440
    ds_read_b64_tr_b16 a[238:239], v12 offset:63488
    v_cmp_nge_f32 vcc, s28, v30
    s_cbranch_vccnz K1_STUB_23
K1_BACK_23:
    v_add_f32 v29, v29, v30
    v_mfma_f32_32x32x16_bf16 a[48:63], a[244:247], a[104:107], a[48:63]
    v_mfma_f32_32x32x16_bf16 v[56:71], v[224:227], v[128:131], v[72:87]
    v_exp_f32 v104, v40
    v_exp_f32 v105, v41
    v_exp_f32 v106, v42
    v_mfma_f32_32x32x16_bf16 v[56:71], v[228:231], v[132:135], v[56:71]
    v_exp_f32 v107, v43
    v_mfma_f32_32x32x16_bf16 v[160:175], a[208:211], v[96:99], v[160:175]
    s_waitcnt lgkmcnt(0)
    s_barrier
    ds_read_b128 v[224:227], v1 offset:16384
    ds_read_b128 v[228:231], v2 offset:16384
    ds_read_b64_tr_b16 a[208:209], v9 offset:16384
    ds_read_b64_tr_b16 a[210:211], v9 offset:18432
    v_mfma_f32_32x32x16_bf16 a[64:79], a[248:251], a[104:107], a[64:79]
    s_add_u32 m0, s24, 98304
    s_mov_b32 s27, 229376
    v_cvt_pk_bf16_f32 v88, v104, v105
    v_exp_f32 v108, v44
    v_add_f32 v30, v104, v106
    v_mfma_f32_32x32x16_bf16 v[56:71], v[232:235], v[136:139], v[56:71]
    ds_read_b128 v[232:235], v3 offset:16384
    s_waitcnt vmcnt(8)
    buffer_load_dwordx4 v21, s[16:19], s27 offen offset:0 nt lds
    v_exp_f32 v109, v45
    v_add_f32 v31, v105, v107
    v_mfma_f32_32x32x16_bf16 v[176:191], a[212:215], v[96:99], v[176:191]
    ds_read_b64_tr_b16 a[212:213], v10 offset:16384
    ds_read_b64_tr_b16 a[214:215], v10 offset:18432
    s_waitcnt vmcnt(6)
    buffer_load_dwordx4 v21, s[16:19], s27 offen offset:1024 nt lds
    v_cvt_pk_bf16_f32 v89, v106, v107
    v_mfma_f32_32x32x16_bf16 v[56:71], v[236:239], v[140:143], v[56:71]
    ds_read_b128 v[236:239], v4 offset:16384
    s_waitcnt vmcnt(6)
    buffer_load_dwordx4 v21, s[16:19], s27 offen offset:2048 nt lds
    v_exp_f32 v110, v46
    v_add_f32 v30, v30, v108
    v_mfma_f32_32x32x16_bf16 a[0:15], a[252:255], a[108:111], a[0:15]
    s_waitcnt vmcnt(6)
    buffer_load_dwordx4 v21, s[16:19], s27 offen offset:3072 nt lds
    v_exp_f32 v111, v47
    v_add_f32 v31, v31, v109
    v_cvt_pk_bf16_f32 v90, v108, v109
    v_mfma_f32_32x32x16_bf16 v[192:207], a[216:219], v[96:99], v[192:207]
    ds_read_b64_tr_b16 a[216:217], v11 offset:16384
    ds_read_b64_tr_b16 a[218:219], v11 offset:18432
    v_exp_f32 v104, v48
    v_add_f32 v30, v30, v110
    v_mfma_f32_32x32x16_bf16 v[56:71], v[240:243], v[144:147], v[56:71]
    ds_read_b128 v[240:243], v5 offset:16384
    v_exp_f32 v105, v49
    v_add_f32 v31, v31, v111
    v_mfma_f32_32x32x16_bf16 a[16:31], v[112:115], a[108:111], a[16:31]
    s_mov_b32 s34, 4096
    buffer_store_dwordx4 a[104:107], v0, s[20:23], s34 offen offset:2048 sc1
    v_mfma_f32_32x32x16_bf16 v[208:223], a[220:223], v[96:99], v[208:223]
    ds_read_b64_tr_b16 a[220:221], v12 offset:16384
    ds_read_b64_tr_b16 a[222:223], v12 offset:18432
    v_cvt_pk_bf16_f32 v91, v110, v111
    v_exp_f32 v106, v50
    v_add_f32 v30, v30, v104
    v_mfma_f32_32x32x16_bf16 v[56:71], v[244:247], v[148:151], v[56:71]
    ds_read_b128 v[244:247], v6 offset:16384
    v_exp_f32 v107, v51
    v_add_f32 v31, v31, v105
    v_cvt_pk_bf16_f32 v92, v104, v105
    v_mfma_f32_32x32x16_bf16 v[160:175], a[224:227], v[100:103], v[160:175]
    s_mov_b32 s34, 4096
    buffer_store_dwordx4 a[108:111], v0, s[20:23], s34 offen offset:3072 sc1
    v_mfma_f32_32x32x16_bf16 a[32:47], v[116:119], a[108:111], a[32:47]
    ds_read_b64_tr_b16 a[224:225], v9 offset:20480
    ds_read_b64_tr_b16 a[226:227], v9 offset:22528
    v_exp_f32 v108, v52
    v_add_f32 v30, v30, v106
    v_mfma_f32_32x32x16_bf16 v[56:71], v[248:251], v[152:155], v[56:71]
    ds_read_b128 v[248:251], v7 offset:16384
    v_exp_f32 v109, v53
    v_add_f32 v31, v31, v107
    v_cvt_pk_bf16_f32 v93, v106, v107
    v_mfma_f32_32x32x16_bf16 v[176:191], a[228:231], v[100:103], v[176:191]
    ds_read_b64_tr_b16 a[228:229], v10 offset:20480
    s_add_u32 s95, s96, 1
    s_and_b32 s95, s95, 3
    s_mul_i32 s27, s95, 294912
    s_add_u32 s27, s27, 0
    s_add_u32 m0, s24, 114688
    v_mfma_f32_32x32x16_bf16 v[56:71], v[252:255], v[156:159], v[56:71]
    ds_read_b64_tr_b16 a[230:231], v10 offset:22528
    ds_read_b128 v[252:255], v8 offset:16384
    v_exp_f32 v110, v54
    v_add_f32 v30, v30, v108
    v_mfma_f32_32x32x16_bf16 a[48:63], v[120:123], a[108:111], a[48:63]
    buffer_load_dwordx4 v22, s[4:7], s27 offen offset:0  lds
    v_exp_f32 v111, v55
    v_add_f32 v31, v31, v109
    v_cvt_pk_bf16_f32 v94, v108, v109
    v_mfma_f32_32x32x16_bf16 v[192:207], a[232:235], v[100:103], v[192:207]
    ds_read_b64_tr_b16 a[232:233], v11 offset:20480
    ds_read_b64_tr_b16 a[234:235], v11 offset:22528
    buffer_load_dwordx4 v23, s[4:7], s27 offen offset:1024  lds
    v_add_f32 v30, v30, v110
    v_add_f32 v31, v31, v111
    v_mfma_f32_32x32x16_bf16 v[208:223], a[236:239], v[100:103], v[208:223]
    ds_read_b64_tr_b16 a[236:237], v12 offset:20480
    ds_read_b64_tr_b16 a[238:239], v12 offset:22528
    buffer_load_dwordx4 v24, s[4:7], s27 offen offset:2048  lds
    v_cvt_pk_bf16_f32 v95, v110, v111
    v_add_f32 v30, v30, v31
    v_mfma_f32_32x32x16_bf16 a[64:79], v[124:127], a[108:111], a[64:79]
    buffer_load_dwordx4 v25, s[4:7], s27 offen offset:3072  lds
    v_cmp_nge_f32 vcc, s28, v30
    s_cbranch_vccnz K1_STUB_24
K1_BACK_24:
    v_add_f32 v29, v29, v30
    s_waitcnt lgkmcnt(14)
    v_mfma_f32_32x32x16_bf16 v[40:55], v[224:227], v[128:131], v[72:87]
    ds_read_b128 v[224:227], v1 offset:24576
    v_exp_f32 v104, v56
    v_exp_f32 v105, v57
    v_mfma_f32_32x32x16_bf16 v[40:55], v[228:231], v[132:135], v[40:55]
    ds_read_b128 v[228:231], v2 offset:24576
    v_exp_f32 v106, v58
    v_exp_f32 v107, v59
    v_cvt_pk_bf16_f32 v96, v104, v105
    v_mfma_f32_32x32x16_bf16 v[160:175], a[208:211], v[88:91], v[160:175]
    ds_read_b64_tr_b16 a[208:209], v9 offset:24576
    ds_read_b64_tr_b16 a[210:211], v9 offset:26624
    v_exp_f32 v108, v60
    v_add_f32 v30, v104, v106
    v_mfma_f32_32x32x16_bf16 v[40:55], v[232:235], v[136:139], v[40:55]
    ds_read_b128 v[232:235], v3 offset:24576
    v_exp_f32 v109, v61
    v_add_f32 v31, v105, v107
    v_cvt_pk_bf16_f32 v97, v106, v107
    v_mfma_f32_32x32x16_bf16 v[176:191], a[212:215], v[88:91], v[176:191]
    ds_read_b64_tr_b16 a[212:213], v10 offset:24576
    ds_read_b64_tr_b16 a[214:215], v10 offset:26624
    v_exp_f32 v110, v62
    v_add_f32 v30, v30, v108
    v_mfma_f32_32x32x16_bf16 v[40:55], v[236:239], v[140:143], v[40:55]
    ds_read_b128 v[236:239], v4 offset:24576
    v_exp_f32 v111, v63
    v_add_f32 v31, v31, v109
    v_cvt_pk_bf16_f32 v98, v108, v109
    v_mfma_f32_32x32x16_bf16 v[192:207], a[216:219], v[88:91], v[192:207]
    ds_read_b64_tr_b16 a[216:217], v11 offset:24576
    ds_read_b64_tr_b16 a[218:219], v11 offset:26624
    v_exp_f32 v104, v64
    v_add_f32 v30, v30, v110
    s_waitcnt lgkmcnt(14)
    v_mfma_f32_32x32x16_bf16 v[40:55], v[240:243], v[144:147], v[40:55]
    ds_read_b128 v[240:243], v5 offset:24576
    v_exp_f32 v105, v65
    v_add_f32 v31, v31, v111
    v_cvt_pk_bf16_f32 v99, v110, v111
    v_mfma_f32_32x32x16_bf16 v[208:223], a[220:223], v[88:91], v[208:223]
    s_lshl_b32 s95, s96, 4
    s_add_u32 s95, s95, s37
    s_lshl2_add_u32 s95, s95, s35
    s_mul_i32 s27, s95, 4608
    s_add_u32 s27, s27, 147456
    v_and_b32 v28, 0x3f0, v0
    v_min_u32 v28, 560, v28
    v_lshlrev_b32 v28, 3, v28
    buffer_load_dword a143, v28, s[4:7], s27 offen
    v_mfma_f32_32x32x16_bf16 v[40:55], v[244:247], v[148:151], v[40:55]
    ds_read_b64_tr_b16 a[220:221], v12 offset:24576
    ds_read_b64_tr_b16 a[222:223], v12 offset:26624
    ds_read_b128 v[244:247], v6 offset:24576
    v_exp_f32 v106, v66
    v_add_f32 v30, v30, v104
    v_mfma_f32_32x32x16_bf16 v[160:175], a[224:227], v[92:95], v[160:175]
    v_exp_f32 v107, v67
    v_add_f32 v31, v31, v105
    v_cvt_pk_bf16_f32 v100, v104, v105
    v_exp_f32 v108, v68
    v_mfma_f32_32x32x16_bf16 v[40:55], v[248:251], v[152:155], v[40:55]
    ds_read_b64_tr_b16 a[224:225], v9 offset:28672
    ds_read_b64_tr_b16 a[226:227], v9 offset:30720
    ds_read_b128 v[248:251], v7 offset:24576
    v_add_f32 v30, v30, v106
    v_exp_f32 v109, v69
    v_mfma_f32_32x32x16_bf16 v[176:191], a[228:231], v[92:95], v[176:191]
    ds_read_b64_tr_b16 a[228:229], v10 offset:28672
    ds_read_b64_tr_b16 a[230:231], v10 offset:30720
    v_add_f32 v31, v31, v107
    v_cvt_pk_bf16_f32 v101, v106, v107
    v_exp_f32 v110, v70
    v_mfma_f32_32x32x16_bf16 v[40:55], v[252:255], v[156:159], v[40:55]
    ds_read_b128 v[252:255], v8 offset:24576
    v_add_f32 v30, v30, v108
    v_exp_f32 v111, v71
    v_add_f32 v31, v31, v109
    v_cvt_pk_bf16_f32 v102, v108, v109
    s_waitcnt lgkmcnt(14)
    v_mfma_f32_32x32x16_bf16 v[192:207], a[232:235], v[92:95], v[192:207]
    ds_read_b64_tr_b16 a[232:233], v11 offset:28672
    ds_read_b64_tr_b16 a[234:235], v11 offset:30720
    v_add_f32 v30, v30, v110
    v_add_f32 v31, v31, v111
    v_cvt_pk_bf16_f32 v103, v110, v111
    v_add_f32 v30, v30, v31
    v_mfma_f32_32x32x16_bf16 v[208:223], a[236:239], v[92:95], v[208:223]
    ds_read_b64_tr_b16 a[236:237], v12 offset:28672
    ds_read_b64_tr_b16 a[238:239], v12 offset:30720
    v_cmp_nge_f32 vcc, s28, v30
    s_cbranch_vccnz K1_STUB_25
K1_BACK_25:
    v_add_f32 v29, v29, v30
    v_mfma_f32_32x32x16_bf16 v[56:71], v[224:227], v[128:131], v[72:87]
    v_exp_f32 v104, v40
    v_exp_f32 v105, v41
    v_exp_f32 v106, v42
    v_exp_f32 v107, v43
    v_mfma_f32_32x32x16_bf16 v[56:71], v[228:231], v[132:135], v[56:71]
    v_cvt_pk_bf16_f32 v88, v104, v105
    v_exp_f32 v108, v44
    v_mfma_f32_32x32x16_bf16 v[160:175], a[208:211], v[96:99], v[160:175]
    s_waitcnt lgkmcnt(0)
    s_waitcnt vmcnt(1)
    s_barrier
    s_lshl_b32 s94, s97, 8
    s_add_u32 s100, s96, 0
    s_lshl2_add_u32 s94, s100, s94
    s_lshr_b32 s100, s64, s100
    v_mov_b32 v37, s100
    v_lshlrev_b32 v27, 8, v0
    buffer_store_dword v37, v27, s[68:71], s94 offen sc1
    s_and_b32 s94, s96, 1
    s_lshl_b32 s94, s94, 8
    s_add_u32 s94, s94, 1024
    s_and_b32 s100, s96, 2
    s_lshl1_add_u32 s100, s100, s97
    s_lshl2_add_u32 s94, s100, s94
    s_lshr_b32 s100, s65, s100
    v_mov_b32 v37, s100
    v_lshlrev_b32 v27, 8, v0
    buffer_store_dword v37, v27, s[68:71], s94 offen sc1
    v_mfma_f32_32x32x16_bf16 v[56:71], v[232:235], v[136:139], v[56:71]
    ds_read_b128 v[224:227], v1 offset:32768
    ds_read_b128 v[228:231], v2 offset:32768
    ds_read_b64_tr_b16 a[208:209], v9 offset:32768
    ds_read_b64_tr_b16 a[210:211], v9 offset:34816
    ds_read_b64_tr_b16 a[240:241], v13 offset:16384
    ds_read_b64_tr_b16 a[242:243], v13 offset:17408
    ds_read_b64_tr_b16 a[244:245], v14 offset:16384
    ds_read_b64_tr_b16 a[246:247], v14 offset:17408
    ds_read_b64_tr_b16 a[248:249], v15 offset:16384
    v_mfma_f32_32x32x16_bf16 v[176:191], a[212:215], v[96:99], v[176:191]
    ds_read_b64_tr_b16 a[250:251], v15 offset:17408
    ds_read_b64_tr_b16 a[252:253], v16 offset:16384
    ds_read_b64_tr_b16 a[254:255], v16 offset:17408
    ds_read_b64_tr_b16 v[112:113], v39 offset:57344
    ds_read_b64_tr_b16 v[114:115], v39 offset:57600
    ds_read_b64_tr_b16 v[116:117], v13 offset:20480
    ds_read_b64_tr_b16 v[118:119], v13 offset:21504
    ds_read_b64_tr_b16 v[120:121], v14 offset:20480
    ds_read_b64_tr_b16 v[122:123], v14 offset:21504
    ds_read_b64_tr_b16 v[124:125], v15 offset:20480
    v_mfma_f32_32x32x16_bf16 v[56:71], v[236:239], v[140:143], v[56:71]
    ds_read_b64_tr_b16 v[126:127], v15 offset:21504
    ds_read_b128 v[232:235], v3 offset:32768
    s_add_u32 m0, s24, 65536
    s_mov_b32 s27, 245760
    buffer_load_dwordx4 v21, s[16:19], s27 offen offset:0 nt lds
    v_add_f32 v30, v104, v106
    v_exp_f32 v109, v45
    v_add_f32 v31, v105, v107
    v_mfma_f32_32x32x16_bf16 v[192:207], a[216:219], v[96:99], v[192:207]
    ds_read_b64_tr_b16 a[212:213], v10 offset:32768
    ds_read_b64_tr_b16 a[214:215], v10 offset:34816
    ds_read_b128 v[236:239], v4 offset:32768
    ds_read_b64_tr_b16 a[216:217], v11 offset:32768
    buffer_load_dwordx4 v21, s[16:19], s27 offen offset:1024 nt lds
    v_cvt_pk_bf16_f32 v89, v106, v107
    v_exp_f32 v110, v46
    v_add_f32 v30, v30, v108
    v_mfma_f32_32x32x16_bf16 v[56:71], v[240:243], v[144:147], v[56:71]
    ds_read_b64_tr_b16 a[218:219], v11 offset:34816
    ds_read_b128 v[240:243], v5 offset:32768
    buffer_load_dwordx4 v21, s[16:19], s27 offen offset:2048 nt lds
    buffer_load_dwordx4 v21, s[16:19], s27 offen offset:3072 nt lds
    v_exp_f32 v111, v47
    v_add_f32 v31, v31, v109
    v_cvt_pk_bf16_f32 v90, v108, v109
    v_mfma_f32_32x32x16_bf16 v[208:223], a[220:223], v[96:99], v[208:223]
    s_add_u32 s95, s96, 1
    s_and_b32 s95, s95, 3
    s_mul_i32 s27, s95, 294912
    s_add_u32 s27, s27, 73728
    s_add_u32 m0, s24, 131072
    v_exp_f32 v104, v48
    v_add_f32 v30, v30, v110
    v_exp_f32 v105, v49
    v_mfma_f32_32x32x16_bf16 v[56:71], v[244:247], v[148:151], v[56:71]
    ds_read_b64_tr_b16 a[220:221], v12 offset:32768
    ds_read_b64_tr_b16 a[222:223], v12 offset:34816
    ds_read_b128 v[244:247], v6 offset:32768
    buffer_load_dwordx4 v22, s[4:7], s27 offen offset:0  lds
    v_add_f32 v31, v31, v111
    v_cvt_pk_bf16_f32 v91, v110, v111
    v_exp_f32 v106, v50
    v_add_f32 v30, v30, v104
    v_mfma_f32_32x32x16_bf16 v[160:175], a[224:227], v[100:103], v[160:175]
    buffer_load_dwordx4 v23, s[4:7], s27 offen offset:1024  lds
    buffer_load_dwordx4 v24, s[4:7], s27 offen offset:2048  lds
    v_exp_f32 v107, v51
    v_add_f32 v31, v31, v105
    v_cvt_pk_bf16_f32 v92, v104, v105
    v_exp_f32 v108, v52
    v_mfma_f32_32x32x16_bf16 v[56:71], v[248:251], v[152:155], v[56:71]
    ds_read_b64_tr_b16 a[224:225], v9 offset:36864
    ds_read_b64_tr_b16 a[226:227], v9 offset:38912
    ds_read_b128 v[248:251], v7 offset:32768
    buffer_load_dwordx4 v25, s[4:7], s27 offen offset:3072  lds
    v_add_f32 v30, v30, v106
    v_exp_f32 v109, v53
    v_add_f32 v31, v31, v107
    v_mfma_f32_32x32x16_bf16 v[176:191], a[228:231], v[100:103], v[176:191]
    ds_read_b64_tr_b16 a[228:229], v10 offset:36864
    ds_read_b64_tr_b16 a[230:231], v10 offset:38912
    s_add_u32 s95, s96, 2
    s_and_b32 s95, s95, 3
    s_mul_i32 s27, s95, 294912
    s_add_u32 s27, s27, 0
    s_add_u32 m0, s24, 0
    v_cvt_pk_bf16_f32 v93, v106, v107
    v_exp_f32 v110, v54
    v_mfma_f32_32x32x16_bf16 v[56:71], v[252:255], v[156:159], v[56:71]
    ds_read_b128 v[252:255], v8 offset:32768
    buffer_load_dwordx4 v22, s[4:7], s27 offen offset:0  lds
    buffer_load_dwordx4 v23, s[4:7], s27 offen offset:1024  lds
    v_add_f32 v30, v30, v108
    v_exp_f32 v111, v55
    v_add_f32 v31, v31, v109
    v_cvt_pk_bf16_f32 v94, v108, v109
    v_mfma_f32_32x32x16_bf16 v[192:207], a[232:235], v[100:103], v[192:207]
    ds_read_b64_tr_b16 a[232:233], v11 offset:36864
    ds_read_b64_tr_b16 a[234:235], v11 offset:38912
    buffer_load_dwordx4 v24, s[4:7], s27 offen offset:2048  lds
    v_add_f32 v30, v30, v110
    v_add_f32 v31, v31, v111
    v_cvt_pk_bf16_f32 v95, v110, v111
    v_add_f32 v30, v30, v31
    v_cmp_nge_f32 vcc, s28, v30
    v_mfma_f32_32x32x16_bf16 v[208:223], a[236:239], v[100:103], v[208:223]
    ds_read_b64_tr_b16 a[236:237], v12 offset:36864
    ds_read_b64_tr_b16 a[238:239], v12 offset:38912
    s_cbranch_vccnz K1_STUB_26
K1_BACK_26:
    buffer_load_dwordx4 v25, s[4:7], s27 offen offset:3072  lds
    v_add_f32 v29, v29, v30
    s_waitcnt lgkmcnt(14)
    v_mfma_f32_32x32x16_bf16 v[40:55], v[224:227], v[128:131], v[72:87]
    ds_read_b128 v[224:227], v1 offset:40960
    v_exp_f32 v104, v56
    v_exp_f32 v105, v57
    v_mfma_f32_32x32x16_bf16 v[40:55], v[228:231], v[132:135], v[40:55]
    ds_read_b128 v[228:231], v2 offset:40960
    v_exp_f32 v106, v58
    v_exp_f32 v107, v59
    v_cvt_pk_bf16_f32 v96, v104, v105
    v_mfma_f32_32x32x16_bf16 v[160:175], a[208:211], v[88:91], v[160:175]
    ds_read_b64_tr_b16 a[208:209], v9 offset:40960
    ds_read_b64_tr_b16 a[210:211], v9 offset:43008
    v_exp_f32 v108, v60
    v_add_f32 v30, v104, v106
    v_mfma_f32_32x32x16_bf16 v[40:55], v[232:235], v[136:139], v[40:55]
    ds_read_b128 v[232:235], v3 offset:40960
    v_exp_f32 v109, v61
    v_add_f32 v31, v105, v107
    v_cvt_pk_bf16_f32 v97, v106, v107
    v_mfma_f32_32x32x16_bf16 v[176:191], a[212:215], v[88:91], v[176:191]
    ds_read_b64_tr_b16 a[212:213], v10 offset:40960
    ds_read_b64_tr_b16 a[214:215], v10 offset:43008
    v_exp_f32 v110, v62
    v_add_f32 v30, v30, v108
    v_mfma_f32_32x32x16_bf16 v[40:55], v[236:239], v[140:143], v[40:55]
    ds_read_b128 v[236:239], v4 offset:40960
    v_exp_f32 v111, v63
    v_add_f32 v31, v31, v109
    v_cvt_pk_bf16_f32 v98, v108, v109
    v_mfma_f32_32x32x16_bf16 v[192:207], a[216:219], v[88:91], v[192:207]
    ds_read_b64_tr_b16 a[216:217], v11 offset:40960
    ds_read_b64_tr_b16 a[218:219], v11 offset:43008
    v_exp_f32 v104, v64
    v_add_f32 v30, v30, v110
    s_waitcnt lgkmcnt(14)
    v_mfma_f32_32x32x16_bf16 v[40:55], v[240:243], v[144:147], v[40:55]
    ds_read_b128 v[240:243], v5 offset:40960
    s_lshl_b32 s94, s97, 8
    buffer_load_dword v37, v36, s[68:71], s94 offen sc1
    v_exp_f32 v105, v65
    v_add_f32 v31, v31, v111
    v_mfma_f32_32x32x16_bf16 v[208:223], a[220:223], v[88:91], v[208:223]
    ds_read_b64_tr_b16 a[220:221], v12 offset:40960
    ds_read_b64_tr_b16 a[222:223], v12 offset:43008
    v_cvt_pk_bf16_f32 v99, v110, v111
    v_exp_f32 v106, v66
    v_add_f32 v30, v30, v104
    v_mfma_f32_32x32x16_bf16 v[40:55], v[244:247], v[148:151], v[40:55]
    ds_read_b128 v[244:247], v6 offset:40960
    v_exp_f32 v107, v67
    v_add_f32 v31, v31, v105
    v_cvt_pk_bf16_f32 v100, v104, v105
    v_mfma_f32_32x32x16_bf16 v[160:175], a[224:227], v[92:95], v[160:175]
    ds_read_b64_tr_b16 a[224:225], v9 offset:45056
    ds_read_b64_tr_b16 a[226:227], v9 offset:47104
    v_exp_f32 v108, v68
    v_add_f32 v30, v30, v106
    v_mfma_f32_32x32x16_bf16 v[40:55], v[248:251], v[152:155], v[40:55]
    ds_read_b128 v[248:251], v7 offset:40960
    v_exp_f32 v109, v69
    v_add_f32 v31, v31, v107
    v_cvt_pk_bf16_f32 v101, v106, v107
    v_mfma_f32_32x32x16_bf16 v[176:191], a[228:231], v[92:95], v[176:191]
    ds_read_b64_tr_b16 a[228:229], v10 offset:45056
    ds_read_b64_tr_b16 a[230:231], v10 offset:47104
    v_exp_f32 v110, v70
    v_add_f32 v30, v30, v108
    v_mfma_f32_32x32x16_bf16 v[40:55], v[252:255], v[156:159], v[40:55]
    ds_read_b128 v[252:255], v8 offset:40960
    v_exp_f32 v111, v71
    v_add_f32 v31, v31, v109
    v_cvt_pk_bf16_f32 v102, v108, v109
    v_add_f32 v30, v30, v110
    s_waitcnt lgkmcnt(14)
    v_mfma_f32_32x32x16_bf16 v[192:207], a[232:235], v[92:95], v[192:207]
    ds_read_b64_tr_b16 a[232:233], v11 offset:45056
    ds_read_b64_tr_b16 a[234:235], v11 offset:47104
    v_add_f32 v31, v31, v111
    v_cvt_pk_bf16_f32 v103, v110, v111
    v_add_f32 v30, v30, v31
    v_cmp_nge_f32 vcc, s28, v30
    v_mfma_f32_32x32x16_bf16 v[208:223], a[236:239], v[92:95], v[208:223]
    ds_read_b64_tr_b16 a[236:237], v12 offset:45056
    ds_read_b64_tr_b16 a[238:239], v12 offset:47104
    s_cbranch_vccnz K1_STUB_27
K1_BACK_27:
    v_add_f32 v29, v29, v30
    v_mfma_f32_32x32x16_bf16 v[56:71], v[224:227], v[128:131], v[72:87]
    v_exp_f32 v104, v40
    v_exp_f32 v105, v41
    v_exp_f32 v106, v42
    v_mfma_f32_32x32x16_bf16 v[56:71], v[228:231], v[132:135], v[56:71]
    v_exp_f32 v107, v43
    v_cvt_pk_bf16_f32 v88, v104, v105
    v_exp_f32 v108, v44
    v_mfma_f32_32x32x16_bf16 v[160:175], a[208:211], v[96:99], v[160:175]
    s_waitcnt lgkmcnt(0)
    s_barrier
    ds_read_b128 v[224:227], v1 offset:49152
    ds_read_b128 v[228:231], v2 offset:49152
    ds_read_b64_tr_b16 a[208:209], v9 offset:49152
    ds_read_b64_tr_b16 a[210:211], v9 offset:51200
    v_add_f32 v30, v104, v106
    v_mfma_f32_32x32x16_bf16 v[56:71], v[232:235], v[136:139], v[56:71]
    ds_read_b128 v[232:235], v3 offset:49152
    v_exp_f32 v109, v45
    v_add_f32 v31, v105, v107
    v_cvt_pk_bf16_f32 v89, v106, v107
    v_exp_f32 v110, v46
    v_mfma_f32_32x32x16_bf16 v[176:191], a[212:215], v[96:99], v[176:191]
    ds_read_b64_tr_b16 a[212:213], v10 offset:49152
    ds_read_b64_tr_b16 a[214:215], v10 offset:51200
    s_add_u32 s95, s96, 2
    s_and_b32 s95, s95, 3
    s_mul_i32 s27, s95, 294912
    s_add_u32 s27, s27, 73728
    s_add_u32 m0, s24, 16384
    v_mfma_f32_32x32x16_bf16 v[56:71], v[236:239], v[140:143], v[56:71]
    ds_read_b128 v[236:239], v4 offset:49152
    buffer_load_dwordx4 v22, s[4:7], s27 offen offset:0  lds
    v_add_f32 v30, v30, v108
    v_exp_f32 v111, v47
    v_add_f32 v31, v31, v109
    v_mfma_f32_32x32x16_bf16 v[192:207], a[216:219], v[96:99], v[192:207]
    ds_read_b64_tr_b16 a[216:217], v11 offset:49152
    ds_read_b64_tr_b16 a[218:219], v11 offset:51200
    buffer_load_dwordx4 v23, s[4:7], s27 offen offset:1024  lds
    v_cvt_pk_bf16_f32 v90, v108, v109
    v_exp_f32 v104, v48
    v_mfma_f32_32x32x16_bf16 v[56:71], v[240:243], v[144:147], v[56:71]
    ds_read_b128 v[240:243], v5 offset:49152
    buffer_load_dwordx4 v24, s[4:7], s27 offen offset:2048  lds
    v_add_f32 v30, v30, v110
    v_exp_f32 v105, v49
    v_add_f32 v31, v31, v111
    v_mfma_f32_32x32x16_bf16 v[208:223], a[220:223], v[96:99], v[208:223]
    ds_read_b64_tr_b16 a[220:221], v12 offset:49152
    ds_read_b64_tr_b16 a[222:223], v12 offset:51200
    v_cvt_pk_bf16_f32 v91, v110, v111
    v_exp_f32 v106, v50
    v_add_f32 v30, v30, v104
    v_mfma_f32_32x32x16_bf16 v[56:71], v[244:247], v[148:151], v[56:71]
    ds_read_b128 v[244:247], v6 offset:49152
    buffer_load_dwordx4 v25, s[4:7], s27 offen offset:3072  lds
    v_exp_f32 v107, v51
    v_add_f32 v31, v31, v105
    v_cvt_pk_bf16_f32 v92, v104, v105
    v_mfma_f32_32x32x16_bf16 v[160:175], a[224:227], v[100:103], v[160:175]
    ds_read_b64_tr_b16 a[224:225], v9 offset:53248
    ds_read_b64_tr_b16 a[226:227], v9 offset:55296
    v_exp_f32 v108, v52
    v_add_f32 v30, v30, v106
    v_exp_f32 v109, v53
    v_mfma_f32_32x32x16_bf16 v[56:71], v[248:251], v[152:155], v[56:71]
    ds_read_b128 v[248:251], v7 offset:49152
    s_add_u32 s95, s96, 3
    s_and_b32 s95, s95, 3
    s_mul_i32 s27, s95, 294912
    s_add_u32 s27, s27, 0
    s_add_u32 m0, s24, 32768
    v_add_f32 v31, v31, v107
    v_mfma_f32_32x32x16_bf16 v[176:191], a[228:231], v[100:103], v[176:191]
    ds_read_b64_tr_b16 a[228:229], v10 offset:53248
    ds_read_b64_tr_b16 a[230:231], v10 offset:55296
    buffer_load_dwordx4 v22, s[4:7], s27 offen offset:0  lds
    v_cvt_pk_bf16_f32 v93, v106, v107
    v_exp_f32 v110, v54
    v_mfma_f32_32x32x16_bf16 v[56:71], v[252:255], v[156:159], v[56:71]
    ds_read_b128 v[252:255], v8 offset:49152
    buffer_load_dwordx4 v23, s[4:7], s27 offen offset:1024  lds
    v_add_f32 v30, v30, v108
    v_exp_f32 v111, v55
    v_add_f32 v31, v31, v109
    v_mfma_f32_32x32x16_bf16 v[192:207], a[232:235], v[100:103], v[192:207]
    s_branch K1_TJ8
K1_TP8:
    s_setpc_b64 s[30:31]
K1_TJ8:
    ds_read_b64_tr_b16 a[232:233], v11 offset:53248
    ds_read_b64_tr_b16 a[234:235], v11 offset:55296
    buffer_load_dwordx4 v24, s[4:7], s27 offen offset:2048  lds
    v_cvt_pk_bf16_f32 v94, v108, v109
    v_add_f32 v30, v30, v110
    v_add_f32 v31, v31, v111
    v_mfma_f32_32x32x16_bf16 v[208:223], a[236:239], v[100:103], v[208:223]
    ds_read_b64_tr_b16 a[236:237], v12 offset:53248
    ds_read_b64_tr_b16 a[238:239], v12 offset:55296
    buffer_load_dwordx4 v25, s[4:7], s27 offen offset:3072  lds
    v_cvt_pk_bf16_f32 v95, v110, v111
    v_add_f32 v30, v30, v31
    v_cmp_nge_f32 vcc, s28, v30
    s_cbranch_vccnz K1_STUB_28
K1_BACK_28:
    v_add_f32 v29, v29, v30
    s_waitcnt lgkmcnt(14)
    v_mfma_f32_32x32x16_bf16 v[40:55], v[224:227], v[128:131], v[72:87]
    ds_read_b128 v[224:227], v1 offset:57344
    v_exp_f32 v104, v56
    v_exp_f32 v105, v57
    v_exp_f32 v106, v58
    v_mfma_f32_32x32x16_bf16 v[40:55], v[228:231], v[132:135], v[40:55]
    ds_read_b128 v[228:231], v2 offset:57344
    v_exp_f32 v107, v59
    v_cvt_pk_bf16_f32 v96, v104, v105
    v_exp_f32 v108, v60
    v_mfma_f32_32x32x16_bf16 v[160:175], a[208:211], v[88:91], v[160:175]
    s_lshl_b32 s94, s97, 8
    s_waitcnt vmcnt(8)
    v_and_b32 v37, 1, v37
    v_cmp_ne_u32_e64 s[100:101], 0, v37
    s_nop 0
    s_xor_b32 s100, s100, s64
    s_and_b32 s100, s100, 15
    s_cbranch_scc0 K1_PBACK_0
    s_mov_b32 s30, 0
K1_PLOOP_0:
    buffer_load_dword v37, v36, s[68:71], s94 offen sc1
    s_add_u32 s30, s30, 1
    s_waitcnt vmcnt(0)
    s_cmp_gt_u32 s30, 0x30000
    s_cbranch_scc1 K1_PBACK_0
    v_and_b32 v37, 1, v37
            v_cmp_ne_u32_e64 s[100:101], 0, v37
            s_nop 0
            s_xor_b32 s100, s100, s64
            s_and_b32 s100, s100, 15
    s_cbranch_scc1 K1_PLOOP_0
K1_PBACK_0:
    v_mfma_f32_32x32x16_bf16 v[40:55], v[232:235], v[136:139], v[40:55]
    ds_read_b64_tr_b16 a[208:209], v9 offset:57344
    ds_read_b64_tr_b16 a[210:211], v9 offset:59392
    ds_read_b128 v[232:235], v3 offset:57344
    v_add_f32 v30, v104, v106
    v_exp_f32 v109, v61
    v_add_f32 v31, v105, v107
    v_mfma_f32_32x32x16_bf16 v[176:191], a[212:215], v[88:91], v[176:191]
    ds_read_b64_tr_b16 a[212:213], v10 offset:57344
    ds_read_b64_tr_b16 a[214:215], v10 offset:59392
    v_cvt_pk_bf16_f32 v97, v106, v107
    v_exp_f32 v110, v62
    v_add_f32 v30, v30, v108
    v_mfma_f32_32x32x16_bf16 v[40:55], v[236:239], v[140:143], v[40:55]
    ds_read_b128 v[236:239], v4 offset:57344
    s_add_u32 s95, s96, 1
    s_and_b32 s95, s95, 3
    s_lshl_b32 s93, s95, 15
    v_exp_f32 v111, v63
    v_mfma_f32_32x32x16_bf16 v[192:207], a[216:219], v[88:91], v[192:207]
    ds_read_b64_tr_b16 a[216:217], v11 offset:57344
    ds_read_b64_tr_b16 a[218:219], v11 offset:59392
    buffer_load_dwordx4 a[112:115], v0, s[8:11], s93 offen offset:0 sc1
    v_add_f32 v31, v31, v109
    v_cvt_pk_bf16_f32 v98, v108, v109
    s_waitcnt lgkmcnt(14)
    v_mfma_f32_32x32x16_bf16 v[40:55], v[240:243], v[144:147], v[40:55]
    buffer_load_dwordx4 a[116:119], v0, s[8:11], s93 offen offset:1024 sc1
    v_exp_f32 v104, v64
    v_add_f32 v30, v30, v110
    v_exp_f32 v105, v65
    v_mfma_f32_32x32x16_bf16 v[208:223], a[220:223], v[88:91], v[208:223]
    ds_read_b128 v[240:243], v5 offset:57344
    ds_read_b64_tr_b16 a[220:221], v12 offset:57344
    ds_read_b64_tr_b16 a[222:223], v12 offset:59392
    buffer_load_dwordx4 a[120:123], v0, s[8:11], s93 offen offset:2048 sc1
    v_add_f32 v31, v31, v111
    v_cvt_pk_bf16_f32 v99, v110, v111
    v_mfma_f32_32x32x16_bf16 v[40:55], v[244:247], v[148:151], v[40:55]
    ds_read_b128 v[244:247], v6 offset:57344
    v_exp_f32 v106, v66
    v_add_f32 v30, v30, v104
    v_exp_f32 v107, v67
    v_add_f32 v31, v31, v105
    v_mfma_f32_32x32x16_bf16 v[160:175], a[224:227], v[92:95], v[160:175]
    ds_read_b64_tr_b16 a[224:225], v9 offset:61440
    buffer_load_dwordx4 a[124:127], v0, s[8:11], s93 offen offset:3072 sc1
    s_add_u32 s93, s93, 4096
    v_cvt_pk_bf16_f32 v100, v104, v105
    v_exp_f32 v108, v68
    v_mfma_f32_32x32x16_bf16 v[40:55], v[248:251], v[152:155], v[40:55]
    ds_read_b64_tr_b16 a[226:227], v9 offset:63488
    ds_read_b128 v[248:251], v7 offset:57344
    buffer_load_dwordx4 a[128:131], v0, s[8:11], s93 offen offset:0 sc1
    v_add_f32 v30, v30, v106
    v_exp_f32 v109, v69
    v_mfma_f32_32x32x16_bf16 v[176:191], a[228:231], v[92:95], v[176:191]
    ds_read_b64_tr_b16 a[228:229], v10 offset:61440
    buffer_load_dwordx4 a[132:135], v0, s[8:11], s93 offen offset:1024 sc1
    v_add_f32 v31, v31, v107
    v_cvt_pk_bf16_f32 v101, v106, v107
    v_exp_f32 v110, v70
    v_mfma_f32_32x32x16_bf16 v[40:55], v[252:255], v[156:159], v[40:55]
    ds_read_b64_tr_b16 a[230:231], v10 offset:63488
    ds_read_b128 v[252:255], v8 offset:57344
    buffer_load_dwordx4 a[136:139], v0, s[8:11], s93 offen offset:2048 sc1
    v_add_f32 v30, v30, v108
    v_exp_f32 v111, v71
    s_waitcnt lgkmcnt(14)
    v_mfma_f32_32x32x16_bf16 v[192:207], a[232:235], v[92:95], v[192:207]
    ds_read_b64_tr_b16 a[232:233], v11 offset:61440
    buffer_load_dwordx4 a[140:143], v0, s[8:11], s93 offen offset:3072 sc1
    v_add_f32 v31, v31, v109
    v_cvt_pk_bf16_f32 v102, v108, v109
    v_add_f32 v30, v30, v110
    v_add_f32 v31, v31, v111
    v_mfma_f32_32x32x16_bf16 v[208:223], a[236:239], v[92:95], v[208:223]
    ds_read_b64_tr_b16 a[234:235], v11 offset:63488
    ds_read_b64_tr_b16 a[236:237], v12 offset:61440
    ds_read_b64_tr_b16 a[238:239], v12 offset:63488
    s_and_b32 s94, s96, 1
    s_lshl_b32 s94, s94, 8
    s_add_u32 s94, s94, 1024
    buffer_load_dword v37, v36, s[68:71], s94 offen sc1
    v_cvt_pk_bf16_f32 v103, v110, v111
    v_add_f32 v30, v30, v31
    v_cmp_nge_f32 vcc, s28, v30
    s_cbranch_vccnz K1_STUB_29
K1_BACK_29:
    v_add_f32 v29, v29, v30
    v_mfma_f32_32x32x16_bf16 v[56:71], v[224:227], v[128:131], v[72:87]
    v_subrev_u32 v1, 49152, v13
    v_subrev_u32 v2, 49152, v14
    v_subrev_u32 v3, 49152, v15
    v_subrev_u32 v4, 49152, v16
    v_subrev_u32 v5, 65536, v39
    v_mfma_f32_32x32x16_bf16 v[56:71], v[228:231], v[132:135], v[56:71]
    v_exp_f32 v104, v40
    v_exp_f32 v105, v41
    v_exp_f32 v106, v42
    v_mfma_f32_32x32x16_bf16 v[160:175], a[208:211], v[96:99], v[160:175]
    s_waitcnt lgkmcnt(0)
    s_waitcnt vmcnt(9)
    s_barrier
    ds_read_b64_tr_b16 a[208:209], v9 offset:16384
    ds_read_b64_tr_b16 a[210:211], v9 offset:18432
    v_exp_f32 v107, v43
    v_mfma_f32_32x32x16_bf16 v[56:71], v[232:235], v[136:139], v[56:71]
    v_cvt_pk_bf16_f32 v88, v104, v105
    v_exp_f32 v108, v44
    v_add_f32 v30, v104, v106
    v_exp_f32 v109, v45
    s_waitcnt vmcnt(8)
    v_mfma_f32_32x32x16_bf16 a[0:15], a[240:243], a[112:115], a[0:15]
    ds_read_b64_tr_b16 a[240:241], v16 offset:20480
    ds_read_b64_tr_b16 a[242:243], v16 offset:21504
    v_add_f32 v31, v105, v107
    v_cvt_pk_bf16_f32 v89, v106, v107
    v_exp_f32 v110, v46
    v_mfma_f32_32x32x16_bf16 v[176:191], a[212:215], v[96:99], v[176:191]
    ds_read_b64_tr_b16 a[212:213], v10 offset:16384
    s_add_u32 s95, s96, 0
    s_and_b32 s95, s95, 3
    s_mul_i32 s27, s95, 294912
    s_add_u32 s27, s27, 147456
    s_add_u32 m0, s24, 49152
    v_mfma_f32_32x32x16_bf16 v[56:71], v[236:239], v[140:143], v[56:71]
    ds_read_b64_tr_b16 a[214:215], v10 offset:18432
    buffer_load_dwordx4 v22, s[4:7], s27 offen offset:0  lds
    v_add_f32 v30, v30, v108
    v_exp_f32 v111, v47
    v_mfma_f32_32x32x16_bf16 v[192:207], a[216:219], v[96:99], v[192:207]
    ds_read_b64_tr_b16 a[216:217], v11 offset:16384
    ds_read_b64_tr_b16 a[218:219], v11 offset:18432
    buffer_load_dwordx4 v23, s[4:7], s27 offen offset:1024  lds
    v_add_f32 v31, v31, v109
    v_cvt_pk_bf16_f32 v90, v108, v109
    v_mfma_f32_32x32x16_bf16 v[56:71], v[240:243], v[144:147], v[56:71]
    v_exp_f32 v104, v48
    v_add_f32 v30, v30, v110
    v_exp_f32 v105, v49
    v_add_f32 v31, v31, v111
    v_mfma_f32_32x32x16_bf16 a[16:31], a[244:247], a[112:115], a[16:31]
    ds_read_b64_tr_b16 a[244:245], v39 offset:58368
    ds_read_b64_tr_b16 a[246:247], v39 offset:58624
    buffer_load_dwordx4 v24, s[4:7], s27 offen offset:2048  lds
    v_cvt_pk_bf16_f32 v91, v110, v111
    v_mfma_f32_32x32x16_bf16 v[208:223], a[220:223], v[96:99], v[208:223]
    ds_read_b64_tr_b16 a[220:221], v12 offset:16384
    ds_read_b64_tr_b16 a[222:223], v12 offset:18432
    buffer_load_dwordx4 v25, s[4:7], s27 offen offset:3072  lds
    v_exp_f32 v106, v50
    v_mfma_f32_32x32x16_bf16 v[56:71], v[244:247], v[148:151], v[56:71]
    v_add_f32 v30, v30, v104
    v_exp_f32 v107, v51
    v_add_f32 v31, v31, v105
    v_cvt_pk_bf16_f32 v92, v104, v105
    v_mfma_f32_32x32x16_bf16 v[160:175], a[224:227], v[100:103], v[160:175]
    ds_read_b64_tr_b16 a[224:225], v9 offset:20480
    ds_read_b64_tr_b16 a[226:227], v9 offset:22528
    v_exp_f32 v108, v52
    v_add_f32 v30, v30, v106
    v_mfma_f32_32x32x16_bf16 v[56:71], v[248:251], v[152:155], v[56:71]
    s_add_u32 s95, s96, 0
    s_and_b32 s95, s95, 3
    s_mul_i32 s27, s95, 294912
    s_add_u32 s27, s27, 221184
    s_add_u32 m0, s24, 81920
    v_mfma_f32_32x32x16_bf16 a[32:47], a[248:251], a[112:115], a[32:47]
    ds_read_b64_tr_b16 a[248:249], v13 offset:24576
    ds_read_b64_tr_b16 a[250:251], v13 offset:25600
    v_exp_f32 v109, v53
    v_add_f32 v31, v31, v107
    v_cvt_pk_bf16_f32 v93, v106, v107
    v_mfma_f32_32x32x16_bf16 v[176:191], a[228:231], v[100:103], v[176:191]
    ds_read_b64_tr_b16 a[228:229], v10 offset:20480
    ds_read_b64_tr_b16 a[230:231], v10 offset:22528
    buffer_load_dwordx4 v22, s[4:7], s27 offen offset:0  lds
    v_exp_f32 v110, v54
    v_mfma_f32_32x32x16_bf16 v[56:71], v[252:255], v[156:159], v[56:71]
    buffer_load_dwordx4 v23, s[4:7], s27 offen offset:1024  lds
    v_add_f32 v30, v30, v108
    v_exp_f32 v111, v55
    v_add_f32 v31, v31, v109
    v_mfma_f32_32x32x16_bf16 v[192:207], a[232:235], v[100:103], v[192:207]
    ds_read_b64_tr_b16 a[232:233], v11 offset:20480
    ds_read_b64_tr_b16 a[234:235], v11 offset:22528
    buffer_load_dwordx4 v24, s[4:7], s27 offen offset:2048  lds
    v_cvt_pk_bf16_f32 v94, v108, v109
    v_add_f32 v30, v30, v110
    v_mfma_f32_32x32x16_bf16 v[208:223], a[236:239], v[100:103], v[208:223]
    ds_read_b64_tr_b16 a[236:237], v12 offset:20480
    ds_read_b64_tr_b16 a[238:239], v12 offset:22528
    v_add_f32 v31, v31, v111
    v_cvt_pk_bf16_f32 v95, v110, v111
    v_add_f32 v30, v30, v31
    v_cmp_nge_f32 vcc, s28, v30
    v_mfma_f32_32x32x16_bf16 a[48:63], a[252:255], a[112:115], a[48:63]
    ds_read_b64_tr_b16 a[252:253], v14 offset:24576
    ds_read_b64_tr_b16 a[254:255], v14 offset:25600
    s_cbranch_vccnz K1_STUB_30
K1_BACK_30:
    buffer_load_dwordx4 v25, s[4:7], s27 offen offset:3072  lds
    v_add_f32 v29, v29, v30
    s_waitcnt lgkmcnt(14)
    v_mfma_f32_32x32x16_bf16 v[160:175], a[208:211], v[88:91], v[160:175]
    ds_read_b64_tr_b16 a[208:209], v9 offset:24576
    ds_read_b64_tr_b16 a[210:211], v9 offset:26624
    v_exp_f32 v104, v56
    v_exp_f32 v105, v57
    v_mfma_f32_32x32x16_bf16 a[64:79], v[112:115], a[112:115], a[64:79]
    ds_read_b64_tr_b16 v[112:113], v15 offset:24576
    ds_read_b64_tr_b16 v[114:115], v15 offset:25600
    s_add_u32 s95, s96, 2
    s_and_b32 s95, s95, 3
    s_lshl_b32 s93, s95, 15
    v_mfma_f32_32x32x16_bf16 v[176:191], a[212:215], v[88:91], v[176:191]
    ds_read_b64_tr_b16 a[212:213], v9 offset:28672
    ds_read_b64_tr_b16 a[214:215], v9 offset:30720
    v_exp_f32 v106, v58
    v_exp_f32 v107, v59
    v_cvt_pk_bf16_f32 v96, v104, v105
    s_waitcnt vmcnt(15)
    v_mfma_f32_32x32x16_bf16 a[0:15], v[116:119], a[116:119], a[0:15]
    ds_read_b64_tr_b16 v[116:117], v16 offset:24576
    ds_read_b64_tr_b16 v[118:119], v16 offset:25600
    buffer_load_dwordx4 a[144:147], v0, s[8:11], s93 offen offset:0 sc1
    v_exp_f32 v108, v60
    v_add_f32 v30, v104, v106
    v_mfma_f32_32x32x16_bf16 v[192:207], a[216:219], v[88:91], v[192:207]
    ds_read_b64_tr_b16 a[216:217], v10 offset:24576
    ds_read_b64_tr_b16 a[218:219], v10 offset:26624
    buffer_load_dwordx4 a[148:151], v0, s[8:11], s93 offen offset:1024 sc1
    v_exp_f32 v109, v61
    v_add_f32 v31, v105, v107
    v_mfma_f32_32x32x16_bf16 a[16:31], v[120:123], a[116:119], a[16:31]
    ds_read_b64_tr_b16 v[120:121], v39 offset:59392
    ds_read_b64_tr_b16 v[122:123], v39 offset:59648
    v_cvt_pk_bf16_f32 v97, v106, v107
    v_exp_f32 v110, v62
    v_add_f32 v30, v30, v108
    s_waitcnt lgkmcnt(14)
    v_mfma_f32_32x32x16_bf16 v[208:223], a[220:223], v[88:91], v[208:223]
    ds_read_b64_tr_b16 a[220:221], v10 offset:28672
    ds_read_b64_tr_b16 a[222:223], v10 offset:30720
    buffer_load_dwordx4 a[152:155], v0, s[8:11], s93 offen offset:2048 sc1
    v_exp_f32 v111, v63
    v_add_f32 v31, v31, v109
    v_mfma_f32_32x32x16_bf16 a[32:47], v[124:127], a[116:119], a[32:47]
    ds_read_b64_tr_b16 v[124:125], v13 offset:28672
    ds_read_b64_tr_b16 v[126:127], v13 offset:29696
    buffer_load_dwordx4 a[156:159], v0, s[8:11], s93 offen offset:3072 sc1
    v_cvt_pk_bf16_f32 v98, v108, v109
    v_exp_f32 v104, v64
    v_mfma_f32_32x32x16_bf16 a[48:63], a[240:243], a[116:119], a[48:63]
    ds_read_b64_tr_b16 a[240:241], v14 offset:28672
    ds_read_b64_tr_b16 a[242:243], v14 offset:29696
    s_add_u32 s93, s93, 4096
    v_add_f32 v30, v30, v110
    v_exp_f32 v105, v65
    v_add_f32 v31, v31, v111
    v_mfma_f32_32x32x16_bf16 v[160:175], a[224:227], v[92:95], v[160:175]
    ds_read_b64_tr_b16 a[224:225], v11 offset:24576
    ds_read_b64_tr_b16 a[226:227], v11 offset:26624
    buffer_load_dwordx4 a[160:163], v0, s[8:11], s93 offen offset:0 sc1
    v_cvt_pk_bf16_f32 v99, v110, v111
    v_mfma_f32_32x32x16_bf16 a[64:79], a[244:247], a[116:119], a[64:79]
    ds_read_b64_tr_b16 a[244:245], v15 offset:28672
    ds_read_b64_tr_b16 a[246:247], v15 offset:29696
    buffer_load_dwordx4 a[164:167], v0, s[8:11], s93 offen offset:1024 sc1
    v_exp_f32 v106, v66
    v_add_f32 v30, v30, v104
    v_mfma_f32_32x32x16_bf16 v[176:191], a[228:231], v[92:95], v[176:191]
    ds_read_b64_tr_b16 a[228:229], v11 offset:28672
    ds_read_b64_tr_b16 a[230:231], v11 offset:30720
    v_exp_f32 v107, v67
    v_add_f32 v31, v31, v105
    v_cvt_pk_bf16_f32 v100, v104, v105
    s_waitcnt vmcnt(20)
    v_mfma_f32_32x32x16_bf16 a[0:15], a[248:251], a[120:123], a[0:15]
    ds_read_b64_tr_b16 a[248:249], v16 offset:28672
    ds_read_b64_tr_b16 a[250:251], v16 offset:29696
    buffer_load_dwordx4 a[168:171], v0, s[8:11], s93 offen offset:2048 sc1
    v_exp_f32 v108, v68
    v_add_f32 v30, v30, v106
    v_mfma_f32_32x32x16_bf16 v[192:207], a[232:235], v[92:95], v[192:207]
    ds_read_b64_tr_b16 a[232:233], v12 offset:24576
    buffer_load_dwordx4 a[172:175], v0, s[8:11], s93 offen offset:3072 sc1
    v_exp_f32 v109, v69
    v_add_f32 v31, v31, v107
    v_cvt_pk_bf16_f32 v101, v106, v107
    s_waitcnt lgkmcnt(14)
    v_mfma_f32_32x32x16_bf16 a[16:31], a[252:255], a[120:123], a[16:31]
    ds_read_b64_tr_b16 a[234:235], v12 offset:26624
    ds_read_b64_tr_b16 a[252:253], v39 offset:60416
    ds_read_b64_tr_b16 a[254:255], v39 offset:60672
    v_exp_f32 v110, v70
    v_add_f32 v30, v30, v108
    v_mfma_f32_32x32x16_bf16 v[208:223], a[236:239], v[92:95], v[208:223]
    ds_read_b64_tr_b16 a[236:237], v12 offset:28672
    ds_read_b64_tr_b16 a[238:239], v12 offset:30720
    v_exp_f32 v111, v71
    v_add_f32 v31, v31, v109
    v_cvt_pk_bf16_f32 v102, v108, v109
    v_add_f32 v30, v30, v110
    v_mfma_f32_32x32x16_bf16 a[32:47], v[112:115], a[120:123], a[32:47]
    s_and_b32 s94, s96, 1
    s_lshl_b32 s94, s94, 8
    s_add_u32 s94, s94, 1024
    s_waitcnt vmcnt(16)
    v_and_b32 v37, 1, v37
    v_cmp_ne_u32_e64 s[100:101], 0, v37
    s_nop 0
    s_xor_b32 s100, s100, s65
    s_and_b32 s100, s100, 255
    s_cbranch_scc0 K1_PBACK_2
    s_mov_b32 s30, 0
K1_PLOOP_2:
    buffer_load_dword v37, v36, s[68:71], s94 offen sc1
    s_add_u32 s30, s30, 1
    s_waitcnt vmcnt(0)
    s_cmp_gt_u32 s30, 0x30000
    s_cbranch_scc1 K1_PBACK_2
    v_and_b32 v37, 1, v37
            v_cmp_ne_u32_e64 s[100:101], 0, v37
            s_nop 0
            s_xor_b32 s100, s100, s65
            s_and_b32 s100, s100, 255
    s_cbranch_scc1 K1_PLOOP_2
K1_PBACK_2:
    v_mfma_f32_32x32x16_bf16 a[48:63], v[116:119], a[120:123], a[48:63]
    ds_read_b64_tr_b16 v[112:113], v13 offset:32768
    ds_read_b64_tr_b16 v[114:115], v13 offset:33792
    ds_read_b64_tr_b16 v[116:117], v14 offset:32768
    ds_read_b64_tr_b16 v[118:119], v14 offset:33792
    v_add_f32 v31, v31, v111
    v_cvt_pk_bf16_f32 v103, v110, v111
    v_add_f32 v30, v30, v31
    v_cmp_nge_f32 vcc, s28, v30
    s_cbranch_vccnz K1_STUB_31
K1_BACK_31:
    v_add_f32 v29, v29, v30
    v_mov_b32 v27, v29
    v_mov_b32 v26, v29
    s_nop 1
    v_permlane32_swap_b32 v26, v27
    v_add_f32 v26, v26, v27
    v_rcp_f32 v26, v26
    v_mfma_f32_32x32x16_bf16 v[160:175], a[208:211], v[96:99], v[160:175]
    v_mfma_f32_32x32x16_bf16 a[64:79], v[120:123], a[120:123], a[64:79]
    ds_read_b64_tr_b16 v[120:121], v15 offset:32768
    ds_read_b64_tr_b16 v[122:123], v15 offset:33792
    v_mfma_f32_32x32x16_bf16 v[160:175], a[212:215], v[100:103], v[160:175]
    s_waitcnt lgkmcnt(14)
    v_mfma_f32_32x32x16_bf16 a[0:15], v[124:127], a[124:127], a[0:15]
    ds_read_b64_tr_b16 v[124:125], v16 offset:32768
    ds_read_b64_tr_b16 v[126:127], v16 offset:33792
    v_mfma_f32_32x32x16_bf16 v[176:191], a[216:219], v[96:99], v[176:191]
    s_nop 6
    v_pk_mul_f32 v[160:161], v[160:161], v[26:27] op_sel_hi:[1,0]
    v_pk_mul_f32 v[162:163], v[162:163], v[26:27] op_sel_hi:[1,0]
    v_pk_mul_f32 v[164:165], v[164:165], v[26:27] op_sel_hi:[1,0]
    v_pk_mul_f32 v[166:167], v[166:167], v[26:27] op_sel_hi:[1,0]
    v_cvt_pk_bf16_f32 v128, v160, v161
    v_cvt_pk_bf16_f32 v129, v162, v163
    v_cvt_pk_bf16_f32 v130, v164, v165
    v_cvt_pk_bf16_f32 v131, v166, v167
    v_mfma_f32_32x32x16_bf16 a[16:31], a[240:243], a[124:127], a[16:31]
    s_mov_b32 s34, 524288
    buffer_store_dwordx4 v[128:131], v0, s[20:23], s34 offen offset:0 sc1
    v_pk_mul_f32 v[168:169], v[168:169], v[26:27] op_sel_hi:[1,0]
    v_pk_mul_f32 v[170:171], v[170:171], v[26:27] op_sel_hi:[1,0]
    v_mfma_f32_32x32x16_bf16 v[176:191], a[220:223], v[100:103], v[176:191]
    ds_read_b64_tr_b16 a[240:241], v39 offset:61440
    ds_read_b64_tr_b16 a[242:243], v39 offset:61696
    v_pk_mul_f32 v[172:173], v[172:173], v[26:27] op_sel_hi:[1,0]
    v_pk_mul_f32 v[174:175], v[174:175], v[26:27] op_sel_hi:[1,0]
    v_cvt_pk_bf16_f32 v132, v168, v169
    v_cvt_pk_bf16_f32 v133, v170, v171
    v_cvt_pk_bf16_f32 v134, v172, v173
    v_cvt_pk_bf16_f32 v135, v174, v175
    v_mfma_f32_32x32x16_bf16 a[32:47], a[244:247], a[124:127], a[32:47]
    ds_read_b64_tr_b16 a[244:245], v13 offset:36864
    ds_read_b64_tr_b16 a[246:247], v13 offset:37888
    s_mov_b32 s34, 524288
    buffer_store_dwordx4 v[132:135], v0, s[20:23], s34 offen offset:1024 sc1
    v_mfma_f32_32x32x16_bf16 v[192:207], a[224:227], v[96:99], v[192:207]
    v_pk_mul_f32 v[176:177], v[176:177], v[26:27] op_sel_hi:[1,0]
    v_pk_mul_f32 v[178:179], v[178:179], v[26:27] op_sel_hi:[1,0]
    v_pk_mul_f32 v[180:181], v[180:181], v[26:27] op_sel_hi:[1,0]
    v_pk_mul_f32 v[182:183], v[182:183], v[26:27] op_sel_hi:[1,0]
    v_cvt_pk_bf16_f32 v136, v176, v177
    v_cvt_pk_bf16_f32 v137, v178, v179
    v_cvt_pk_bf16_f32 v138, v180, v181
    v_cvt_pk_bf16_f32 v139, v182, v183
    s_waitcnt lgkmcnt(14)
    v_mfma_f32_32x32x16_bf16 a[48:63], a[248:251], a[124:127], a[48:63]
    s_mov_b32 s34, 524288
    buffer_store_dwordx4 v[136:139], v0, s[20:23], s34 offen offset:2048 sc1
    v_pk_mul_f32 v[184:185], v[184:185], v[26:27] op_sel_hi:[1,0]
    v_pk_mul_f32 v[186:187], v[186:187], v[26:27] op_sel_hi:[1,0]
    v_mfma_f32_32x32x16_bf16 v[192:207], a[228:231], v[100:103], v[192:207]
    ds_read_b64_tr_b16 a[248:249], v14 offset:36864
    ds_read_b64_tr_b16 a[250:251], v14 offset:37888
    v_pk_mul_f32 v[188:189], v[188:189], v[26:27] op_sel_hi:[1,0]
    v_pk_mul_f32 v[190:191], v[190:191], v[26:27] op_sel_hi:[1,0]
    v_cvt_pk_bf16_f32 v140, v184, v185
    v_cvt_pk_bf16_f32 v141, v186, v187
    v_cvt_pk_bf16_f32 v142, v188, v189
    v_cvt_pk_bf16_f32 v143, v190, v191
    v_mfma_f32_32x32x16_bf16 a[64:79], a[252:255], a[124:127], a[64:79]
    ds_read_b64_tr_b16 a[252:253], v15 offset:36864
    ds_read_b64_tr_b16 a[254:255], v15 offset:37888
    s_mov_b32 s34, 524288
    buffer_store_dwordx4 v[140:143], v0, s[20:23], s34 offen offset:3072 sc1
    v_mfma_f32_32x32x16_bf16 v[208:223], a[232:235], v[96:99], v[208:223]
    v_pk_mul_f32 v[192:193], v[192:193], v[26:27] op_sel_hi:[1,0]
    v_pk_mul_f32 v[194:195], v[194:195], v[26:27] op_sel_hi:[1,0]
    v_pk_mul_f32 v[196:197], v[196:197], v[26:27] op_sel_hi:[1,0]
    v_pk_mul_f32 v[198:199], v[198:199], v[26:27] op_sel_hi:[1,0]
    v_cvt_pk_bf16_f32 v144, v192, v193
    v_cvt_pk_bf16_f32 v145, v194, v195
    v_cvt_pk_bf16_f32 v146, v196, v197
    v_cvt_pk_bf16_f32 v147, v198, v199
    s_waitcnt lgkmcnt(14)
    v_mfma_f32_32x32x16_bf16 a[0:15], v[112:115], a[128:131], a[0:15]
    s_mov_b32 s34, 528384
    buffer_store_dwordx4 v[144:147], v0, s[20:23], s34 offen offset:0 sc1
    v_pk_mul_f32 v[200:201], v[200:201], v[26:27] op_sel_hi:[1,0]
    v_pk_mul_f32 v[202:203], v[202:203], v[26:27] op_sel_hi:[1,0]
    v_mfma_f32_32x32x16_bf16 v[208:223], a[236:239], v[100:103], v[208:223]
    ds_read_b64_tr_b16 v[112:113], v16 offset:36864
    ds_read_b64_tr_b16 v[114:115], v16 offset:37888
    v_pk_mul_f32 v[204:205], v[204:205], v[26:27] op_sel_hi:[1,0]
    v_pk_mul_f32 v[206:207], v[206:207], v[26:27] op_sel_hi:[1,0]
    v_cvt_pk_bf16_f32 v148, v200, v201
    v_cvt_pk_bf16_f32 v149, v202, v203
    v_cvt_pk_bf16_f32 v150, v204, v205
    v_cvt_pk_bf16_f32 v151, v206, v207
    s_waitcnt lgkmcnt(14)
    v_mfma_f32_32x32x16_bf16 a[16:31], v[116:119], a[128:131], a[16:31]
    ds_read_b64_tr_b16 v[116:117], v39 offset:62464
    ds_read_b64_tr_b16 v[118:119], v39 offset:62720
    s_mov_b32 s34, 528384
    buffer_store_dwordx4 v[148:151], v0, s[20:23], s34 offen offset:1024 sc1
    v_pk_mul_f32 v[208:209], v[208:209], v[26:27] op_sel_hi:[1,0]
    v_pk_mul_f32 v[210:211], v[210:211], v[26:27] op_sel_hi:[1,0]
    v_pk_mul_f32 v[212:213], v[212:213], v[26:27] op_sel_hi:[1,0]
    v_pk_mul_f32 v[214:215], v[214:215], v[26:27] op_sel_hi:[1,0]
    v_cvt_pk_bf16_f32 v152, v208, v209
    v_cvt_pk_bf16_f32 v153, v210, v211
    v_cvt_pk_bf16_f32 v154, v212, v213
    v_cvt_pk_bf16_f32 v155, v214, v215
    s_mov_b32 s34, 528384
    buffer_store_dwordx4 v[152:155], v0, s[20:23], s34 offen offset:2048 sc1
    v_pk_mul_f32 v[216:217], v[216:217], v[26:27] op_sel_hi:[1,0]
    v_pk_mul_f32 v[218:219], v[218:219], v[26:27] op_sel_hi:[1,0]
    v_pk_mul_f32 v[220:221], v[220:221], v[26:27] op_sel_hi:[1,0]
    v_pk_mul_f32 v[222:223], v[222:223], v[26:27] op_sel_hi:[1,0]
    v_cvt_pk_bf16_f32 v156, v216, v217
    v_cvt_pk_bf16_f32 v157, v218, v219
    v_cvt_pk_bf16_f32 v158, v220, v221
    v_cvt_pk_bf16_f32 v159, v222, v223
    s_mov_b32 s34, 528384
    buffer_store_dwordx4 v[156:159], v0, s[20:23], s34 offen offset:3072 sc1
    s_add_u32 m0, s24, 98304
    s_add_u32 s27, s98, 147456
    buffer_load_dwordx4 v38, s[4:7], s27 offen offset:0  lds
    s_add_u32 s27, s98, 164864
    buffer_load_dwordx4 v38, s[4:7], s27 offen offset:1024  lds
    s_add_u32 s27, s98, 182272
    buffer_load_dwordx4 v38, s[4:7], s27 offen offset:2048  lds
    s_add_u32 s27, s98, 199680
    buffer_load_dwordx4 v38, s[4:7], s27 offen offset:3072  lds
    s_waitcnt lgkmcnt(14)
    v_mfma_f32_32x32x16_bf16 a[32:47], v[120:123], a[128:131], a[32:47]
    ds_read_b64_tr_b16 v[120:121], v13 offset:40960
    ds_read_b64_tr_b16 v[122:123], v13 offset:41984
    s_waitcnt lgkmcnt(14)
    v_mfma_f32_32x32x16_bf16 a[48:63], v[124:127], a[128:131], a[48:63]
    ds_read_b64_tr_b16 v[124:125], v14 offset:40960
    ds_read_b64_tr_b16 v[126:127], v14 offset:41984
    s_waitcnt lgkmcnt(14)
    v_mfma_f32_32x32x16_bf16 a[64:79], a[240:243], a[128:131], a[64:79]
    ds_read_b64_tr_b16 a[240:241], v15 offset:40960
    ds_read_b64_tr_b16 a[242:243], v15 offset:41984
    s_add_u32 s95, s96, 3
    s_and_b32 s95, s95, 3
    s_lshl_b32 s93, s95, 15
    s_waitcnt lgkmcnt(14)
    v_mfma_f32_32x32x16_bf16 a[0:15], a[244:247], a[132:135], a[0:15]
    ds_read_b64_tr_b16 a[244:245], v16 offset:40960
    ds_read_b64_tr_b16 a[246:247], v16 offset:41984
    buffer_load_dwordx4 a[176:179], v0, s[8:11], s93 offen offset:0 sc1
    s_waitcnt lgkmcnt(14)
    v_mfma_f32_32x32x16_bf16 a[16:31], a[248:251], a[132:135], a[16:31]
    ds_read_b64_tr_b16 a[248:249], v39 offset:63488
    ds_read_b64_tr_b16 a[250:251], v39 offset:63744
    buffer_load_dwordx4 a[180:183], v0, s[8:11], s93 offen offset:1024 sc1
    s_waitcnt lgkmcnt(14)
    v_mfma_f32_32x32x16_bf16 a[32:47], a[252:255], a[132:135], a[32:47]
    ds_read_b64_tr_b16 a[252:253], v13 offset:45056
    ds_read_b64_tr_b16 a[254:255], v13 offset:46080
    s_waitcnt lgkmcnt(14)
    v_mfma_f32_32x32x16_bf16 a[48:63], v[112:115], a[132:135], a[48:63]
    ds_read_b64_tr_b16 v[112:113], v14 offset:45056
    ds_read_b64_tr_b16 v[114:115], v14 offset:46080
    buffer_load_dwordx4 a[184:187], v0, s[8:11], s93 offen offset:2048 sc1
    s_waitcnt lgkmcnt(14)
    v_mfma_f32_32x32x16_bf16 a[64:79], v[116:119], a[132:135], a[64:79]
    ds_read_b64_tr_b16 v[116:117], v15 offset:45056
    ds_read_b64_tr_b16 v[118:119], v15 offset:46080
    s_waitcnt lgkmcnt(14)
    v_mfma_f32_32x32x16_bf16 a[0:15], v[120:123], a[136:139], a[0:15]
    ds_read_b64_tr_b16 v[120:121], v16 offset:45056
    ds_read_b64_tr_b16 v[122:123], v16 offset:46080
    buffer_load_dwordx4 a[188:191], v0, s[8:11], s93 offen offset:3072 sc1
    s_waitcnt lgkmcnt(14)
    v_mfma_f32_32x32x16_bf16 a[16:31], v[124:127], a[136:139], a[16:31]
    ds_read_b64_tr_b16 v[124:125], v39 offset:64512
    ds_read_b64_tr_b16 v[126:127], v39 offset:64768
    s_waitcnt lgkmcnt(14)
    v_mfma_f32_32x32x16_bf16 a[32:47], a[240:243], a[136:139], a[32:47]
    ds_read_b64_tr_b16 a[240:241], v32 offset:0
    ds_read_b64_tr_b16 a[242:243], v32 offset:1024
    s_add_u32 s93, s93, 4096
    buffer_load_dwordx4 a[192:195], v0, s[8:11], s93 offen offset:0 sc1
    s_waitcnt lgkmcnt(14)
    v_mfma_f32_32x32x16_bf16 a[48:63], a[244:247], a[136:139], a[48:63]
    ds_read_b64_tr_b16 a[244:245], v33 offset:0
    ds_read_b64_tr_b16 a[246:247], v33 offset:1024
    s_waitcnt lgkmcnt(14)
    v_mfma_f32_32x32x16_bf16 a[64:79], a[248:251], a[136:139], a[64:79]
    ds_read_b64_tr_b16 a[248:249], v34 offset:0
    ds_read_b64_tr_b16 a[250:251], v34 offset:1024
    buffer_load_dwordx4 a[196:199], v0, s[8:11], s93 offen offset:1024 sc1
    s_waitcnt lgkmcnt(14)
    v_mfma_f32_32x32x16_bf16 a[0:15], a[252:255], a[140:143], a[0:15]
    ds_read_b64_tr_b16 a[252:253], v35 offset:0
    ds_read_b64_tr_b16 a[254:255], v35 offset:1024
    s_waitcnt lgkmcnt(14)
    v_mfma_f32_32x32x16_bf16 a[16:31], v[112:115], a[140:143], a[16:31]
    ds_read_b64_tr_b16 v[112:113], v32 offset:4096
    ds_read_b64_tr_b16 v[114:115], v32 offset:5120
    buffer_load_dwordx4 a[200:203], v0, s[8:11], s93 offen offset:2048 sc1
    s_waitcnt lgkmcnt(14)
    v_mfma_f32_32x32x16_bf16 a[32:47], v[116:119], a[140:143], a[32:47]
    ds_read_b64_tr_b16 v[116:117], v33 offset:4096
    ds_read_b64_tr_b16 v[118:119], v33 offset:5120
    s_waitcnt lgkmcnt(14)
    v_mfma_f32_32x32x16_bf16 a[48:63], v[120:123], a[140:143], a[48:63]
    ds_read_b64_tr_b16 v[120:121], v34 offset:4096
    ds_read_b64_tr_b16 v[122:123], v34 offset:5120
    buffer_load_dwordx4 a[204:207], v0, s[8:11], s93 offen offset:3072 sc1
    s_waitcnt lgkmcnt(14)
    v_mfma_f32_32x32x16_bf16 a[64:79], v[124:127], a[140:143], a[64:79]
    ds_read_b64_tr_b16 v[124:125], v35 offset:4096
    ds_read_b64_tr_b16 v[126:127], v35 offset:5120
    s_waitcnt lgkmcnt(14)
    s_waitcnt vmcnt(27)
    v_mfma_f32_32x32x16_bf16 a[0:15], a[240:243], a[144:147], a[0:15]
    ds_read_b64_tr_b16 a[240:241], v32 offset:8192
    ds_read_b64_tr_b16 a[242:243], v32 offset:9216
    s_waitcnt lgkmcnt(14)
    v_mfma_f32_32x32x16_bf16 a[16:31], a[244:247], a[144:147], a[16:31]
    ds_read_b64_tr_b16 a[244:245], v33 offset:8192
    ds_read_b64_tr_b16 a[246:247], v33 offset:9216
    s_waitcnt lgkmcnt(14)
    v_mfma_f32_32x32x16_bf16 a[32:47], a[248:251], a[144:147], a[32:47]
    s_branch K1_TJ9
K1_TP9:
    s_setpc_b64 s[30:31]
K1_TJ9:
    s_waitcnt lgkmcnt(0)
    s_waitcnt vmcnt(8)
    s_barrier
    s_lshl_b32 s94, s97, 8
    s_add_u32 s100, s96, 4
    s_lshl2_add_u32 s94, s100, s94
    s_lshr_b32 s100, s64, s100
    v_mov_b32 v37, s100
    v_lshlrev_b32 v27, 8, v0
    buffer_store_dword v37, v27, s[68:71], s94 offen sc1
    v_mfma_f32_32x32x16_bf16 a[48:63], a[252:255], a[144:147], a[48:63]
    ds_read_b64_tr_b16 a[248:249], v34 offset:8192
    ds_read_b64_tr_b16 a[250:251], v34 offset:9216
    ds_read_b64_tr_b16 a[252:253], v35 offset:8192
    ds_read_b64_tr_b16 a[254:255], v35 offset:9216
    v_mfma_f32_32x32x16_bf16 a[0:15], v[112:115], a[148:151], a[0:15]
    ds_read_b64_tr_b16 v[112:113], v32 offset:12288
    ds_read_b64_tr_b16 v[114:115], v32 offset:13312
    v_mfma_f32_32x32x16_bf16 a[16:31], v[116:119], a[148:151], a[16:31]
    ds_read_b64_tr_b16 v[116:117], v33 offset:12288
    s_add_u32 s95, s96, 3
    s_and_b32 s95, s95, 3
    s_mul_i32 s27, s95, 294912
    s_add_u32 s27, s27, 73728
    s_add_u32 m0, s24, 114688
    v_mfma_f32_32x32x16_bf16 a[32:47], v[120:123], a[148:151], a[32:47]
    ds_read_b64_tr_b16 v[118:119], v33 offset:13312
    ds_read_b64_tr_b16 v[120:121], v34 offset:12288
    buffer_load_dwordx4 v22, s[4:7], s27 offen offset:0  lds
    buffer_load_dwordx4 v23, s[4:7], s27 offen offset:1024  lds
    v_mfma_f32_32x32x16_bf16 a[48:63], v[124:127], a[148:151], a[48:63]
    ds_read_b64_tr_b16 v[122:123], v34 offset:13312
    ds_read_b64_tr_b16 v[124:125], v35 offset:12288
    ds_read_b64_tr_b16 v[126:127], v35 offset:13312
    buffer_load_dwordx4 v24, s[4:7], s27 offen offset:2048  lds
    v_mfma_f32_32x32x16_bf16 a[0:15], a[240:243], a[152:155], a[0:15]
    ds_read_b64_tr_b16 a[240:241], v32 offset:16384
    ds_read_b64_tr_b16 a[242:243], v32 offset:17408
    buffer_load_dwordx4 v25, s[4:7], s27 offen offset:3072  lds
    v_mfma_f32_32x32x16_bf16 a[16:31], a[244:247], a[152:155], a[16:31]
    ds_read_b64_tr_b16 a[244:245], v33 offset:16384
    ds_read_b64_tr_b16 a[246:247], v33 offset:17408
    s_waitcnt lgkmcnt(14)
    v_mfma_f32_32x32x16_bf16 a[32:47], a[248:251], a[152:155], a[32:47]
    ds_read_b64_tr_b16 a[248:249], v34 offset:16384
    ds_read_b64_tr_b16 a[250:251], v34 offset:17408
    s_waitcnt lgkmcnt(14)
    v_mfma_f32_32x32x16_bf16 a[48:63], a[252:255], a[152:155], a[48:63]
    ds_read_b64_tr_b16 a[252:253], v35 offset:16384
    ds_read_b64_tr_b16 a[254:255], v35 offset:17408
    s_waitcnt lgkmcnt(14)
    v_mfma_f32_32x32x16_bf16 a[0:15], v[112:115], a[156:159], a[0:15]
    ds_read_b64_tr_b16 v[112:113], v32 offset:20480
    s_add_u32 s95, s96, 1
    s_and_b32 s95, s95, 3
    s_mul_i32 s27, s95, 294912
    s_add_u32 s27, s27, 147456
    s_add_u32 m0, s24, 131072
    s_waitcnt lgkmcnt(13)
    v_mfma_f32_32x32x16_bf16 a[16:31], v[116:119], a[156:159], a[16:31]
    ds_read_b64_tr_b16 v[114:115], v32 offset:21504
    ds_read_b64_tr_b16 v[116:117], v33 offset:20480
    buffer_load_dwordx4 v22, s[4:7], s27 offen offset:0  lds
    buffer_load_dwordx4 v23, s[4:7], s27 offen offset:1024  lds
    s_waitcnt lgkmcnt(13)
    v_mfma_f32_32x32x16_bf16 a[32:47], v[120:123], a[156:159], a[32:47]
    ds_read_b64_tr_b16 v[118:119], v33 offset:21504
    ds_read_b64_tr_b16 v[120:121], v34 offset:20480
    ds_read_b64_tr_b16 v[122:123], v34 offset:21504
    buffer_load_dwordx4 v24, s[4:7], s27 offen offset:2048  lds
    s_waitcnt lgkmcnt(14)
    v_mfma_f32_32x32x16_bf16 a[48:63], v[124:127], a[156:159], a[48:63]
    ds_read_b64_tr_b16 v[124:125], v35 offset:20480
    ds_read_b64_tr_b16 v[126:127], v35 offset:21504
    buffer_load_dwordx4 v25, s[4:7], s27 offen offset:3072  lds
    s_waitcnt lgkmcnt(14)
    v_mfma_f32_32x32x16_bf16 a[0:15], a[240:243], a[160:163], a[0:15]
    ds_read_b64_tr_b16 a[240:241], v32 offset:24576
    ds_read_b64_tr_b16 a[242:243], v32 offset:25600
    s_waitcnt lgkmcnt(14)
    v_mfma_f32_32x32x16_bf16 a[16:31], a[244:247], a[160:163], a[16:31]
    ds_read_b64_tr_b16 a[244:245], v33 offset:24576
    ds_read_b64_tr_b16 a[246:247], v33 offset:25600
    s_waitcnt lgkmcnt(14)
    v_mfma_f32_32x32x16_bf16 a[32:47], a[248:251], a[160:163], a[32:47]
    ds_read_b64_tr_b16 a[248:249], v34 offset:24576
    ds_read_b64_tr_b16 a[250:251], v34 offset:25600
    s_waitcnt lgkmcnt(14)
    v_mfma_f32_32x32x16_bf16 a[48:63], a[252:255], a[160:163], a[48:63]
    ds_read_b64_tr_b16 a[252:253], v35 offset:24576
    s_add_u32 s95, s96, 1
    s_and_b32 s95, s95, 3
    s_mul_i32 s27, s95, 294912
    s_add_u32 s27, s27, 221184
    s_add_u32 m0, s24, 147456
    s_waitcnt lgkmcnt(13)
    v_mfma_f32_32x32x16_bf16 a[0:15], v[112:115], a[164:167], a[0:15]
    ds_read_b64_tr_b16 a[254:255], v35 offset:25600
    ds_read_b64_tr_b16 v[112:113], v32 offset:28672
    buffer_load_dwordx4 v22, s[4:7], s27 offen offset:0  lds
    buffer_load_dwordx4 v23, s[4:7], s27 offen offset:1024  lds
    s_waitcnt lgkmcnt(13)
    v_mfma_f32_32x32x16_bf16 a[16:31], v[116:119], a[164:167], a[16:31]
    ds_read_b64_tr_b16 v[114:115], v32 offset:29696
    ds_read_b64_tr_b16 v[116:117], v33 offset:28672
    ds_read_b64_tr_b16 v[118:119], v33 offset:29696
    buffer_load_dwordx4 v24, s[4:7], s27 offen offset:2048  lds
    s_waitcnt lgkmcnt(14)
    v_mfma_f32_32x32x16_bf16 a[32:47], v[120:123], a[164:167], a[32:47]
    ds_read_b64_tr_b16 v[120:121], v34 offset:28672
    ds_read_b64_tr_b16 v[122:123], v34 offset:29696
    buffer_load_dwordx4 v25, s[4:7], s27 offen offset:3072  lds
    s_waitcnt lgkmcnt(14)
    v_mfma_f32_32x32x16_bf16 a[48:63], v[124:127], a[164:167], a[48:63]
    ds_read_b64_tr_b16 v[124:125], v35 offset:28672
    ds_read_b64_tr_b16 v[126:127], v35 offset:29696
    s_waitcnt lgkmcnt(14)
    v_mfma_f32_32x32x16_bf16 a[0:15], a[240:243], a[168:171], a[0:15]
    ds_read_b64_tr_b16 a[240:241], v32 offset:49152
    ds_read_b64_tr_b16 a[242:243], v32 offset:50176
    s_waitcnt lgkmcnt(14)
    v_mfma_f32_32x32x16_bf16 a[16:31], a[244:247], a[168:171], a[16:31]
    ds_read_b64_tr_b16 a[244:245], v33 offset:49152
    ds_read_b64_tr_b16 a[246:247], v33 offset:50176
    s_waitcnt lgkmcnt(14)
    v_mfma_f32_32x32x16_bf16 a[32:47], a[248:251], a[168:171], a[32:47]
    ds_read_b64_tr_b16 a[248:249], v34 offset:49152
    s_add_u32 s95, s96, 2
    s_and_b32 s95, s95, 3
    s_mul_i32 s27, s95, 294912
    s_add_u32 s27, s27, 147456
    s_add_u32 m0, s24, 65536
    s_waitcnt lgkmcnt(13)
    v_mfma_f32_32x32x16_bf16 a[48:63], a[252:255], a[168:171], a[48:63]
    ds_read_b64_tr_b16 a[250:251], v34 offset:50176
    ds_read_b64_tr_b16 a[252:253], v35 offset:49152
    buffer_load_dwordx4 v22, s[4:7], s27 offen offset:0  lds
    buffer_load_dwordx4 v23, s[4:7], s27 offen offset:1024  lds
    s_waitcnt lgkmcnt(13)
    v_mfma_f32_32x32x16_bf16 a[0:15], v[112:115], a[172:175], a[0:15]
    ds_read_b64_tr_b16 a[254:255], v35 offset:50176
    ds_read_b64_tr_b16 v[112:113], v39 offset:0
    ds_read_b64_tr_b16 v[114:115], v39 offset:256
    buffer_load_dwordx4 v24, s[4:7], s27 offen offset:2048  lds
    s_waitcnt lgkmcnt(14)
    v_mfma_f32_32x32x16_bf16 a[16:31], v[116:119], a[172:175], a[16:31]
    ds_read_b64_tr_b16 v[116:117], v32 offset:53248
    ds_read_b64_tr_b16 v[118:119], v32 offset:54272
    buffer_load_dwordx4 v25, s[4:7], s27 offen offset:3072  lds
    s_waitcnt lgkmcnt(14)
    v_mfma_f32_32x32x16_bf16 a[32:47], v[120:123], a[172:175], a[32:47]
    ds_read_b64_tr_b16 v[120:121], v33 offset:53248
    ds_read_b64_tr_b16 v[122:123], v33 offset:54272
    s_waitcnt lgkmcnt(14)
    v_mfma_f32_32x32x16_bf16 a[48:63], v[124:127], a[172:175], a[48:63]
    ds_read_b64_tr_b16 v[124:125], v34 offset:53248
    ds_read_b64_tr_b16 v[126:127], v34 offset:54272
    s_waitcnt lgkmcnt(14)
    v_mfma_f32_32x32x16_bf16 a[0:15], a[240:243], v[128:131], a[0:15]
    ds_read_b64_tr_b16 a[240:241], v35 offset:53248
    ds_read_b64_tr_b16 a[242:243], v35 offset:54272
    s_waitcnt lgkmcnt(14)
    v_mfma_f32_32x32x16_bf16 a[16:31], a[244:247], v[128:131], a[16:31]
    ds_read_b64_tr_b16 a[244:245], v39 offset:1024
    ds_read_b64_tr_b16 a[246:247], v39 offset:1280
    s_waitcnt lgkmcnt(14)
    v_mfma_f32_32x32x16_bf16 a[32:47], a[248:251], v[128:131], a[32:47]
    ds_read_b64_tr_b16 a[248:249], v32 offset:57344
    ds_read_b64_tr_b16 a[250:251], v32 offset:58368
    s_waitcnt lgkmcnt(14)
    v_mfma_f32_32x32x16_bf16 a[48:63], a[252:255], v[128:131], a[48:63]
    ds_read_b64_tr_b16 a[252:253], v33 offset:57344
    ds_read_b64_tr_b16 a[254:255], v33 offset:58368
    s_waitcnt lgkmcnt(14)
    v_mfma_f32_32x32x16_bf16 a[64:79], v[112:115], v[128:131], a[64:79]
    ds_read_b64_tr_b16 v[112:113], v34 offset:57344
    ds_read_b64_tr_b16 v[114:115], v34 offset:58368
    s_waitcnt lgkmcnt(14)
    v_mfma_f32_32x32x16_bf16 a[0:15], v[116:119], v[132:135], a[0:15]
    s_waitcnt lgkmcnt(0)
    s_waitcnt vmcnt(17)
    s_barrier
    s_lshl_b32 s94, s97, 8
    s_add_u32 s100, s96, 8
    s_lshl2_add_u32 s94, s100, s94
    s_lshr_b32 s100, s64, s100
    v_mov_b32 v37, s100
    v_lshlrev_b32 v27, 8, v0
    buffer_store_dword v37, v27, s[68:71], s94 offen sc1
    v_mfma_f32_32x32x16_bf16 a[16:31], v[120:123], v[132:135], a[16:31]
    ds_read_b64_tr_b16 v[116:117], v35 offset:57344
    ds_read_b64_tr_b16 v[118:119], v35 offset:58368
    ds_read_b64_tr_b16 v[120:121], v39 offset:2048
    ds_read_b64_tr_b16 v[122:123], v39 offset:2304
    s_lshl_b32 s94, s97, 8
    buffer_load_dword v37, v36, s[68:71], s94 offen sc1
    v_mfma_f32_32x32x16_bf16 a[32:47], v[124:127], v[132:135], a[32:47]
    ds_read_b64_tr_b16 v[124:125], v32 offset:61440
    ds_read_b64_tr_b16 v[126:127], v32 offset:62464
    v_mfma_f32_32x32x16_bf16 a[48:63], a[240:243], v[132:135], a[48:63]
    ds_read_b64_tr_b16 a[240:241], v33 offset:61440
    ds_read_b64_tr_b16 a[242:243], v33 offset:62464
    v_mfma_f32_32x32x16_bf16 a[64:79], a[244:247], v[132:135], a[64:79]
    ds_read_b64_tr_b16 a[244:245], v34 offset:61440
    s_add_u32 s95, s96, 2
    s_and_b32 s95, s95, 3
    s_mul_i32 s27, s95, 294912
    s_add_u32 s27, s27, 221184
    s_add_u32 m0, s24, 0
    v_mfma_f32_32x32x16_bf16 a[0:15], a[248:251], v[136:139], a[0:15]
    ds_read_b64_tr_b16 a[246:247], v34 offset:62464
    ds_read_b64_tr_b16 a[248:249], v35 offset:61440
    ds_read_b64_tr_b16 a[250:251], v35 offset:62464
    buffer_load_dwordx4 v22, s[4:7], s27 offen offset:0  lds
    v_mfma_f32_32x32x16_bf16 a[16:31], a[252:255], v[136:139], a[16:31]
    ds_read_b64_tr_b16 a[252:253], v39 offset:3072
    ds_read_b64_tr_b16 a[254:255], v39 offset:3328
    buffer_load_dwordx4 v23, s[4:7], s27 offen offset:1024  lds
    v_mfma_f32_32x32x16_bf16 a[32:47], v[112:115], v[136:139], a[32:47]
    ds_read_b64_tr_b16 v[112:113], v1 offset:32768
    ds_read_b64_tr_b16 v[114:115], v1 offset:33792
    buffer_load_dwordx4 v24, s[4:7], s27 offen offset:2048  lds
    s_waitcnt lgkmcnt(14)
    v_mfma_f32_32x32x16_bf16 a[48:63], v[116:119], v[136:139], a[48:63]
    ds_read_b64_tr_b16 v[116:117], v2 offset:32768
    ds_read_b64_tr_b16 v[118:119], v2 offset:33792
    s_waitcnt lgkmcnt(14)
    v_mfma_f32_32x32x16_bf16 a[64:79], v[120:123], v[136:139], a[64:79]
    ds_read_b64_tr_b16 v[120:121], v3 offset:32768
    ds_read_b64_tr_b16 v[122:123], v3 offset:33792
    buffer_load_dwordx4 v25, s[4:7], s27 offen offset:3072  lds
    s_waitcnt lgkmcnt(14)
    v_mfma_f32_32x32x16_bf16 a[0:15], v[124:127], v[140:143], a[0:15]
    ds_read_b64_tr_b16 v[124:125], v4 offset:32768
    ds_read_b64_tr_b16 v[126:127], v4 offset:33792
    s_waitcnt lgkmcnt(14)
    v_mfma_f32_32x32x16_bf16 a[16:31], a[240:243], v[140:143], a[16:31]
    ds_read_b64_tr_b16 a[240:241], v39 offset:4096
    ds_read_b64_tr_b16 a[242:243], v39 offset:4352
    s_waitcnt lgkmcnt(14)
    v_mfma_f32_32x32x16_bf16 a[32:47], a[244:247], v[140:143], a[32:47]
    ds_read_b64_tr_b16 a[244:245], v1 offset:36864
    s_add_u32 s95, s96, 3
    s_and_b32 s95, s95, 3
    s_mul_i32 s27, s95, 294912
    s_add_u32 s27, s27, 147456
    s_add_u32 m0, s24, 16384
    s_waitcnt lgkmcnt(13)
    v_mfma_f32_32x32x16_bf16 a[48:63], a[248:251], v[140:143], a[48:63]
    ds_read_b64_tr_b16 a[246:247], v1 offset:37888
    ds_read_b64_tr_b16 a[248:249], v2 offset:36864
    ds_read_b64_tr_b16 a[250:251], v2 offset:37888
    buffer_load_dwordx4 v22, s[4:7], s27 offen offset:0  lds
    s_waitcnt lgkmcnt(14)
    v_mfma_f32_32x32x16_bf16 a[64:79], a[252:255], v[140:143], a[64:79]
    ds_read_b64_tr_b16 a[252:253], v3 offset:36864
    ds_read_b64_tr_b16 a[254:255], v3 offset:37888
    buffer_load_dwordx4 v23, s[4:7], s27 offen offset:1024  lds
    s_waitcnt lgkmcnt(14)
    v_mfma_f32_32x32x16_bf16 a[0:15], v[112:115], v[144:147], a[0:15]
    ds_read_b64_tr_b16 v[112:113], v4 offset:36864
    ds_read_b64_tr_b16 v[114:115], v4 offset:37888
    buffer_load_dwordx4 v24, s[4:7], s27 offen offset:2048  lds
    s_waitcnt lgkmcnt(14)
    v_mfma_f32_32x32x16_bf16 a[16:31], v[116:119], v[144:147], a[16:31]
    ds_read_b64_tr_b16 v[116:117], v39 offset:5120
    ds_read_b64_tr_b16 v[118:119], v39 offset:5376
    s_waitcnt lgkmcnt(14)
    v_mfma_f32_32x32x16_bf16 a[32:47], v[120:123], v[144:147], a[32:47]
    ds_read_b64_tr_b16 v[120:121], v1 offset:40960
    ds_read_b64_tr_b16 v[122:123], v1 offset:41984
    buffer_load_dwordx4 v25, s[4:7], s27 offen offset:3072  lds
    s_waitcnt lgkmcnt(14)
    v_mfma_f32_32x32x16_bf16 a[48:63], v[124:127], v[144:147], a[48:63]
    ds_read_b64_tr_b16 v[124:125], v2 offset:40960
    ds_read_b64_tr_b16 v[126:127], v2 offset:41984
    s_waitcnt lgkmcnt(14)
    v_mfma_f32_32x32x16_bf16 a[64:79], a[240:243], v[144:147], a[64:79]
    ds_read_b64_tr_b16 a[240:241], v3 offset:40960
    ds_read_b64_tr_b16 a[242:243], v3 offset:41984
    s_waitcnt lgkmcnt(14)
    v_mfma_f32_32x32x16_bf16 a[0:15], a[244:247], v[148:151], a[0:15]
    ds_read_b64_tr_b16 a[244:245], v4 offset:40960
    ds_read_b64_tr_b16 a[246:247], v4 offset:41984
    s_waitcnt lgkmcnt(14)
    v_mfma_f32_32x32x16_bf16 a[16:31], a[248:251], v[148:151], a[16:31]
    ds_read_b64_tr_b16 a[248:249], v39 offset:6144
    ds_read_b64_tr_b16 a[250:251], v39 offset:6400
    s_waitcnt lgkmcnt(14)
    v_mfma_f32_32x32x16_bf16 a[32:47], a[252:255], v[148:151], a[32:47]
    s_lshl_b32 s94, s97, 8
    s_waitcnt vmcnt(8)
    v_and_b32 v37, 1, v37
    v_cmp_ne_u32_e64 s[100:101], 0, v37
    s_nop 0
    s_xor_b32 s100, s100, s64
    s_and_b32 s100, s100, 240
    s_cbranch_scc0 K1_PBACK_1
    s_mov_b32 s30, 0
K1_PLOOP_1:
    buffer_load_dword v37, v36, s[68:71], s94 offen sc1
    s_add_u32 s30, s30, 1
    s_waitcnt vmcnt(0)
    s_cmp_gt_u32 s30, 0x30000
    s_cbranch_scc1 K1_PBACK_1
    v_and_b32 v37, 1, v37
            v_cmp_ne_u32_e64 s[100:101], 0, v37
            s_nop 0
            s_xor_b32 s100, s100, s64
            s_and_b32 s100, s100, 240
    s_cbranch_scc1 K1_PLOOP_1
K1_PBACK_1:
    s_waitcnt lgkmcnt(12)
    v_mfma_f32_32x32x16_bf16 a[48:63], v[112:115], v[148:151], a[48:63]
    s_add_u32 s95, s96, 1
    s_and_b32 s95, s95, 3
    s_lshl_b32 s93, s95, 15
    s_add_u32 s93, s93, 524288
    buffer_load_dwordx4 a[80:83], v0, s[8:11], s93 offen offset:0 sc1
    s_waitcnt lgkmcnt(10)
    v_mfma_f32_32x32x16_bf16 a[64:79], v[116:119], v[148:151], a[64:79]
    ds_read_b64_tr_b16 a[252:253], v1 offset:45056
    ds_read_b64_tr_b16 a[254:255], v1 offset:46080
    ds_read_b64_tr_b16 v[112:113], v2 offset:45056
    ds_read_b64_tr_b16 v[114:115], v2 offset:46080
    buffer_load_dwordx4 a[84:87], v0, s[8:11], s93 offen offset:1024 sc1
    s_waitcnt lgkmcnt(12)
    v_mfma_f32_32x32x16_bf16 a[0:15], v[120:123], v[152:155], a[0:15]
    ds_read_b64_tr_b16 v[116:117], v3 offset:45056
    ds_read_b64_tr_b16 v[118:119], v3 offset:46080
    ds_read_b64_tr_b16 v[120:121], v4 offset:45056
    ds_read_b64_tr_b16 v[122:123], v4 offset:46080
    buffer_load_dwordx4 a[88:91], v0, s[8:11], s93 offen offset:2048 sc1
    s_waitcnt lgkmcnt(14)
    v_mfma_f32_32x32x16_bf16 a[16:31], v[124:127], v[152:155], a[16:31]
    ds_read_b64_tr_b16 v[124:125], v39 offset:7168
    ds_read_b64_tr_b16 v[126:127], v39 offset:7424
    buffer_load_dwordx4 a[92:95], v0, s[8:11], s93 offen offset:3072 sc1
    s_waitcnt lgkmcnt(14)
    v_mfma_f32_32x32x16_bf16 a[32:47], a[240:243], v[152:155], a[32:47]
    ds_read_b64_tr_b16 a[240:241], v33 offset:32768
    ds_read_b64_tr_b16 a[242:243], v33 offset:33792
    s_add_u32 s93, s93, 4096
    buffer_load_dwordx4 a[96:99], v0, s[8:11], s93 offen offset:0 sc1
    s_waitcnt lgkmcnt(14)
    v_mfma_f32_32x32x16_bf16 a[48:63], a[244:247], v[152:155], a[48:63]
    ds_read_b64_tr_b16 a[244:245], v34 offset:32768
    ds_read_b64_tr_b16 a[246:247], v34 offset:33792
    buffer_load_dwordx4 a[100:103], v0, s[8:11], s93 offen offset:1024 sc1
    s_waitcnt lgkmcnt(14)
    v_mfma_f32_32x32x16_bf16 a[64:79], a[248:251], v[152:155], a[64:79]
    ds_read_b64_tr_b16 a[248:249], v35 offset:32768
    ds_read_b64_tr_b16 a[250:251], v35 offset:33792
    s_waitcnt lgkmcnt(14)
    v_mfma_f32_32x32x16_bf16 a[0:15], a[252:255], v[156:159], a[0:15]
    ds_read_b64_tr_b16 a[252:253], v33 offset:36864
    ds_read_b64_tr_b16 a[254:255], v33 offset:37888
    buffer_load_dwordx4 a[104:107], v0, s[8:11], s93 offen offset:2048 sc1
    s_waitcnt lgkmcnt(14)
    v_mfma_f32_32x32x16_bf16 a[16:31], v[112:115], v[156:159], a[16:31]
    ds_read_b64_tr_b16 v[112:113], v34 offset:36864
    ds_read_b64_tr_b16 v[114:115], v34 offset:37888
    buffer_load_dwordx4 a[108:111], v0, s[8:11], s93 offen offset:3072 sc1
    s_waitcnt lgkmcnt(14)
    v_mfma_f32_32x32x16_bf16 a[32:47], v[116:119], v[156:159], a[32:47]
    ds_read_b64_tr_b16 v[116:117], v35 offset:36864
    ds_read_b64_tr_b16 v[118:119], v35 offset:37888
    s_waitcnt lgkmcnt(14)
    v_mfma_f32_32x32x16_bf16 a[48:63], v[120:123], v[156:159], a[48:63]
    ds_read_b64_tr_b16 v[120:121], v33 offset:40960
    ds_read_b64_tr_b16 v[122:123], v33 offset:41984
    v_bfe_u32 v212, v0, 7, 2
    v_bfe_u32 v213, v0, 5, 1
    v_lshl_add_u32 v212, v212, 1, v213
    v_bfe_u32 v213, v0, 6, 1
    s_waitcnt lgkmcnt(14)
    v_mfma_f32_32x32x16_bf16 a[64:79], v[124:127], v[156:159], a[64:79]
    v_bfe_u32 v214, v0, 9, 1
    v_xor_b32 v213, v213, v214
    v_lshl_add_u32 v212, v213, 3, v212
    v_and_b32 v213, 16, v0
    v_mov_b32 v214, 0x3f80
    v_lshlrev_b32 v213, v213, v214
    s_waitcnt lgkmcnt(12)
    v_mfma_f32_32x32x16_bf16 a[16:31], a[240:243], a[176:179], a[16:31]
    v_cmp_eq_u32_e64 s[100:101], 0, v212
    s_nop 1
    v_cndmask_b32_e64 v88, 0, v213, s[100:101]
    v_cmp_eq_u32_e64 s[100:101], 1, v212
    s_nop 1
    v_cndmask_b32_e64 v89, 0, v213, s[100:101]
    s_waitcnt lgkmcnt(10)
    v_mfma_f32_32x32x16_bf16 a[32:47], a[244:247], a[176:179], a[32:47]
    v_cmp_eq_u32_e64 s[100:101], 2, v212
    s_nop 1
    v_cndmask_b32_e64 v90, 0, v213, s[100:101]
    v_cmp_eq_u32_e64 s[100:101], 3, v212
    s_nop 1
    v_cndmask_b32_e64 v91, 0, v213, s[100:101]
    s_waitcnt lgkmcnt(8)
    v_mfma_f32_32x32x16_bf16 a[48:63], a[248:251], a[176:179], a[48:63]
    v_cmp_eq_u32_e64 s[100:101], 4, v212
    s_nop 1
    v_cndmask_b32_e64 v92, 0, v213, s[100:101]
    v_cmp_eq_u32_e64 s[100:101], 5, v212
    s_nop 1
    v_cndmask_b32_e64 v93, 0, v213, s[100:101]
    s_waitcnt lgkmcnt(6)
    v_mfma_f32_32x32x16_bf16 a[16:31], a[252:255], a[180:183], a[16:31]
    v_cmp_eq_u32_e64 s[100:101], 6, v212
    s_nop 1
    v_cndmask_b32_e64 v94, 0, v213, s[100:101]
    v_cmp_eq_u32_e64 s[100:101], 7, v212
    s_nop 1
    v_cndmask_b32_e64 v95, 0, v213, s[100:101]
    s_waitcnt lgkmcnt(4)
    v_mfma_f32_32x32x16_bf16 a[32:47], v[112:115], a[180:183], a[32:47]
    ds_read_b64_tr_b16 v[124:125], v34 offset:40960
    ds_read_b64_tr_b16 v[126:127], v34 offset:41984
    ds_read_b64_tr_b16 a[240:241], v35 offset:40960
    ds_read_b64_tr_b16 a[242:243], v35 offset:41984
    ds_read_b64_tr_b16 a[244:245], v33 offset:45056
    ds_read_b64_tr_b16 a[246:247], v33 offset:46080
    s_waitcnt lgkmcnt(8)
    v_mfma_f32_32x32x16_bf16 a[48:63], v[116:119], a[180:183], a[48:63]
    s_waitcnt lgkmcnt(0)
    s_barrier
    ds_read_b64_tr_b16 a[248:249], v34 offset:45056
    ds_read_b64_tr_b16 a[250:251], v34 offset:46080
    ds_read_b64_tr_b16 a[252:253], v35 offset:45056
    ds_read_b64_tr_b16 a[254:255], v35 offset:46080
    v_mfma_f32_32x32x16_bf16 a[16:31], v[120:123], a[184:187], a[16:31]
    s_mov_b32 s16, s82
    s_mov_b32 s17, s83
    s_mov_b32 s18, 524288
    s_lshl_b32 s26, s36, 15
    s_and_b32 s25, s96, 2
    s_lshl_b32 s25, s25, 9
    s_add_u32 s25, s25, 6144
    v_mfma_f32_32x32x16_bf16 a[32:47], v[124:127], a[184:187], a[32:47]
    s_cmp_eq_u32 s35, s97
    s_cselect_b32 s95, s25, 0x40000000
    s_cselect_b64 s[66:67], -1, 0
    v_add_u32 v10, s95, v0
    v_bfe_u32 v9, v0, 4, 5
    s_lshl_b32 s95, s35, 5
    v_add_u32 v9, s95, v9
    v_mul_u32_u24 v9, 2304, v9
    v_bfe_u32 v11, v0, 9, 1
    v_lshl_add_u32 v9, v11, 4, v9
    v_mfma_f32_32x32x16_bf16 a[48:63], a[240:243], a[184:187], a[48:63]
    s_lshl2_add_u32 s95, s96, s97
    s_lshl_b32 s95, s95, 6
    s_and_b32 s92, s96, 1
    s_lshl_b32 s92, s92, 1
    s_lshr_b32 s34, s96, 1
    s_add_u32 s92, s92, s34
    s_lshl_b32 s92, s92, 5
    s_add_u32 s92, s92, 1024
    s_sub_u32 s92, s92, s95
    s_cmp_eq_u32 s35, s97
    s_cselect_b32 s92, s92, 0x40000000
    s_mul_i32 s34, s37, 294912
    s_add_u32 s95, s95, s34
    s_mul_i32 s34, s38, 1152
    s_add_u32 s95, s95, s34
    s_add_u32 s12, s88, s95
    s_addc_u32 s13, s89, 0
    s_sub_u32 s14, 2359296, s95
    v_mfma_f32_32x32x16_bf16 a[16:31], a[244:247], a[188:191], a[16:31]
    ds_read_b64_tr_b16 v[112:113], v14 offset:16384
    ds_read_b64_tr_b16 v[114:115], v14 offset:17408
    ds_read_b64_tr_b16 v[116:117], v15 offset:16384
    ds_read_b64_tr_b16 v[118:119], v15 offset:17408
    ds_read_b64_tr_b16 v[120:121], v16 offset:16384
    ds_read_b64_tr_b16 v[122:123], v16 offset:17408
    s_waitcnt lgkmcnt(8)
    v_mfma_f32_32x32x16_bf16 a[32:47], a[248:251], a[188:191], a[32:47]
    ds_read_b64_tr_b16 v[124:125], v14 offset:20480
    ds_read_b64_tr_b16 v[126:127], v14 offset:21504
    ds_read_b64_tr_b16 a[240:241], v15 offset:20480
    ds_read_b64_tr_b16 a[242:243], v15 offset:21504
    ds_read_b64_tr_b16 a[244:245], v16 offset:20480
    ds_read_b64_tr_b16 a[246:247], v16 offset:21504
    s_waitcnt lgkmcnt(12)
    v_mfma_f32_32x32x16_bf16 a[48:63], a[252:255], a[188:191], a[48:63]
    ds_read_b64_tr_b16 a[248:249], v14 offset:24576
    s_add_u32 s95, s96, 3
    s_and_b32 s95, s95, 3
    s_mul_i32 s27, s95, 294912
    s_add_u32 s27, s27, 221184
    s_add_u32 m0, s24, 49152
    s_waitcnt lgkmcnt(11)
    v_mfma_f32_32x32x16_bf16 a[16:31], v[112:115], a[192:195], a[16:31]
    ds_read_b64_tr_b16 a[250:251], v14 offset:25600
    ds_read_b64_tr_b16 a[252:253], v15 offset:24576
    buffer_load_dwordx4 v22, s[4:7], s27 offen offset:0  lds
    buffer_load_dwordx4 v23, s[4:7], s27 offen offset:1024  lds
    s_waitcnt lgkmcnt(11)
    v_mfma_f32_32x32x16_bf16 a[32:47], v[116:119], a[192:195], a[32:47]
    ds_read_b64_tr_b16 a[254:255], v15 offset:25600
    ds_read_b64_tr_b16 v[112:113], v16 offset:24576
    buffer_load_dwordx4 v24, s[4:7], s27 offen offset:2048  lds
    buffer_load_dwordx4 v25, s[4:7], s27 offen offset:3072  lds
    s_waitcnt lgkmcnt(11)
    v_mfma_f32_32x32x16_bf16 a[48:63], v[120:123], a[192:195], a[48:63]
    ds_read_b64_tr_b16 v[114:115], v16 offset:25600
    ds_read_b64_tr_b16 v[116:117], v14 offset:28672
    ds_read_b64_tr_b16 v[118:119], v14 offset:29696
    ds_read_b64_tr_b16 v[120:121], v15 offset:28672
    ds_read_b64_tr_b16 v[122:123], v15 offset:29696
    s_waitcnt lgkmcnt(14)
    v_mfma_f32_32x32x16_bf16 a[16:31], v[124:127], a[196:199], a[16:31]
    ds_read_b64_tr_b16 v[124:125], v16 offset:28672
    ds_read_b64_tr_b16 v[126:127], v16 offset:29696
    s_lshl_b32 s94, s97, 8
    buffer_load_dword v37, v36, s[68:71], s94 offen sc1
    s_waitcnt lgkmcnt(14)
    v_mfma_f32_32x32x16_bf16 a[32:47], a[240:243], a[196:199], a[32:47]
    s_add_u32 s95, s96, 2
    s_and_b32 s95, s95, 3
    s_lshl_b32 s93, s95, 15
    s_add_u32 s93, s93, 524288
    buffer_load_dwordx4 v[224:227], v0, s[8:11], s93 offen offset:0 sc1
    s_waitcnt lgkmcnt(12)
    v_mfma_f32_32x32x16_bf16 a[48:63], a[244:247], a[196:199], a[48:63]
    ds_read_b64_tr_b16 a[240:241], v14 offset:32768
    ds_read_b64_tr_b16 a[242:243], v14 offset:33792
    ds_read_b64_tr_b16 a[244:245], v15 offset:32768
    ds_read_b64_tr_b16 a[246:247], v15 offset:33792
    buffer_load_dwordx4 v[228:231], v0, s[8:11], s93 offen offset:1024 sc1
    s_waitcnt lgkmcnt(14)
    v_mfma_f32_32x32x16_bf16 a[16:31], a[248:251], a[200:203], a[16:31]
    ds_read_b64_tr_b16 a[248:249], v16 offset:32768
    ds_read_b64_tr_b16 a[250:251], v16 offset:33792
    buffer_load_dwordx4 v[232:235], v0, s[8:11], s93 offen offset:2048 sc1
    s_waitcnt lgkmcnt(14)
    v_mfma_f32_32x32x16_bf16 a[32:47], a[252:255], a[200:203], a[32:47]
    ds_read_b64_tr_b16 a[252:253], v39 offset:8192
    ds_read_b64_tr_b16 a[254:255], v39 offset:8448
    buffer_load_dwordx4 v[236:239], v0, s[8:11], s93 offen offset:3072 sc1
    s_waitcnt lgkmcnt(14)
    v_mfma_f32_32x32x16_bf16 a[48:63], v[112:115], a[200:203], a[48:63]
    ds_read_b64_tr_b16 v[112:113], v14 offset:36864
    ds_read_b64_tr_b16 v[114:115], v14 offset:37888
    s_waitcnt lgkmcnt(14)
    v_mfma_f32_32x32x16_bf16 a[16:31], v[116:119], a[204:207], a[16:31]
    ds_read_b64_tr_b16 v[116:117], v15 offset:36864
    ds_read_b64_tr_b16 v[118:119], v15 offset:37888
    s_add_u32 s93, s93, 4096
    buffer_load_dwordx4 v[240:243], v0, s[8:11], s93 offen offset:0 sc1
    s_waitcnt lgkmcnt(14)
    v_mfma_f32_32x32x16_bf16 a[32:47], v[120:123], a[204:207], a[32:47]
    ds_read_b64_tr_b16 v[120:121], v16 offset:36864
    ds_read_b64_tr_b16 v[122:123], v16 offset:37888
    buffer_load_dwordx4 v[244:247], v0, s[8:11], s93 offen offset:1024 sc1
    s_waitcnt lgkmcnt(14)
    v_mfma_f32_32x32x16_bf16 a[48:63], v[124:127], a[204:207], a[48:63]
    ds_read_b64_tr_b16 v[124:125], v39 offset:9216
    ds_read_b64_tr_b16 v[126:127], v39 offset:9472
    s_waitcnt lgkmcnt(14)
    s_waitcnt vmcnt(18)
    v_mfma_f32_32x32x16_bf16 a[16:31], a[240:243], a[80:83], a[16:31]
    ds_read_b64_tr_b16 a[240:241], v14 offset:40960
    ds_read_b64_tr_b16 a[242:243], v14 offset:41984
    buffer_load_dwordx4 v[248:251], v0, s[8:11], s93 offen offset:2048 sc1
    s_waitcnt lgkmcnt(14)
    v_mfma_f32_32x32x16_bf16 a[32:47], a[244:247], a[80:83], a[32:47]
    ds_read_b64_tr_b16 a[244:245], v15 offset:40960
    ds_read_b64_tr_b16 a[246:247], v15 offset:41984
    buffer_load_dwordx4 v[252:255], v0, s[8:11], s93 offen offset:3072 sc1
    s_waitcnt lgkmcnt(14)
    v_mfma_f32_32x32x16_bf16 a[48:63], a[248:251], a[80:83], a[48:63]
    ds_read_b64_tr_b16 a[248:249], v16 offset:40960
    ds_read_b64_tr_b16 a[250:251], v16 offset:41984
    s_waitcnt lgkmcnt(14)
    v_mfma_f32_32x32x16_bf16 a[64:79], a[252:255], a[80:83], a[64:79]
    ds_read_b64_tr_b16 a[252:253], v39 offset:10240
    ds_read_b64_tr_b16 a[254:255], v39 offset:10496
    s_waitcnt lgkmcnt(14)
    s_waitcnt vmcnt(19)
    v_mfma_f32_32x32x16_bf16 a[16:31], v[112:115], a[84:87], a[16:31]
    ds_read_b64_tr_b16 v[112:113], v14 offset:45056
    ds_read_b64_tr_b16 v[114:115], v14 offset:46080
    s_waitcnt lgkmcnt(14)
    v_mfma_f32_32x32x16_bf16 a[32:47], v[116:119], a[84:87], a[32:47]
    ds_read_b64_tr_b16 v[116:117], v15 offset:45056
    ds_read_b64_tr_b16 v[118:119], v15 offset:46080
    s_waitcnt lgkmcnt(14)
    v_mfma_f32_32x32x16_bf16 a[48:63], v[120:123], a[84:87], a[48:63]
    ds_read_b64_tr_b16 v[120:121], v16 offset:45056
    ds_read_b64_tr_b16 v[122:123], v16 offset:46080
    s_add_u32 s95, s96, 3
    s_and_b32 s95, s95, 3
    s_lshl_b32 s93, s95, 15
    s_add_u32 s93, s93, 524288
    s_waitcnt lgkmcnt(14)
    v_mfma_f32_32x32x16_bf16 a[64:79], v[124:127], a[84:87], a[64:79]
    ds_read_b64_tr_b16 v[124:125], v39 offset:11264
    ds_read_b64_tr_b16 v[126:127], v39 offset:11520
    buffer_load_dwordx4 a[208:211], v0, s[8:11], s93 offen offset:0 sc1
    buffer_load_dwordx4 a[212:215], v0, s[8:11], s93 offen offset:1024 sc1
    s_waitcnt lgkmcnt(14)
    s_waitcnt vmcnt(20)
    v_mfma_f32_32x32x16_bf16 a[16:31], a[240:243], a[88:91], a[16:31]
    s_branch K1_TJ10
K1_TP10:
    s_setpc_b64 s[30:31]
K1_TJ10:
    ds_read_b64_tr_b16 a[240:241], v14 offset:49152
    ds_read_b64_tr_b16 a[242:243], v14 offset:50176
    s_waitcnt lgkmcnt(14)
    v_mfma_f32_32x32x16_bf16 a[32:47], a[244:247], a[88:91], a[32:47]
    ds_read_b64_tr_b16 a[244:245], v15 offset:49152
    ds_read_b64_tr_b16 a[246:247], v15 offset:50176
    buffer_load_dwordx4 a[216:219], v0, s[8:11], s93 offen offset:2048 sc1
    s_waitcnt lgkmcnt(14)
    v_mfma_f32_32x32x16_bf16 a[48:63], a[248:251], a[88:91], a[48:63]
    ds_read_b64_tr_b16 a[248:249], v16 offset:49152
    ds_read_b64_tr_b16 a[250:251], v16 offset:50176
    buffer_load_dwordx4 a[220:223], v0, s[8:11], s93 offen offset:3072 sc1
    s_waitcnt lgkmcnt(14)
    v_mfma_f32_32x32x16_bf16 a[64:79], a[252:255], a[88:91], a[64:79]
    ds_read_b64_tr_b16 a[252:253], v39 offset:12288
    ds_read_b64_tr_b16 a[254:255], v39 offset:12544
    s_waitcnt lgkmcnt(14)
    s_waitcnt vmcnt(21)
    v_mfma_f32_32x32x16_bf16 a[16:31], v[112:115], a[92:95], a[16:31]
    ds_read_b64_tr_b16 v[112:113], v14 offset:53248
    ds_read_b64_tr_b16 v[114:115], v14 offset:54272
    s_add_u32 s93, s93, 4096
    buffer_load_dwordx4 a[224:227], v0, s[8:11], s93 offen offset:0 sc1
    s_waitcnt lgkmcnt(14)
    v_mfma_f32_32x32x16_bf16 a[32:47], v[116:119], a[92:95], a[32:47]
    ds_read_b64_tr_b16 v[116:117], v15 offset:53248
    ds_read_b64_tr_b16 v[118:119], v15 offset:54272
    buffer_load_dwordx4 a[228:231], v0, s[8:11], s93 offen offset:1024 sc1
    s_waitcnt lgkmcnt(14)
    v_mfma_f32_32x32x16_bf16 a[48:63], v[120:123], a[92:95], a[48:63]
    ds_read_b64_tr_b16 v[120:121], v16 offset:53248
    ds_read_b64_tr_b16 v[122:123], v16 offset:54272
    s_waitcnt lgkmcnt(14)
    v_mfma_f32_32x32x16_bf16 a[64:79], v[124:127], a[92:95], a[64:79]
    ds_read_b64_tr_b16 v[124:125], v39 offset:13312
    ds_read_b64_tr_b16 v[126:127], v39 offset:13568
    buffer_load_dwordx4 a[232:235], v0, s[8:11], s93 offen offset:2048 sc1
    s_waitcnt lgkmcnt(14)
    s_waitcnt vmcnt(23)
    v_mfma_f32_32x32x16_bf16 a[16:31], a[240:243], a[96:99], a[16:31]
    s_waitcnt lgkmcnt(0)
    s_waitcnt vmcnt(16)
    s_barrier
    ds_read_b64_tr_b16 a[240:241], v14 offset:57344
    ds_read_b64_tr_b16 a[242:243], v14 offset:58368
    buffer_load_dwordx4 a[236:239], v0, s[8:11], s93 offen offset:3072 sc1
    v_mfma_f32_32x32x16_bf16 a[32:47], a[244:247], a[96:99], a[32:47]
    ds_read_b64_tr_b16 a[244:245], v15 offset:57344
    ds_read_b64_tr_b16 a[246:247], v15 offset:58368
    v_mfma_f32_32x32x16_bf16 a[48:63], a[248:251], a[96:99], a[48:63]
    ds_read_b64_tr_b16 a[248:249], v16 offset:57344
    ds_read_b64_tr_b16 a[250:251], v16 offset:58368
    v_mfma_f32_32x32x16_bf16 a[64:79], a[252:255], a[96:99], a[64:79]
    ds_read_b64_tr_b16 a[252:253], v39 offset:14336
    ds_read_b64_tr_b16 a[254:255], v39 offset:14592
    v_mfma_f32_32x32x16_bf16 a[16:31], v[112:115], a[100:103], a[16:31]
    ds_read_b64_tr_b16 v[112:113], v14 offset:61440
    ds_read_b64_tr_b16 v[114:115], v14 offset:62464
    v_mfma_f32_32x32x16_bf16 a[32:47], v[116:119], a[100:103], a[32:47]
    s_lshl_b32 s94, s97, 8
    s_waitcnt vmcnt(16)
    v_and_b32 v37, 1, v37
    v_cmp_ne_u32_e64 s[100:101], 0, v37
    s_nop 0
    s_xor_b32 s100, s100, s64
    s_and_b32 s100, s100, 3840
    s_cbranch_scc0 K1_PBACK_3
    s_mov_b32 s30, 0
K1_PLOOP_3:
    buffer_load_dword v37, v36, s[68:71], s94 offen sc1
    s_add_u32 s30, s30, 1
    s_waitcnt vmcnt(0)
    s_cmp_gt_u32 s30, 0x30000
    s_cbranch_scc1 K1_PBACK_3
    v_and_b32 v37, 1, v37
            v_cmp_ne_u32_e64 s[100:101], 0, v37
            s_nop 0
            s_xor_b32 s100, s100, s64
            s_and_b32 s100, s100, 3840
    s_cbranch_scc1 K1_PLOOP_3
K1_PBACK_3:
    v_mfma_f32_32x32x16_bf16 a[48:63], v[120:123], a[100:103], a[48:63]
    ds_read_b64_tr_b16 v[116:117], v15 offset:61440
    ds_read_b64_tr_b16 v[118:119], v15 offset:62464
    ds_read_b64_tr_b16 v[120:121], v16 offset:61440
    ds_read_b64_tr_b16 v[122:123], v16 offset:62464
    v_accvgpr_read_b32 v72, a0
    v_accvgpr_read_b32 v73, a1
    v_mfma_f32_32x32x16_bf16 a[64:79], v[124:127], a[100:103], a[64:79]
    v_accvgpr_read_b32 v74, a2
    v_accvgpr_read_b32 v75, a3
    v_accvgpr_read_b32 v76, a4
    v_accvgpr_read_b32 v77, a5
    v_accvgpr_read_b32 v78, a6
    v_accvgpr_read_b32 v79, a7
    s_waitcnt lgkmcnt(12)
    v_mfma_f32_32x32x16_bf16 a[16:31], a[240:243], a[104:107], a[16:31]
    v_accvgpr_read_b32 v80, a8
    v_accvgpr_read_b32 v81, a9
    v_accvgpr_read_b32 v82, a10
    v_accvgpr_read_b32 v83, a11
    v_accvgpr_read_b32 v84, a12
    v_accvgpr_read_b32 v85, a13
    s_waitcnt lgkmcnt(10)
    v_mfma_f32_32x32x16_bf16 a[32:47], a[244:247], a[104:107], a[32:47]
    ds_read_b64_tr_b16 v[124:125], v39 offset:15360
    ds_read_b64_tr_b16 v[126:127], v39 offset:15616
    ds_read_b64_tr_b16 a[240:241], v2 offset:16384
    ds_read_b64_tr_b16 a[242:243], v2 offset:17408
    v_accvgpr_read_b32 v86, a14
    v_accvgpr_read_b32 v87, a15
    s_waitcnt lgkmcnt(12)
    v_mfma_f32_32x32x16_bf16 a[48:63], a[248:251], a[104:107], a[48:63]
    ds_read_b64_tr_b16 a[244:245], v3 offset:16384
    ds_read_b64_tr_b16 a[246:247], v3 offset:17408
    ds_read_b64_tr_b16 a[248:249], v4 offset:16384
    ds_read_b64_tr_b16 a[250:251], v4 offset:17408
    s_waitcnt lgkmcnt(14)
    v_mfma_f32_32x32x16_bf16 a[64:79], a[252:255], a[104:107], a[64:79]
    ds_read_b64_tr_b16 a[252:253], v2 offset:20480
    ds_read_b64_tr_b16 a[254:255], v2 offset:21504
    s_waitcnt lgkmcnt(14)
    v_mfma_f32_32x32x16_bf16 a[16:31], v[112:115], a[108:111], a[16:31]
    ds_read_b64_tr_b16 v[112:113], v3 offset:20480
    ds_read_b64_tr_b16 v[114:115], v3 offset:21504
    s_waitcnt lgkmcnt(14)
    v_mfma_f32_32x32x16_bf16 a[32:47], v[116:119], a[108:111], a[32:47]
    ds_read_b64_tr_b16 v[116:117], v4 offset:20480
    ds_read_b64_tr_b16 v[118:119], v4 offset:21504
    s_waitcnt lgkmcnt(14)
    v_mfma_f32_32x32x16_bf16 a[48:63], v[120:123], a[108:111], a[48:63]
    ds_read_b64_tr_b16 v[120:121], v2 offset:24576
    ds_read_b64_tr_b16 v[122:123], v2 offset:25600
    s_waitcnt lgkmcnt(14)
    v_mfma_f32_32x32x16_bf16 a[64:79], v[124:127], a[108:111], a[64:79]
    ds_read_b64_tr_b16 v[124:125], v3 offset:24576
    ds_read_b64_tr_b16 v[126:127], v3 offset:25600
    s_waitcnt lgkmcnt(14)
    s_waitcnt vmcnt(15)
    v_mfma_f32_32x32x16_bf16 a[16:31], a[240:243], v[224:227], a[16:31]
    ds_read_b64_tr_b16 a[240:241], v4 offset:24576
    ds_read_b64_tr_b16 a[242:243], v4 offset:25600
    s_waitcnt lgkmcnt(14)
    v_mfma_f32_32x32x16_bf16 a[32:47], a[244:247], v[224:227], a[32:47]
    s_nop 2
    v_accvgpr_read_b32 v40, a64
    v_accvgpr_read_b32 v41, a65
    v_accvgpr_read_b32 v42, a66
    v_accvgpr_read_b32 v43, a67
    v_accvgpr_read_b32 v44, a68
    v_accvgpr_read_b32 v45, a69
    s_waitcnt lgkmcnt(12)
    v_mfma_f32_32x32x16_bf16 a[48:63], a[248:251], v[224:227], a[48:63]
    v_accvgpr_read_b32 v46, a70
    v_accvgpr_read_b32 v47, a71
    v_cvt_pk_bf16_f32 v40, v40, v41
    v_cvt_pk_bf16_f32 v41, v42, v43
    v_cvt_pk_bf16_f32 v42, v44, v45
    v_cvt_pk_bf16_f32 v43, v46, v47
    s_waitcnt lgkmcnt(10)
    s_waitcnt vmcnt(14)
    v_mfma_f32_32x32x16_bf16 a[16:31], a[252:255], v[228:231], a[16:31]
    v_or_b32 v40, 1, v40
    v_or_b32 v42, 1, v42
    buffer_store_dwordx4 v[40:43], v0, s[20:23], s25 offen offset:0 sc1
    v_accvgpr_read_b32 v48, a72
    v_accvgpr_read_b32 v49, a73
    s_waitcnt lgkmcnt(8)
    v_mfma_f32_32x32x16_bf16 a[32:47], v[112:115], v[228:231], a[32:47]
    v_accvgpr_read_b32 v50, a74
    v_accvgpr_read_b32 v51, a75
    v_accvgpr_read_b32 v52, a76
    v_accvgpr_read_b32 v53, a77
    v_accvgpr_read_b32 v54, a78
    v_accvgpr_read_b32 v55, a79
    s_waitcnt lgkmcnt(6)
    v_mfma_f32_32x32x16_bf16 a[48:63], v[116:119], v[228:231], a[48:63]
    v_cvt_pk_bf16_f32 v48, v48, v49
    v_cvt_pk_bf16_f32 v49, v50, v51
    v_cvt_pk_bf16_f32 v50, v52, v53
    v_cvt_pk_bf16_f32 v51, v54, v55
    v_or_b32 v48, 1, v48
    v_or_b32 v50, 1, v50
    s_waitcnt lgkmcnt(4)
    s_waitcnt vmcnt(14)
    v_mfma_f32_32x32x16_bf16 a[16:31], v[120:123], v[232:235], a[16:31]
    ds_read_b64_tr_b16 a[244:245], v2 offset:28672
    ds_read_b64_tr_b16 a[246:247], v2 offset:29696
    ds_read_b64_tr_b16 a[248:249], v3 offset:28672
    ds_read_b64_tr_b16 a[250:251], v3 offset:29696
    s_xor_b32 s34, s25, 1024
    buffer_store_dwordx4 v[48:51], v0, s[20:23], s34 offen offset:0 sc1
    s_waitcnt lgkmcnt(6)
    v_mfma_f32_32x32x16_bf16 a[32:47], v[124:127], v[232:235], a[32:47]
    ds_read_b64_tr_b16 a[252:253], v4 offset:28672
    ds_read_b64_tr_b16 a[254:255], v4 offset:29696
    ds_read_b64_tr_b16 v[112:113], v33 offset:0
    ds_read_b64_tr_b16 v[114:115], v33 offset:1024
    ds_read_b64_tr_b16 v[116:117], v34 offset:0
    ds_read_b64_tr_b16 v[118:119], v34 offset:1024
    s_waitcnt lgkmcnt(10)
    v_mfma_f32_32x32x16_bf16 a[48:63], a[240:243], v[232:235], a[48:63]
    ds_read_b64_tr_b16 v[120:121], v35 offset:0
    ds_read_b64_tr_b16 v[122:123], v35 offset:1024
    ds_read_b64_tr_b16 v[124:125], v33 offset:4096
    ds_read_b64_tr_b16 v[126:127], v33 offset:5120
    ds_read_b64_tr_b16 a[240:241], v34 offset:4096
    ds_read_b64_tr_b16 a[242:243], v34 offset:5120
    s_waitcnt lgkmcnt(14)
    s_waitcnt vmcnt(14)
    v_mfma_f32_32x32x16_bf16 a[16:31], a[244:247], v[236:239], a[16:31]
    ds_read_b64_tr_b16 a[244:245], v35 offset:4096
    ds_read_b64_tr_b16 a[246:247], v35 offset:5120
    s_waitcnt lgkmcnt(14)
    v_mfma_f32_32x32x16_bf16 a[32:47], a[248:251], v[236:239], a[32:47]
    ds_read_b64_tr_b16 a[248:249], v33 offset:8192
    ds_read_b64_tr_b16 a[250:251], v33 offset:9216
    s_waitcnt lgkmcnt(14)
    v_mfma_f32_32x32x16_bf16 a[48:63], a[252:255], v[236:239], a[48:63]
    ds_read_b64_tr_b16 a[252:253], v34 offset:8192
    ds_read_b64_tr_b16 a[254:255], v34 offset:9216
    s_waitcnt lgkmcnt(14)
    s_waitcnt vmcnt(13)
    v_mfma_f32_32x32x16_bf16 a[16:31], v[112:115], v[240:243], a[16:31]
    ds_read_b64_tr_b16 v[112:113], v35 offset:8192
    ds_read_b64_tr_b16 v[114:115], v35 offset:9216
    s_waitcnt lgkmcnt(14)
    v_mfma_f32_32x32x16_bf16 a[32:47], v[116:119], v[240:243], a[32:47]
    ds_read_b64_tr_b16 v[116:117], v33 offset:12288
    ds_read_b64_tr_b16 v[118:119], v33 offset:13312
    s_waitcnt lgkmcnt(14)
    v_mfma_f32_32x32x16_bf16 a[48:63], v[120:123], v[240:243], a[48:63]
    ds_read_b64_tr_b16 v[120:121], v34 offset:12288
    ds_read_b64_tr_b16 v[122:123], v34 offset:13312
    s_waitcnt lgkmcnt(14)
    s_waitcnt vmcnt(12)
    v_mfma_f32_32x32x16_bf16 a[16:31], v[124:127], v[244:247], a[16:31]
    ds_read_b64_tr_b16 v[124:125], v35 offset:12288
    ds_read_b64_tr_b16 v[126:127], v35 offset:13312
    s_waitcnt lgkmcnt(14)
    v_mfma_f32_32x32x16_bf16 a[32:47], a[240:243], v[244:247], a[32:47]
    ds_read_b64_tr_b16 a[240:241], v33 offset:16384
    ds_read_b64_tr_b16 a[242:243], v33 offset:17408
    s_waitcnt lgkmcnt(14)
    v_mfma_f32_32x32x16_bf16 a[48:63], a[244:247], v[244:247], a[48:63]
    ds_read_b64_tr_b16 a[244:245], v33 offset:20480
    ds_read_b64_tr_b16 a[246:247], v33 offset:21504
    s_waitcnt lgkmcnt(14)
    s_waitcnt vmcnt(11)
    v_mfma_f32_32x32x16_bf16 a[16:31], a[248:251], v[248:251], a[16:31]
    ds_read_b64_tr_b16 a[248:249], v33 offset:24576
    ds_read_b64_tr_b16 a[250:251], v33 offset:25600
    s_waitcnt lgkmcnt(14)
    v_mfma_f32_32x32x16_bf16 a[32:47], a[252:255], v[248:251], a[32:47]
    ds_read_b64_tr_b16 a[252:253], v33 offset:28672
    ds_read_b64_tr_b16 a[254:255], v33 offset:29696
    s_waitcnt lgkmcnt(14)
    v_mfma_f32_32x32x16_bf16 a[48:63], v[112:115], v[248:251], a[48:63]
    ds_read_b64_tr_b16 v[112:113], v33 offset:49152
    ds_read_b64_tr_b16 v[114:115], v33 offset:50176
    s_waitcnt lgkmcnt(14)
    s_waitcnt vmcnt(10)
    v_mfma_f32_32x32x16_bf16 a[16:31], v[116:119], v[252:255], a[16:31]
    ds_read_b64_tr_b16 v[116:117], v33 offset:53248
    ds_read_b64_tr_b16 v[118:119], v33 offset:54272
    s_waitcnt lgkmcnt(14)
    v_mfma_f32_32x32x16_bf16 a[32:47], v[120:123], v[252:255], a[32:47]
    ds_read_b64_tr_b16 v[120:121], v33 offset:57344
    ds_read_b64_tr_b16 v[122:123], v33 offset:58368
    s_xor_b32 s99, s26, 65536
    buffer_load_dwordx4 v[184:187], v10, s[16:19], s99 offen sc1
    s_waitcnt lgkmcnt(14)
    v_mfma_f32_32x32x16_bf16 a[48:63], v[124:127], v[252:255], a[48:63]
    ds_read_b64_tr_b16 v[124:125], v33 offset:61440
    ds_read_b64_tr_b16 v[126:127], v33 offset:62464
    s_xor_b32 s99, s26, 131072
    buffer_load_dwordx4 v[188:191], v10, s[16:19], s99 offen sc1
    s_waitcnt lgkmcnt(14)
    s_waitcnt vmcnt(11)
    v_mfma_f32_32x32x16_bf16 a[16:31], a[240:243], a[208:211], a[16:31]
    ds_read_b64_tr_b16 a[240:241], v34 offset:16384
    ds_read_b64_tr_b16 a[242:243], v34 offset:17408
    s_xor_b32 s99, s26, 196608
    buffer_load_dwordx4 v[192:195], v10, s[16:19], s99 offen sc1
    s_waitcnt lgkmcnt(14)
    s_waitcnt vmcnt(11)
    v_mfma_f32_32x32x16_bf16 a[16:31], a[244:247], a[212:215], a[16:31]
    ds_read_b64_tr_b16 a[244:245], v34 offset:20480
    ds_read_b64_tr_b16 a[246:247], v34 offset:21504
    s_xor_b32 s99, s26, 262144
    buffer_load_dwordx4 v[196:199], v10, s[16:19], s99 offen sc1
    s_waitcnt lgkmcnt(14)
    s_waitcnt vmcnt(11)
    v_mfma_f32_32x32x16_bf16 a[16:31], a[248:251], a[216:219], a[16:31]
    ds_read_b64_tr_b16 a[248:249], v34 offset:24576
    ds_read_b64_tr_b16 a[250:251], v34 offset:25600
    s_xor_b32 s99, s26, 327680
    buffer_load_dwordx4 v[200:203], v10, s[16:19], s99 offen sc1
    s_waitcnt lgkmcnt(14)
    s_waitcnt vmcnt(11)
    v_mfma_f32_32x32x16_bf16 a[16:31], a[252:255], a[220:223], a[16:31]
    ds_read_b64_tr_b16 a[252:253], v34 offset:28672
    ds_read_b64_tr_b16 a[254:255], v34 offset:29696
    s_xor_b32 s99, s26, 393216
    buffer_load_dwordx4 v[204:207], v10, s[16:19], s99 offen sc1
    s_waitcnt lgkmcnt(14)
    s_waitcnt vmcnt(11)
    v_mfma_f32_32x32x16_bf16 a[16:31], v[112:115], a[224:227], a[16:31]
    ds_read_b64_tr_b16 v[112:113], v34 offset:49152
    ds_read_b64_tr_b16 v[114:115], v34 offset:50176
    s_xor_b32 s99, s26, 458752
    buffer_load_dwordx4 v[208:211], v10, s[16:19], s99 offen sc1
    s_waitcnt lgkmcnt(14)
    s_waitcnt vmcnt(11)
    v_mfma_f32_32x32x16_bf16 a[16:31], v[116:119], a[228:231], a[16:31]
    ds_read_b64_tr_b16 v[116:117], v34 offset:53248
    ds_read_b64_tr_b16 v[118:119], v34 offset:54272
    s_waitcnt lgkmcnt(14)
    s_waitcnt vmcnt(10)
    v_mfma_f32_32x32x16_bf16 a[16:31], v[120:123], a[232:235], a[16:31]
    ds_read_b64_tr_b16 v[120:121], v34 offset:57344
    ds_read_b64_tr_b16 v[122:123], v34 offset:58368
    s_waitcnt lgkmcnt(14)
    s_waitcnt vmcnt(9)
    v_mfma_f32_32x32x16_bf16 a[16:31], v[124:127], a[236:239], a[16:31]
    ds_read_b64_tr_b16 v[124:125], v34 offset:61440
    ds_read_b64_tr_b16 v[126:127], v34 offset:62464
    s_waitcnt lgkmcnt(14)
    v_mfma_f32_32x32x16_bf16 a[32:47], a[240:243], a[208:211], a[32:47]
    ds_read_b64_tr_b16 a[240:241], v35 offset:16384
    ds_read_b64_tr_b16 a[242:243], v35 offset:17408
    s_waitcnt lgkmcnt(14)
    v_mfma_f32_32x32x16_bf16 a[32:47], a[244:247], a[212:215], a[32:47]
    s_nop 3
    v_accvgpr_read_b32 v56, a16
    v_accvgpr_read_b32 v57, a17
    v_accvgpr_read_b32 v58, a18
    v_accvgpr_read_b32 v59, a19
    v_accvgpr_read_b32 v60, a20
    v_accvgpr_read_b32 v61, a21
    v_accvgpr_read_b32 v62, a22
    v_accvgpr_read_b32 v63, a23
    s_waitcnt lgkmcnt(12)
    v_mfma_f32_32x32x16_bf16 a[32:47], a[248:251], a[216:219], a[32:47]
    v_cvt_pk_bf16_f32 v56, v56, v57
    v_cvt_pk_bf16_f32 v57, v58, v59
    v_cvt_pk_bf16_f32 v58, v60, v61
    v_cvt_pk_bf16_f32 v59, v62, v63
    v_or_b32 v56, 1, v56
    v_or_b32 v58, 1, v58
    buffer_store_dwordx4 v[56:59], v0, s[20:23], 0 offen offset:0 sc1
    s_waitcnt lgkmcnt(10)
    v_mfma_f32_32x32x16_bf16 a[32:47], a[252:255], a[220:223], a[32:47]
    v_accvgpr_read_b32 v64, a24
    v_accvgpr_read_b32 v65, a25
    v_accvgpr_read_b32 v66, a26
    v_accvgpr_read_b32 v67, a27
    v_accvgpr_read_b32 v68, a28
    v_accvgpr_read_b32 v69, a29
    v_accvgpr_read_b32 v70, a30
    v_accvgpr_read_b32 v71, a31
    s_waitcnt lgkmcnt(8)
    v_mfma_f32_32x32x16_bf16 a[32:47], v[112:115], a[224:227], a[32:47]
    v_cvt_pk_bf16_f32 v64, v64, v65
    v_cvt_pk_bf16_f32 v65, v66, v67
    v_cvt_pk_bf16_f32 v66, v68, v69
    v_cvt_pk_bf16_f32 v67, v70, v71
    v_or_b32 v64, 1, v64
    v_or_b32 v66, 1, v66
    buffer_store_dwordx4 v[64:67], v0, s[20:23], 0 offen offset:1024 sc1
    s_waitcnt lgkmcnt(6)
    v_mfma_f32_32x32x16_bf16 a[32:47], v[116:119], a[228:231], a[32:47]
    ds_read_b64_tr_b16 a[244:245], v35 offset:20480
    ds_read_b64_tr_b16 a[246:247], v35 offset:21504
    ds_read_b64_tr_b16 a[248:249], v35 offset:24576
    ds_read_b64_tr_b16 a[250:251], v35 offset:25600
    ds_read_b64_tr_b16 a[252:253], v35 offset:28672
    ds_read_b64_tr_b16 a[254:255], v35 offset:29696
    ds_read_b64_tr_b16 v[112:113], v35 offset:49152
    ds_read_b64_tr_b16 v[114:115], v35 offset:50176
    s_waitcnt lgkmcnt(12)
    v_mfma_f32_32x32x16_bf16 a[32:47], v[120:123], a[232:235], a[32:47]
    ds_read_b64_tr_b16 v[116:117], v35 offset:53248
    ds_read_b64_tr_b16 v[118:119], v35 offset:54272
    ds_read_b64_tr_b16 v[120:121], v35 offset:57344
    ds_read_b64_tr_b16 v[122:123], v35 offset:58368
    s_waitcnt lgkmcnt(14)
    v_mfma_f32_32x32x16_bf16 a[32:47], v[124:127], a[236:239], a[32:47]
    ds_read_b64_tr_b16 v[124:125], v35 offset:61440
    ds_read_b64_tr_b16 v[126:127], v35 offset:62464
    s_waitcnt lgkmcnt(14)
    v_mfma_f32_32x32x16_bf16 a[48:63], a[240:243], a[208:211], a[48:63]
    ds_read_b64_tr_b16 a[240:241], v32 offset:32768
    ds_read_b64_tr_b16 a[242:243], v32 offset:33792
    s_waitcnt lgkmcnt(14)
    v_mfma_f32_32x32x16_bf16 a[48:63], a[244:247], a[212:215], a[48:63]
    s_nop 3
    v_accvgpr_read_b32 v40, a32
    v_accvgpr_read_b32 v41, a33
    v_accvgpr_read_b32 v42, a34
    v_accvgpr_read_b32 v43, a35
    v_accvgpr_read_b32 v44, a36
    v_accvgpr_read_b32 v45, a37
    v_accvgpr_read_b32 v46, a38
    v_accvgpr_read_b32 v47, a39
    s_waitcnt lgkmcnt(12)
    v_mfma_f32_32x32x16_bf16 a[48:63], a[248:251], a[216:219], a[48:63]
    v_cvt_pk_bf16_f32 v40, v40, v41
    v_cvt_pk_bf16_f32 v41, v42, v43
    v_cvt_pk_bf16_f32 v42, v44, v45
    v_cvt_pk_bf16_f32 v43, v46, v47
    v_or_b32 v40, 1, v40
    v_or_b32 v42, 1, v42
    buffer_store_dwordx4 v[40:43], v0, s[20:23], 0 offen offset:2048 sc1
    s_waitcnt lgkmcnt(10)
    v_mfma_f32_32x32x16_bf16 a[48:63], a[252:255], a[220:223], a[48:63]
    v_accvgpr_read_b32 v48, a40
    v_accvgpr_read_b32 v49, a41
    v_accvgpr_read_b32 v50, a42
    v_accvgpr_read_b32 v51, a43
    v_accvgpr_read_b32 v52, a44
    v_accvgpr_read_b32 v53, a45
    v_accvgpr_read_b32 v54, a46
    v_accvgpr_read_b32 v55, a47
    s_waitcnt lgkmcnt(8)
    v_mfma_f32_32x32x16_bf16 a[48:63], v[112:115], a[224:227], a[48:63]
    v_cvt_pk_bf16_f32 v48, v48, v49
    v_cvt_pk_bf16_f32 v49, v50, v51
    v_cvt_pk_bf16_f32 v50, v52, v53
    v_cvt_pk_bf16_f32 v51, v54, v55
    v_or_b32 v48, 1, v48
    v_or_b32 v50, 1, v50
    buffer_store_dwordx4 v[48:51], v0, s[20:23], 0 offen offset:3072 sc1
    s_waitcnt lgkmcnt(6)
    v_mfma_f32_32x32x16_bf16 a[48:63], v[116:119], a[228:231], a[48:63]
    ds_read_b64_tr_b16 a[244:245], v32 offset:36864
    ds_read_b64_tr_b16 a[246:247], v32 offset:37888
    ds_read_b64_tr_b16 a[248:249], v32 offset:40960
    ds_read_b64_tr_b16 a[250:251], v32 offset:41984
    ds_read_b64_tr_b16 a[252:253], v32 offset:45056
    ds_read_b64_tr_b16 a[254:255], v32 offset:46080
    ds_read_b64_tr_b16 v[112:113], v13 offset:16384
    ds_read_b64_tr_b16 v[114:115], v13 offset:17408
    s_waitcnt lgkmcnt(12)
    v_mfma_f32_32x32x16_bf16 a[48:63], v[120:123], a[232:235], a[48:63]
    ds_read_b64_tr_b16 v[116:117], v13 offset:20480
    ds_read_b64_tr_b16 v[118:119], v13 offset:21504
    ds_read_b64_tr_b16 v[120:121], v13 offset:24576
    ds_read_b64_tr_b16 v[122:123], v13 offset:25600
    s_waitcnt lgkmcnt(14)
    v_mfma_f32_32x32x16_bf16 a[48:63], v[124:127], a[236:239], a[48:63]
    ds_read_b64_tr_b16 v[124:125], v13 offset:28672
    ds_read_b64_tr_b16 v[126:127], v13 offset:29696
    s_waitcnt lgkmcnt(14)
    v_mfma_f32_32x32x16_bf16 v[72:87], a[240:243], a[176:179], v[72:87]
    ds_read_b64_tr_b16 a[240:241], v13 offset:32768
    ds_read_b64_tr_b16 a[242:243], v13 offset:33792
    s_waitcnt lgkmcnt(14)
    v_mfma_f32_32x32x16_bf16 v[72:87], a[244:247], a[180:183], v[72:87]
    s_nop 3
    v_accvgpr_read_b32 v56, a48
    v_accvgpr_read_b32 v57, a49
    v_accvgpr_read_b32 v58, a50
    v_accvgpr_read_b32 v59, a51
    v_accvgpr_read_b32 v60, a52
    v_accvgpr_read_b32 v61, a53
    v_accvgpr_read_b32 v62, a54
    v_accvgpr_read_b32 v63, a55
    s_waitcnt lgkmcnt(12)
    v_mfma_f32_32x32x16_bf16 v[72:87], a[248:251], a[184:187], v[72:87]
    v_cvt_pk_bf16_f32 v56, v56, v57
    v_cvt_pk_bf16_f32 v57, v58, v59
    v_cvt_pk_bf16_f32 v58, v60, v61
    v_cvt_pk_bf16_f32 v59, v62, v63
    v_or_b32 v56, 1, v56
    v_or_b32 v58, 1, v58
    s_movk_i32 s34, 4096
    buffer_store_dwordx4 v[56:59], v0, s[20:23], s34 offen offset:0 sc1
    s_waitcnt lgkmcnt(10)
    v_mfma_f32_32x32x16_bf16 v[72:87], a[252:255], a[188:191], v[72:87]
    v_accvgpr_read_b32 v64, a56
    v_accvgpr_read_b32 v65, a57
    v_accvgpr_read_b32 v66, a58
    v_accvgpr_read_b32 v67, a59
    v_accvgpr_read_b32 v68, a60
    v_accvgpr_read_b32 v69, a61
    v_accvgpr_read_b32 v70, a62
    v_accvgpr_read_b32 v71, a63
    s_waitcnt lgkmcnt(8)
    v_mfma_f32_32x32x16_bf16 v[72:87], v[112:115], a[192:195], v[72:87]
    v_cvt_pk_bf16_f32 v64, v64, v65
    v_cvt_pk_bf16_f32 v65, v66, v67
    v_cvt_pk_bf16_f32 v66, v68, v69
    v_cvt_pk_bf16_f32 v67, v70, v71
    v_or_b32 v64, 1, v64
    v_or_b32 v66, 1, v66
    s_movk_i32 s34, 4096
    buffer_store_dwordx4 v[64:67], v0, s[20:23], s34 offen offset:1024 sc1
    s_waitcnt lgkmcnt(6)
    v_mfma_f32_32x32x16_bf16 v[72:87], v[116:119], a[196:199], v[72:87]
    ds_read_b64_tr_b16 a[244:245], v13 offset:36864
    ds_read_b64_tr_b16 a[246:247], v13 offset:37888
    ds_read_b64_tr_b16 a[248:249], v13 offset:40960
    ds_read_b64_tr_b16 a[250:251], v13 offset:41984
    ds_read_b64_tr_b16 a[252:253], v13 offset:45056
    ds_read_b64_tr_b16 a[254:255], v13 offset:46080
    ds_read_b64_tr_b16 v[112:113], v13 offset:49152
    ds_read_b64_tr_b16 v[114:115], v13 offset:50176
    s_waitcnt lgkmcnt(12)
    v_mfma_f32_32x32x16_bf16 v[72:87], v[120:123], a[200:203], v[72:87]
    ds_read_b64_tr_b16 v[116:117], v13 offset:53248
    ds_read_b64_tr_b16 v[118:119], v13 offset:54272
    ds_read_b64_tr_b16 v[120:121], v13 offset:57344
    ds_read_b64_tr_b16 v[122:123], v13 offset:58368
    s_waitcnt lgkmcnt(14)
    v_mfma_f32_32x32x16_bf16 v[72:87], v[124:127], a[204:207], v[72:87]
    ds_read_b64_tr_b16 v[124:125], v13 offset:61440
    ds_read_b64_tr_b16 v[126:127], v13 offset:62464
    s_waitcnt lgkmcnt(14)
    v_mfma_f32_32x32x16_bf16 v[72:87], a[240:243], a[80:83], v[72:87]
    ds_read_b64_tr_b16 a[240:241], v1 offset:16384
    ds_read_b64_tr_b16 a[242:243], v1 offset:17408
    s_waitcnt vmcnt(12)
    v_bitop3_b32 v212, v184, v186, 1 bitop3:0x80
    s_waitcnt vmcnt(11)
    v_bitop3_b32 v212, v188, v190, v212 bitop3:0x80
    s_waitcnt vmcnt(10)
    v_bitop3_b32 v212, v192, v194, v212 bitop3:0x80
    s_waitcnt vmcnt(9)
    v_bitop3_b32 v212, v196, v198, v212 bitop3:0x80
    s_waitcnt vmcnt(8)
    v_bitop3_b32 v212, v200, v202, v212 bitop3:0x80
    s_waitcnt vmcnt(7)
    v_bitop3_b32 v212, v204, v206, v212 bitop3:0x80
    s_waitcnt lgkmcnt(14)
    v_mfma_f32_32x32x16_bf16 v[72:87], a[244:247], a[84:87], v[72:87]
    s_waitcnt vmcnt(6)
    v_bitop3_b32 v212, v208, v210, v212 bitop3:0x80
    v_cmp_eq_u32 vcc, 0, v212
    s_nop 0
    s_and_b64 vcc, vcc, s[66:67]
    s_cbranch_scc0 K1_RBACK_4
    s_mov_b32 s30, 0
K1_RLOOP_4:
    s_xor_b32 s99, s26, 65536
    buffer_load_dwordx4 v[184:187], v10, s[16:19], s99 offen sc1
    s_xor_b32 s99, s26, 131072
    buffer_load_dwordx4 v[188:191], v10, s[16:19], s99 offen sc1
    s_xor_b32 s99, s26, 196608
    buffer_load_dwordx4 v[192:195], v10, s[16:19], s99 offen sc1
    s_xor_b32 s99, s26, 262144
    buffer_load_dwordx4 v[196:199], v10, s[16:19], s99 offen sc1
    s_xor_b32 s99, s26, 327680
    buffer_load_dwordx4 v[200:203], v10, s[16:19], s99 offen sc1
    s_xor_b32 s99, s26, 393216
    buffer_load_dwordx4 v[204:207], v10, s[16:19], s99 offen sc1
    s_xor_b32 s99, s26, 458752
    buffer_load_dwordx4 v[208:211], v10, s[16:19], s99 offen sc1
    s_add_u32 s30, s30, 1
    s_waitcnt vmcnt(0)
    s_cmp_gt_u32 s30, 0x30000
    s_cbranch_scc1 K1_RBACK_4
    v_bitop3_b32 v212, v184, v186, 1 bitop3:0x80
    v_bitop3_b32 v212, v188, v190, v212 bitop3:0x80
    v_bitop3_b32 v212, v192, v194, v212 bitop3:0x80
    v_bitop3_b32 v212, v196, v198, v212 bitop3:0x80
    v_bitop3_b32 v212, v200, v202, v212 bitop3:0x80
    v_bitop3_b32 v212, v204, v206, v212 bitop3:0x80
    v_bitop3_b32 v212, v208, v210, v212 bitop3:0x80
    v_cmp_eq_u32 vcc, 0, v212
    s_nop 0
    s_and_b64 vcc, vcc, s[66:67]
    s_cbranch_scc1 K1_RLOOP_4
K1_RBACK_4:
    v_mfma_f32_32x32x16_bf16 a[64:79], v[88:91], v[184:187], a[64:79]
    s_waitcnt lgkmcnt(12)
    v_mfma_f32_32x32x16_bf16 v[72:87], a[248:251], a[88:91], v[72:87]
    ds_read_b64_tr_b16 a[244:245], v1 offset:20480
    ds_read_b64_tr_b16 a[246:247], v1 offset:21504
    v_mfma_f32_32x32x16_bf16 a[64:79], v[88:91], v[188:191], a[64:79]
    v_mfma_f32_32x32x16_bf16 a[64:79], v[88:91], v[192:195], a[64:79]
    s_waitcnt lgkmcnt(12)
    v_mfma_f32_32x32x16_bf16 v[72:87], a[252:255], a[92:95], v[72:87]
    ds_read_b64_tr_b16 a[248:249], v1 offset:24576
    ds_read_b64_tr_b16 a[250:251], v1 offset:25600
    v_mfma_f32_32x32x16_bf16 a[64:79], v[88:91], v[196:199], a[64:79]
    v_mfma_f32_32x32x16_bf16 a[64:79], v[88:91], v[200:203], a[64:79]
    s_waitcnt lgkmcnt(12)
    v_mfma_f32_32x32x16_bf16 v[72:87], v[112:115], a[96:99], v[72:87]
    ds_read_b64_tr_b16 a[252:253], v1 offset:28672
    ds_read_b64_tr_b16 a[254:255], v1 offset:29696
    v_mfma_f32_32x32x16_bf16 a[64:79], v[88:91], v[204:207], a[64:79]
    s_branch K1_TJ11
K1_TP11:
    s_setpc_b64 s[30:31]
K1_TJ11:
    v_mfma_f32_32x32x16_bf16 a[64:79], v[88:91], v[208:211], a[64:79]
    s_waitcnt lgkmcnt(12)
    v_mfma_f32_32x32x16_bf16 v[72:87], v[116:119], a[100:103], v[72:87]
    ds_read_b64_tr_b16 v[112:113], v32 offset:0
    ds_read_b64_tr_b16 v[114:115], v32 offset:1024
    s_xor_b32 s99, s26, 131072
    buffer_load_dwordx4 v[160:163], v0, s[16:19], s99 offen offset:0 sc1
    s_waitcnt lgkmcnt(12)
    v_mfma_f32_32x32x16_bf16 v[72:87], v[120:123], a[104:107], v[72:87]
    s_nop 3
    v_accvgpr_read_b32 v104, a64
    v_accvgpr_read_b32 v105, a65
    v_accvgpr_read_b32 v106, a66
    v_accvgpr_read_b32 v107, a67
    v_accvgpr_read_b32 v108, a68
    v_accvgpr_read_b32 v109, a69
    v_accvgpr_read_b32 v110, a70
    v_accvgpr_read_b32 v111, a71
    s_waitcnt lgkmcnt(10)
    v_mfma_f32_32x32x16_bf16 v[72:87], v[124:127], a[108:111], v[72:87]
    ds_read_b64_tr_b16 v[116:117], v32 offset:4096
    ds_read_b64_tr_b16 v[118:119], v32 offset:5120
    v_cvt_pk_bf16_f32 v104, v104, v105
    v_cvt_pk_bf16_f32 v105, v106, v107
    v_cvt_pk_bf16_f32 v106, v108, v109
    v_cvt_pk_bf16_f32 v107, v110, v111
    buffer_store_dwordx4 v[104:107], v9, s[12:15], s92 offen
    s_waitcnt lgkmcnt(10)
    v_mfma_f32_32x32x16_bf16 v[72:87], a[240:243], v[224:227], v[72:87]
    ds_read_b64_tr_b16 v[120:121], v32 offset:8192
    ds_read_b64_tr_b16 v[122:123], v32 offset:9216
    s_xor_b32 s99, s26, 131072
    buffer_load_dwordx4 v[164:167], v0, s[16:19], s99 offen offset:1024 sc1
    s_waitcnt lgkmcnt(10)
    v_mfma_f32_32x32x16_bf16 v[72:87], a[244:247], v[228:231], v[72:87]
    ds_read_b64_tr_b16 v[124:125], v32 offset:12288
    ds_read_b64_tr_b16 v[126:127], v32 offset:13312
    s_xor_b32 s99, s26, 262144
    buffer_load_dwordx4 v[168:171], v0, s[16:19], s99 offen offset:2048 sc1
    s_waitcnt lgkmcnt(10)
    v_mfma_f32_32x32x16_bf16 v[72:87], a[248:251], v[232:235], v[72:87]
    ds_read_b64_tr_b16 a[240:241], v32 offset:16384
    ds_read_b64_tr_b16 a[242:243], v32 offset:17408
    s_xor_b32 s99, s26, 262144
    buffer_load_dwordx4 v[172:175], v0, s[16:19], s99 offen offset:3072 sc1
    s_waitcnt lgkmcnt(10)
    v_mfma_f32_32x32x16_bf16 v[72:87], a[252:255], v[236:239], v[72:87]
    ds_read_b64_tr_b16 a[244:245], v32 offset:20480
    ds_read_b64_tr_b16 a[246:247], v32 offset:21504
    ds_read_b64_tr_b16 a[248:249], v32 offset:24576
    ds_read_b64_tr_b16 a[250:251], v32 offset:25600
    ds_read_b64_tr_b16 a[252:253], v32 offset:28672
    ds_read_b64_tr_b16 a[254:255], v32 offset:29696
    s_waitcnt lgkmcnt(14)
    v_mfma_f32_32x32x16_bf16 v[72:87], v[112:115], v[240:243], v[72:87]
    ds_read_b64_tr_b16 v[112:113], v32 offset:49152
    ds_read_b64_tr_b16 v[114:115], v32 offset:50176
    s_waitcnt lgkmcnt(14)
    v_mfma_f32_32x32x16_bf16 v[72:87], v[116:119], v[244:247], v[72:87]
    ds_read_b64_tr_b16 v[116:117], v32 offset:53248
    ds_read_b64_tr_b16 v[118:119], v32 offset:54272
    s_waitcnt lgkmcnt(14)
    v_mfma_f32_32x32x16_bf16 v[72:87], v[120:123], v[248:251], v[72:87]
    ds_read_b64_tr_b16 v[120:121], v32 offset:57344
    ds_read_b64_tr_b16 v[122:123], v32 offset:58368
    s_xor_b32 s99, s26, 397312
    buffer_load_dwordx4 v[176:179], v0, s[16:19], s99 offen offset:0 sc1
    s_waitcnt lgkmcnt(14)
    v_mfma_f32_32x32x16_bf16 v[72:87], v[124:127], v[252:255], v[72:87]
    ds_read_b64_tr_b16 v[124:125], v32 offset:61440
    ds_read_b64_tr_b16 v[126:127], v32 offset:62464
    s_xor_b32 s99, s26, 397312
    buffer_load_dwordx4 v[180:183], v0, s[16:19], s99 offen offset:1024 sc1
    s_waitcnt lgkmcnt(14)
    v_mfma_f32_32x32x16_bf16 v[72:87], a[240:243], a[208:211], v[72:87]
    s_waitcnt lgkmcnt(12)
    v_mfma_f32_32x32x16_bf16 v[72:87], a[244:247], a[212:215], v[72:87]
    s_waitcnt lgkmcnt(10)
    v_mfma_f32_32x32x16_bf16 v[72:87], a[248:251], a[216:219], v[72:87]
    s_waitcnt lgkmcnt(8)
    v_mfma_f32_32x32x16_bf16 v[72:87], a[252:255], a[220:223], v[72:87]
    s_waitcnt lgkmcnt(6)
    v_mfma_f32_32x32x16_bf16 v[72:87], v[112:115], a[224:227], v[72:87]
    s_waitcnt lgkmcnt(4)
    v_mfma_f32_32x32x16_bf16 v[72:87], v[116:119], a[228:231], v[72:87]
    s_waitcnt lgkmcnt(2)
    v_mfma_f32_32x32x16_bf16 v[72:87], v[120:123], a[232:235], v[72:87]
    s_waitcnt lgkmcnt(0)
    v_mfma_f32_32x32x16_bf16 v[72:87], v[124:127], a[236:239], v[72:87]
    s_waitcnt vmcnt(6)
    v_bitop3_b32 v212, v160, v162, 1 bitop3:0x80
    s_waitcnt vmcnt(4)
    v_bitop3_b32 v212, v164, v166, v212 bitop3:0x80
    v_cmp_eq_u32 vcc, 0, v212
    s_nop 0
    s_or_b64 vcc, vcc, vcc
    s_cbranch_scc0 K1_RBACK_1
    s_mov_b32 s30, 0
K1_RLOOP_1:
    s_xor_b32 s99, s26, 131072
    buffer_load_dwordx4 v[160:163], v0, s[16:19], s99 offen offset:0 sc1
    s_xor_b32 s99, s26, 131072
    buffer_load_dwordx4 v[164:167], v0, s[16:19], s99 offen offset:1024 sc1
    s_xor_b32 s99, s26, 262144
    buffer_load_dwordx4 v[168:171], v0, s[16:19], s99 offen offset:2048 sc1
    s_xor_b32 s99, s26, 262144
    buffer_load_dwordx4 v[172:175], v0, s[16:19], s99 offen offset:3072 sc1
    s_xor_b32 s99, s26, 397312
    buffer_load_dwordx4 v[176:179], v0, s[16:19], s99 offen offset:0 sc1
    s_xor_b32 s99, s26, 397312
    buffer_load_dwordx4 v[180:183], v0, s[16:19], s99 offen offset:1024 sc1
    s_add_u32 s30, s30, 1
    s_waitcnt vmcnt(0)
    s_cmp_gt_u32 s30, 0x30000
    s_cbranch_scc1 K1_RBACK_1
    v_bitop3_b32 v212, v160, v162, 1 bitop3:0x80
    v_bitop3_b32 v212, v164, v166, v212 bitop3:0x80
    v_cmp_eq_u32 vcc, 0, v212
    s_nop 0
    s_or_b64 vcc, vcc, vcc
    s_cbranch_scc1 K1_RLOOP_1
K1_RBACK_1:
    v_mfma_f32_32x32x16_bf16 v[72:87], v[88:91], v[160:163], v[72:87]
    v_mfma_f32_32x32x16_bf16 v[72:87], v[92:95], v[164:167], v[72:87]
    s_waitcnt vmcnt(3)
    v_bitop3_b32 v212, v168, v170, 1 bitop3:0x80
    s_waitcnt vmcnt(2)
    v_bitop3_b32 v212, v172, v174, v212 bitop3:0x80
    v_cmp_eq_u32 vcc, 0, v212
    s_nop 0
    s_or_b64 vcc, vcc, vcc
    s_cbranch_scc0 K1_RBACK_2
    s_mov_b32 s30, 0
K1_RLOOP_2:
    s_xor_b32 s99, s26, 262144
    buffer_load_dwordx4 v[168:171], v0, s[16:19], s99 offen offset:2048 sc1
    s_xor_b32 s99, s26, 262144
    buffer_load_dwordx4 v[172:175], v0, s[16:19], s99 offen offset:3072 sc1
    s_xor_b32 s99, s26, 397312
    buffer_load_dwordx4 v[176:179], v0, s[16:19], s99 offen offset:0 sc1
    s_xor_b32 s99, s26, 397312
    buffer_load_dwordx4 v[180:183], v0, s[16:19], s99 offen offset:1024 sc1
    s_add_u32 s30, s30, 1
    s_waitcnt vmcnt(0)
    s_cmp_gt_u32 s30, 0x30000
    s_cbranch_scc1 K1_RBACK_2
    v_bitop3_b32 v212, v168, v170, 1 bitop3:0x80
    v_bitop3_b32 v212, v172, v174, v212 bitop3:0x80
    v_cmp_eq_u32 vcc, 0, v212
    s_nop 0
    s_or_b64 vcc, vcc, vcc
    s_cbranch_scc1 K1_RLOOP_2
K1_RBACK_2:
    v_mfma_f32_32x32x16_bf16 v[72:87], v[88:91], v[168:171], v[72:87]
    v_mfma_f32_32x32x16_bf16 v[72:87], v[92:95], v[172:175], v[72:87]
    s_waitcnt vmcnt(1)
    v_bitop3_b32 v212, v176, v178, 1 bitop3:0x80
    s_waitcnt vmcnt(0)
    v_bitop3_b32 v212, v180, v182, v212 bitop3:0x80
    v_cmp_eq_u32 vcc, 0, v212
    s_nop 0
    s_or_b64 vcc, vcc, vcc
    s_cbranch_scc0 K1_RBACK_3
    s_mov_b32 s30, 0
K1_RLOOP_3:
    s_xor_b32 s99, s26, 397312
    buffer_load_dwordx4 v[176:179], v0, s[16:19], s99 offen offset:0 sc1
    s_xor_b32 s99, s26, 397312
    buffer_load_dwordx4 v[180:183], v0, s[16:19], s99 offen offset:1024 sc1
    s_add_u32 s30, s30, 1
    s_waitcnt vmcnt(0)
    s_cmp_gt_u32 s30, 0x30000
    s_cbranch_scc1 K1_RBACK_3
    v_bitop3_b32 v212, v176, v178, 1 bitop3:0x80
    v_bitop3_b32 v212, v180, v182, v212 bitop3:0x80
    v_cmp_eq_u32 vcc, 0, v212
    s_nop 0
    s_or_b64 vcc, vcc, vcc
    s_cbranch_scc1 K1_RLOOP_3
K1_RBACK_3:
    v_mfma_f32_32x32x16_bf16 v[72:87], v[88:91], v[176:179], v[72:87]
    v_mfma_f32_32x32x16_bf16 v[72:87], v[92:95], v[180:183], v[72:87]
    s_nop 11
    v_cvt_pk_bf16_f32 v72, v72, v73
    v_cvt_pk_bf16_f32 v73, v74, v75
    v_cvt_pk_bf16_f32 v74, v76, v77
    v_cvt_pk_bf16_f32 v75, v78, v79
    buffer_store_dwordx4 v[72:75], v9, s[12:15], 0 offen offset:0
    v_cvt_pk_bf16_f32 v80, v80, v81
    v_cvt_pk_bf16_f32 v81, v82, v83
    v_cvt_pk_bf16_f32 v82, v84, v85
    v_cvt_pk_bf16_f32 v83, v86, v87
    buffer_store_dwordx4 v[80:83], v9, s[12:15], 0 offen offset:32
K1_FIN:
K1_END:
K1_LAST:
    s_endpgm
K1_STUB_1:
    s_call_b64 s[30:31], K1_RARE_101
    s_branch K1_BACK_1
K1_STUB_2:
    s_call_b64 s[30:31], K1_RARE_001
    s_branch K1_BACK_2
K1_STUB_3:
    s_call_b64 s[30:31], K1_RARE_101
    s_branch K1_BACK_3
K1_STUB_4:
    s_call_b64 s[30:31], K1_RARE_001
    s_branch K1_BACK_4
K1_STUB_5:
    s_call_b64 s[30:31], K1_RARE_101
    s_branch K1_BACK_5
K1_STUB_6:
    s_call_b64 s[30:31], K1_RARE_001
    s_branch K1_BACK_6
K1_STUB_7:
    s_call_b64 s[30:31], K1_RARE_101
    s_branch K1_BACK_7
K1_STUB_8:
    s_call_b64 s[30:31], K1_RARE_001
    s_branch K1_BACK_8
K1_STUB_9:
    s_call_b64 s[30:31], K1_RARE_101
    s_branch K1_BACK_9
K1_STUB_10:
    s_call_b64 s[30:31], K1_RARE_001
    s_branch K1_BACK_10
K1_STUB_11:
    s_call_b64 s[30:31], K1_RARE_101
    s_branch K1_BACK_11
K1_STUB_12:
    s_call_b64 s[30:31], K1_RARE_001
    s_branch K1_BACK_12
K1_STUB_13:
    s_call_b64 s[30:31], K1_RARE_101
    s_branch K1_BACK_13
K1_STUB_14:
    s_call_b64 s[30:31], K1_RARE_001
    s_branch K1_BACK_14
K1_STUB_15:
    s_call_b64 s[30:31], K1_RARE_100
    s_branch K1_BACK_15
K1_STUB_17:
    s_call_b64 s[30:31], K1_RARE_111
    s_branch K1_BACK_17
K1_STUB_18:
    s_call_b64 s[30:31], K1_RARE_011
    s_branch K1_BACK_18
K1_STUB_19:
    s_call_b64 s[30:31], K1_RARE_111
    s_branch K1_BACK_19
K1_STUB_20:
    s_call_b64 s[30:31], K1_RARE_011
    s_branch K1_BACK_20
K1_STUB_21:
    s_call_b64 s[30:31], K1_RARE_111
    s_branch K1_BACK_21
K1_STUB_22:
    s_call_b64 s[30:31], K1_RARE_011
    s_branch K1_BACK_22
K1_STUB_23:
    s_call_b64 s[30:31], K1_RARE_111
    s_branch K1_BACK_23
K1_STUB_24:
    s_call_b64 s[30:31], K1_RARE_011
    s_branch K1_BACK_24
K1_STUB_25:
    s_call_b64 s[30:31], K1_RARE_111
    s_branch K1_BACK_25
K1_STUB_26:
    s_call_b64 s[30:31], K1_RARE_011
    s_branch K1_BACK_26
K1_STUB_27:
    s_call_b64 s[30:31], K1_RARE_111
    s_branch K1_BACK_27
K1_STUB_28:
    s_call_b64 s[30:31], K1_RARE_011
    s_branch K1_BACK_28
K1_STUB_29:
    s_call_b64 s[30:31], K1_RARE_111
    s_branch K1_BACK_29
K1_STUB_30:
    s_call_b64 s[30:31], K1_RARE_011
    s_branch K1_BACK_30
K1_STUB_31:
    s_call_b64 s[30:31], K1_RARE_110
    s_branch K1_BACK_31
K1_RARE_101:
    s_nop 15
    v_max3_f32 v30, v56, v57, v58
    v_max3_f32 v31, v59, v60, v61
    v_max3_f32 v30, v30, v62, v63
    v_max3_f32 v31, v31, v64, v65
    v_max3_f32 v30, v30, v66, v67
    v_max3_f32 v31, v31, v68, v69
    v_max3_f32 v30, v30, v70, v71
    v_max_f32 v30, v30, v31
    v_mov_b32 v31, v30
    s_nop 1
    v_permlane32_swap_b32 v30, v31
    v_max_f32 v30, v30, v31
    v_max_f32 v30, 0, v30
    v_sub_f32 v31, 0, v30
    v_exp_f32 v31, v31
    v_sub_f32 v56, v56, v30
    v_sub_f32 v72, v72, v30
    v_sub_f32 v40, v40, v30
    v_sub_f32 v57, v57, v30
    v_sub_f32 v73, v73, v30
    v_sub_f32 v41, v41, v30
    v_sub_f32 v58, v58, v30
    v_sub_f32 v74, v74, v30
    v_sub_f32 v42, v42, v30
    v_sub_f32 v59, v59, v30
    v_sub_f32 v75, v75, v30
    v_sub_f32 v43, v43, v30
    v_sub_f32 v60, v60, v30
    v_sub_f32 v76, v76, v30
    v_sub_f32 v44, v44, v30
    v_sub_f32 v61, v61, v30
    v_sub_f32 v77, v77, v30
    v_sub_f32 v45, v45, v30
    v_sub_f32 v62, v62, v30
    v_sub_f32 v78, v78, v30
    v_sub_f32 v46, v46, v30
    v_sub_f32 v63, v63, v30
    v_sub_f32 v79, v79, v30
    v_sub_f32 v47, v47, v30
    v_sub_f32 v64, v64, v30
    v_sub_f32 v80, v80, v30
    v_sub_f32 v48, v48, v30
    v_sub_f32 v65, v65, v30
    v_sub_f32 v81, v81, v30
    v_sub_f32 v49, v49, v30
    v_sub_f32 v66, v66, v30
    v_sub_f32 v82, v82, v30
    v_sub_f32 v50, v50, v30
    v_sub_f32 v67, v67, v30
    v_sub_f32 v83, v83, v30
    v_sub_f32 v51, v51, v30
    v_sub_f32 v68, v68, v30
    v_sub_f32 v84, v84, v30
    v_sub_f32 v52, v52, v30
    v_sub_f32 v69, v69, v30
    v_sub_f32 v85, v85, v30
    v_sub_f32 v53, v53, v30
    v_sub_f32 v70, v70, v30
    v_sub_f32 v86, v86, v30
    v_sub_f32 v54, v54, v30
    v_sub_f32 v71, v71, v30
    v_sub_f32 v87, v87, v30
    v_sub_f32 v55, v55, v30
    v_mul_f32 v28, v28, v31
    v_accvgpr_read_b32 v104, a144
    v_mul_f32 v104, v104, v31
    v_accvgpr_write_b32 a144, v104
    v_accvgpr_read_b32 v104, a145
    v_mul_f32 v104, v104, v31
    v_accvgpr_write_b32 a145, v104
    v_accvgpr_read_b32 v104, a146
    v_mul_f32 v104, v104, v31
    v_accvgpr_write_b32 a146, v104
    v_accvgpr_read_b32 v104, a147
    v_mul_f32 v104, v104, v31
    v_accvgpr_write_b32 a147, v104
    v_accvgpr_read_b32 v104, a148
    v_mul_f32 v104, v104, v31
    v_accvgpr_write_b32 a148, v104
    v_accvgpr_read_b32 v104, a149
    v_mul_f32 v104, v104, v31
    v_accvgpr_write_b32 a149, v104
    v_accvgpr_read_b32 v104, a150
    v_mul_f32 v104, v104, v31
    v_accvgpr_write_b32 a150, v104
    v_accvgpr_read_b32 v104, a151
    v_mul_f32 v104, v104, v31
    v_accvgpr_write_b32 a151, v104
    v_accvgpr_read_b32 v104, a152
    v_mul_f32 v104, v104, v31
    v_accvgpr_write_b32 a152, v104
    v_accvgpr_read_b32 v104, a153
    v_mul_f32 v104, v104, v31
    v_accvgpr_write_b32 a153, v104
    v_accvgpr_read_b32 v104, a154
    v_mul_f32 v104, v104, v31
    v_accvgpr_write_b32 a154, v104
    v_accvgpr_read_b32 v104, a155
    v_mul_f32 v104, v104, v31
    v_accvgpr_write_b32 a155, v104
    v_accvgpr_read_b32 v104, a156
    v_mul_f32 v104, v104, v31
    v_accvgpr_write_b32 a156, v104
    v_accvgpr_read_b32 v104, a157
    v_mul_f32 v104, v104, v31
    v_accvgpr_write_b32 a157, v104
    v_accvgpr_read_b32 v104, a158
    v_mul_f32 v104, v104, v31
    v_accvgpr_write_b32 a158, v104
    v_accvgpr_read_b32 v104, a159
    v_mul_f32 v104, v104, v31
    v_accvgpr_write_b32 a159, v104
    v_accvgpr_read_b32 v104, a160
    v_mul_f32 v104, v104, v31
    v_accvgpr_write_b32 a160, v104
    v_accvgpr_read_b32 v104, a161
    v_mul_f32 v104, v104, v31
    v_accvgpr_write_b32 a161, v104
    v_accvgpr_read_b32 v104, a162
    v_mul_f32 v104, v104, v31
    v_accvgpr_write_b32 a162, v104
    v_accvgpr_read_b32 v104, a163
    v_mul_f32 v104, v104, v31
    v_accvgpr_write_b32 a163, v104
    v_accvgpr_read_b32 v104, a164
    v_mul_f32 v104, v104, v31
    v_accvgpr_write_b32 a164, v104
    v_accvgpr_read_b32 v104, a165
    v_mul_f32 v104, v104, v31
    v_accvgpr_write_b32 a165, v104
    v_accvgpr_read_b32 v104, a166
    v_mul_f32 v104, v104, v31
    v_accvgpr_write_b32 a166, v104
    v_accvgpr_read_b32 v104, a167
    v_mul_f32 v104, v104, v31
    v_accvgpr_write_b32 a167, v104
    v_accvgpr_read_b32 v104, a168
    v_mul_f32 v104, v104, v31
    v_accvgpr_write_b32 a168, v104
    v_accvgpr_read_b32 v104, a169
    v_mul_f32 v104, v104, v31
    v_accvgpr_write_b32 a169, v104
    v_accvgpr_read_b32 v104, a170
    v_mul_f32 v104, v104, v31
    v_accvgpr_write_b32 a170, v104
    v_accvgpr_read_b32 v104, a171
    v_mul_f32 v104, v104, v31
    v_accvgpr_write_b32 a171, v104
    v_accvgpr_read_b32 v104, a172
    v_mul_f32 v104, v104, v31
    v_accvgpr_write_b32 a172, v104
    v_accvgpr_read_b32 v104, a173
    v_mul_f32 v104, v104, v31
    v_accvgpr_write_b32 a173, v104
    v_accvgpr_read_b32 v104, a174
    v_mul_f32 v104, v104, v31
    v_accvgpr_write_b32 a174, v104
    v_accvgpr_read_b32 v104, a175
    v_mul_f32 v104, v104, v31
    v_accvgpr_write_b32 a175, v104
    v_accvgpr_read_b32 v104, a176
    v_mul_f32 v104, v104, v31
    v_accvgpr_write_b32 a176, v104
    v_accvgpr_read_b32 v104, a177
    v_mul_f32 v104, v104, v31
    v_accvgpr_write_b32 a177, v104
    v_accvgpr_read_b32 v104, a178
    v_mul_f32 v104, v104, v31
    v_accvgpr_write_b32 a178, v104
    v_accvgpr_read_b32 v104, a179
    v_mul_f32 v104, v104, v31
    v_accvgpr_write_b32 a179, v104
    v_accvgpr_read_b32 v104, a180
    v_mul_f32 v104, v104, v31
    v_accvgpr_write_b32 a180, v104
    v_accvgpr_read_b32 v104, a181
    v_mul_f32 v104, v104, v31
    v_accvgpr_write_b32 a181, v104
    v_accvgpr_read_b32 v104, a182
    v_mul_f32 v104, v104, v31
    v_accvgpr_write_b32 a182, v104
    v_accvgpr_read_b32 v104, a183
    v_mul_f32 v104, v104, v31
    v_accvgpr_write_b32 a183, v104
    v_accvgpr_read_b32 v104, a184
    v_mul_f32 v104, v104, v31
    v_accvgpr_write_b32 a184, v104
    v_accvgpr_read_b32 v104, a185
    v_mul_f32 v104, v104, v31
    v_accvgpr_write_b32 a185, v104
    v_accvgpr_read_b32 v104, a186
    v_mul_f32 v104, v104, v31
    v_accvgpr_write_b32 a186, v104
    v_accvgpr_read_b32 v104, a187
    v_mul_f32 v104, v104, v31
    v_accvgpr_write_b32 a187, v104
    v_accvgpr_read_b32 v104, a188
    v_mul_f32 v104, v104, v31
    v_accvgpr_write_b32 a188, v104
    v_accvgpr_read_b32 v104, a189
    v_mul_f32 v104, v104, v31
    v_accvgpr_write_b32 a189, v104
    v_accvgpr_read_b32 v104, a190
    v_mul_f32 v104, v104, v31
    v_accvgpr_write_b32 a190, v104
    v_accvgpr_read_b32 v104, a191
    v_mul_f32 v104, v104, v31
    v_accvgpr_write_b32 a191, v104
    v_accvgpr_read_b32 v104, a192
    v_mul_f32 v104, v104, v31
    v_accvgpr_write_b32 a192, v104
    v_accvgpr_read_b32 v104, a193
    v_mul_f32 v104, v104, v31
    v_accvgpr_write_b32 a193, v104
    v_accvgpr_read_b32 v104, a194
    v_mul_f32 v104, v104, v31
    v_accvgpr_write_b32 a194, v104
    v_accvgpr_read_b32 v104, a195
    v_mul_f32 v104, v104, v31
    v_accvgpr_write_b32 a195, v104
    v_accvgpr_read_b32 v104, a196
    v_mul_f32 v104, v104, v31
    v_accvgpr_write_b32 a196, v104
    v_accvgpr_read_b32 v104, a197
    v_mul_f32 v104, v104, v31
    v_accvgpr_write_b32 a197, v104
    v_accvgpr_read_b32 v104, a198
    v_mul_f32 v104, v104, v31
    v_accvgpr_write_b32 a198, v104
    v_accvgpr_read_b32 v104, a199
    v_mul_f32 v104, v104, v31
    v_accvgpr_write_b32 a199, v104
    v_accvgpr_read_b32 v104, a200
    v_mul_f32 v104, v104, v31
    v_accvgpr_write_b32 a200, v104
    v_accvgpr_read_b32 v104, a201
    v_mul_f32 v104, v104, v31
    v_accvgpr_write_b32 a201, v104
    v_accvgpr_read_b32 v104, a202
    v_mul_f32 v104, v104, v31
    v_accvgpr_write_b32 a202, v104
    v_accvgpr_read_b32 v104, a203
    v_mul_f32 v104, v104, v31
    v_accvgpr_write_b32 a203, v104
    v_accvgpr_read_b32 v104, a204
    v_mul_f32 v104, v104, v31
    v_accvgpr_write_b32 a204, v104
    v_accvgpr_read_b32 v104, a205
    v_mul_f32 v104, v104, v31
    v_accvgpr_write_b32 a205, v104
    v_accvgpr_read_b32 v104, a206
    v_mul_f32 v104, v104, v31
    v_accvgpr_write_b32 a206, v104
    v_accvgpr_read_b32 v104, a207
    v_mul_f32 v104, v104, v31
    v_accvgpr_write_b32 a207, v104
    v_mov_b32 v30, 0
    v_exp_f32 v104, v56
    v_exp_f32 v105, v57
    v_add_f32 v30, v30, v104
    v_add_f32 v30, v30, v105
    v_cvt_pk_bf16_f32 v96, v104, v105
    v_exp_f32 v104, v58
    v_exp_f32 v105, v59
    v_add_f32 v30, v30, v104
    v_add_f32 v30, v30, v105
    v_cvt_pk_bf16_f32 v97, v104, v105
    v_exp_f32 v104, v60
    v_exp_f32 v105, v61
    v_add_f32 v30, v30, v104
    v_add_f32 v30, v30, v105
    v_cvt_pk_bf16_f32 v98, v104, v105
    v_exp_f32 v104, v62
    v_exp_f32 v105, v63
    v_add_f32 v30, v30, v104
    v_add_f32 v30, v30, v105
    v_cvt_pk_bf16_f32 v99, v104, v105
    v_exp_f32 v104, v64
    v_exp_f32 v105, v65
    v_add_f32 v30, v30, v104
    v_add_f32 v30, v30, v105
    v_cvt_pk_bf16_f32 v100, v104, v105
    v_exp_f32 v104, v66
    v_exp_f32 v105, v67
    v_add_f32 v30, v30, v104
    v_add_f32 v30, v30, v105
    v_cvt_pk_bf16_f32 v101, v104, v105
    v_exp_f32 v104, v68
    v_exp_f32 v105, v69
    v_add_f32 v30, v30, v104
    v_add_f32 v30, v30, v105
    v_cvt_pk_bf16_f32 v102, v104, v105
    v_exp_f32 v104, v70
    v_exp_f32 v105, v71
    v_add_f32 v30, v30, v104
    v_add_f32 v30, v30, v105
    v_cvt_pk_bf16_f32 v103, v104, v105
    s_nop 3
    s_setpc_b64 s[30:31]
K1_RARE_001:
    s_nop 15
    v_max3_f32 v30, v40, v41, v42
    v_max3_f32 v31, v43, v44, v45
    v_max3_f32 v30, v30, v46, v47
    v_max3_f32 v31, v31, v48, v49
    v_max3_f32 v30, v30, v50, v51
    v_max3_f32 v31, v31, v52, v53
    v_max3_f32 v30, v30, v54, v55
    v_max_f32 v30, v30, v31
    v_mov_b32 v31, v30
    s_nop 1
    v_permlane32_swap_b32 v30, v31
    v_max_f32 v30, v30, v31
    v_max_f32 v30, 0, v30
    v_sub_f32 v31, 0, v30
    v_exp_f32 v31, v31
    v_sub_f32 v40, v40, v30
    v_sub_f32 v72, v72, v30
    v_sub_f32 v56, v56, v30
    v_sub_f32 v41, v41, v30
    v_sub_f32 v73, v73, v30
    v_sub_f32 v57, v57, v30
    v_sub_f32 v42, v42, v30
    v_sub_f32 v74, v74, v30
    v_sub_f32 v58, v58, v30
    v_sub_f32 v43, v43, v30
    v_sub_f32 v75, v75, v30
    v_sub_f32 v59, v59, v30
    v_sub_f32 v44, v44, v30
    v_sub_f32 v76, v76, v30
    v_sub_f32 v60, v60, v30
    v_sub_f32 v45, v45, v30
    v_sub_f32 v77, v77, v30
    v_sub_f32 v61, v61, v30
    v_sub_f32 v46, v46, v30
    v_sub_f32 v78, v78, v30
    v_sub_f32 v62, v62, v30
    v_sub_f32 v47, v47, v30
    v_sub_f32 v79, v79, v30
    v_sub_f32 v63, v63, v30
    v_sub_f32 v48, v48, v30
    v_sub_f32 v80, v80, v30
    v_sub_f32 v64, v64, v30
    v_sub_f32 v49, v49, v30
    v_sub_f32 v81, v81, v30
    v_sub_f32 v65, v65, v30
    v_sub_f32 v50, v50, v30
    v_sub_f32 v82, v82, v30
    v_sub_f32 v66, v66, v30
    v_sub_f32 v51, v51, v30
    v_sub_f32 v83, v83, v30
    v_sub_f32 v67, v67, v30
    v_sub_f32 v52, v52, v30
    v_sub_f32 v84, v84, v30
    v_sub_f32 v68, v68, v30
    v_sub_f32 v53, v53, v30
    v_sub_f32 v85, v85, v30
    v_sub_f32 v69, v69, v30
    v_sub_f32 v54, v54, v30
    v_sub_f32 v86, v86, v30
    v_sub_f32 v70, v70, v30
    v_sub_f32 v55, v55, v30
    v_sub_f32 v87, v87, v30
    v_sub_f32 v71, v71, v30
    v_mul_f32 v28, v28, v31
    v_accvgpr_read_b32 v104, a144
    v_mul_f32 v104, v104, v31
    v_accvgpr_write_b32 a144, v104
    v_accvgpr_read_b32 v104, a145
    v_mul_f32 v104, v104, v31
    v_accvgpr_write_b32 a145, v104
    v_accvgpr_read_b32 v104, a146
    v_mul_f32 v104, v104, v31
    v_accvgpr_write_b32 a146, v104
    v_accvgpr_read_b32 v104, a147
    v_mul_f32 v104, v104, v31
    v_accvgpr_write_b32 a147, v104
    v_accvgpr_read_b32 v104, a148
    v_mul_f32 v104, v104, v31
    v_accvgpr_write_b32 a148, v104
    v_accvgpr_read_b32 v104, a149
    v_mul_f32 v104, v104, v31
    v_accvgpr_write_b32 a149, v104
    v_accvgpr_read_b32 v104, a150
    v_mul_f32 v104, v104, v31
    v_accvgpr_write_b32 a150, v104
    v_accvgpr_read_b32 v104, a151
    v_mul_f32 v104, v104, v31
    v_accvgpr_write_b32 a151, v104
    v_accvgpr_read_b32 v104, a152
    v_mul_f32 v104, v104, v31
    v_accvgpr_write_b32 a152, v104
    v_accvgpr_read_b32 v104, a153
    v_mul_f32 v104, v104, v31
    v_accvgpr_write_b32 a153, v104
    v_accvgpr_read_b32 v104, a154
    v_mul_f32 v104, v104, v31
    v_accvgpr_write_b32 a154, v104
    v_accvgpr_read_b32 v104, a155
    v_mul_f32 v104, v104, v31
    v_accvgpr_write_b32 a155, v104
    v_accvgpr_read_b32 v104, a156
    v_mul_f32 v104, v104, v31
    v_accvgpr_write_b32 a156, v104
    v_accvgpr_read_b32 v104, a157
    v_mul_f32 v104, v104, v31
    v_accvgpr_write_b32 a157, v104
    v_accvgpr_read_b32 v104, a158
    v_mul_f32 v104, v104, v31
    v_accvgpr_write_b32 a158, v104
    v_accvgpr_read_b32 v104, a159
    v_mul_f32 v104, v104, v31
    v_accvgpr_write_b32 a159, v104
    v_accvgpr_read_b32 v104, a160
    v_mul_f32 v104, v104, v31
    v_accvgpr_write_b32 a160, v104
    v_accvgpr_read_b32 v104, a161
    v_mul_f32 v104, v104, v31
    v_accvgpr_write_b32 a161, v104
    v_accvgpr_read_b32 v104, a162
    v_mul_f32 v104, v104, v31
    v_accvgpr_write_b32 a162, v104
    v_accvgpr_read_b32 v104, a163
    v_mul_f32 v104, v104, v31
    v_accvgpr_write_b32 a163, v104
    v_accvgpr_read_b32 v104, a164
    v_mul_f32 v104, v104, v31
    v_accvgpr_write_b32 a164, v104
    v_accvgpr_read_b32 v104, a165
    v_mul_f32 v104, v104, v31
    v_accvgpr_write_b32 a165, v104
    v_accvgpr_read_b32 v104, a166
    v_mul_f32 v104, v104, v31
    v_accvgpr_write_b32 a166, v104
    v_accvgpr_read_b32 v104, a167
    v_mul_f32 v104, v104, v31
    v_accvgpr_write_b32 a167, v104
    v_accvgpr_read_b32 v104, a168
    v_mul_f32 v104, v104, v31
    v_accvgpr_write_b32 a168, v104
    v_accvgpr_read_b32 v104, a169
    v_mul_f32 v104, v104, v31
    v_accvgpr_write_b32 a169, v104
    v_accvgpr_read_b32 v104, a170
    v_mul_f32 v104, v104, v31
    v_accvgpr_write_b32 a170, v104
    v_accvgpr_read_b32 v104, a171
    v_mul_f32 v104, v104, v31
    v_accvgpr_write_b32 a171, v104
    v_accvgpr_read_b32 v104, a172
    v_mul_f32 v104, v104, v31
    v_accvgpr_write_b32 a172, v104
    v_accvgpr_read_b32 v104, a173
    v_mul_f32 v104, v104, v31
    v_accvgpr_write_b32 a173, v104
    v_accvgpr_read_b32 v104, a174
    v_mul_f32 v104, v104, v31
    v_accvgpr_write_b32 a174, v104
    v_accvgpr_read_b32 v104, a175
    v_mul_f32 v104, v104, v31
    v_accvgpr_write_b32 a175, v104
    v_accvgpr_read_b32 v104, a176
    v_mul_f32 v104, v104, v31
    v_accvgpr_write_b32 a176, v104
    v_accvgpr_read_b32 v104, a177
    v_mul_f32 v104, v104, v31
    v_accvgpr_write_b32 a177, v104
    v_accvgpr_read_b32 v104, a178
    v_mul_f32 v104, v104, v31
    v_accvgpr_write_b32 a178, v104
    v_accvgpr_read_b32 v104, a179
    v_mul_f32 v104, v104, v31
    v_accvgpr_write_b32 a179, v104
    v_accvgpr_read_b32 v104, a180
    v_mul_f32 v104, v104, v31
    v_accvgpr_write_b32 a180, v104
    v_accvgpr_read_b32 v104, a181
    v_mul_f32 v104, v104, v31
    v_accvgpr_write_b32 a181, v104
    v_accvgpr_read_b32 v104, a182
    v_mul_f32 v104, v104, v31
    v_accvgpr_write_b32 a182, v104
    v_accvgpr_read_b32 v104, a183
    v_mul_f32 v104, v104, v31
    v_accvgpr_write_b32 a183, v104
    v_accvgpr_read_b32 v104, a184
    v_mul_f32 v104, v104, v31
    v_accvgpr_write_b32 a184, v104
    v_accvgpr_read_b32 v104, a185
    v_mul_f32 v104, v104, v31
    v_accvgpr_write_b32 a185, v104
    v_accvgpr_read_b32 v104, a186
    v_mul_f32 v104, v104, v31
    v_accvgpr_write_b32 a186, v104
    v_accvgpr_read_b32 v104, a187
    v_mul_f32 v104, v104, v31
    v_accvgpr_write_b32 a187, v104
    v_accvgpr_read_b32 v104, a188
    v_mul_f32 v104, v104, v31
    v_accvgpr_write_b32 a188, v104
    v_accvgpr_read_b32 v104, a189
    v_mul_f32 v104, v104, v31
    v_accvgpr_write_b32 a189, v104
    v_accvgpr_read_b32 v104, a190
    v_mul_f32 v104, v104, v31
    v_accvgpr_write_b32 a190, v104
    v_accvgpr_read_b32 v104, a191
    v_mul_f32 v104, v104, v31
    v_accvgpr_write_b32 a191, v104
    v_accvgpr_read_b32 v104, a192
    v_mul_f32 v104, v104, v31
    v_accvgpr_write_b32 a192, v104
    v_accvgpr_read_b32 v104, a193
    v_mul_f32 v104, v104, v31
    v_accvgpr_write_b32 a193, v104
    v_accvgpr_read_b32 v104, a194
    v_mul_f32 v104, v104, v31
    v_accvgpr_write_b32 a194, v104
    v_accvgpr_read_b32 v104, a195
    v_mul_f32 v104, v104, v31
    v_accvgpr_write_b32 a195, v104
    v_accvgpr_read_b32 v104, a196
    v_mul_f32 v104, v104, v31
    v_accvgpr_write_b32 a196, v104
    v_accvgpr_read_b32 v104, a197
    v_mul_f32 v104, v104, v31
    v_accvgpr_write_b32 a197, v104
    v_accvgpr_read_b32 v104, a198
    v_mul_f32 v104, v104, v31
    v_accvgpr_write_b32 a198, v104
    v_accvgpr_read_b32 v104, a199
    v_mul_f32 v104, v104, v31
    v_accvgpr_write_b32 a199, v104
    v_accvgpr_read_b32 v104, a200
    v_mul_f32 v104, v104, v31
    v_accvgpr_write_b32 a200, v104
    v_accvgpr_read_b32 v104, a201
    v_mul_f32 v104, v104, v31
    v_accvgpr_write_b32 a201, v104
    v_accvgpr_read_b32 v104, a202
    v_mul_f32 v104, v104, v31
    v_accvgpr_write_b32 a202, v104
    v_accvgpr_read_b32 v104, a203
    v_mul_f32 v104, v104, v31
    v_accvgpr_write_b32 a203, v104
    v_accvgpr_read_b32 v104, a204
    v_mul_f32 v104, v104, v31
    v_accvgpr_write_b32 a204, v104
    v_accvgpr_read_b32 v104, a205
    v_mul_f32 v104, v104, v31
    v_accvgpr_write_b32 a205, v104
    v_accvgpr_read_b32 v104, a206
    v_mul_f32 v104, v104, v31
    v_accvgpr_write_b32 a206, v104
    v_accvgpr_read_b32 v104, a207
    v_mul_f32 v104, v104, v31
    v_accvgpr_write_b32 a207, v104
    v_mov_b32 v30, 0
    v_exp_f32 v104, v40
    v_exp_f32 v105, v41
    v_add_f32 v30, v30, v104
    v_add_f32 v30, v30, v105
    v_cvt_pk_bf16_f32 v88, v104, v105
    v_exp_f32 v104, v42
    v_exp_f32 v105, v43
    v_add_f32 v30, v30, v104
    v_add_f32 v30, v30, v105
    v_cvt_pk_bf16_f32 v89, v104, v105
    v_exp_f32 v104, v44
    v_exp_f32 v105, v45
    v_add_f32 v30, v30, v104
    v_add_f32 v30, v30, v105
    v_cvt_pk_bf16_f32 v90, v104, v105
    v_exp_f32 v104, v46
    v_exp_f32 v105, v47
    v_add_f32 v30, v30, v104
    v_add_f32 v30, v30, v105
    v_cvt_pk_bf16_f32 v91, v104, v105
    v_exp_f32 v104, v48
    v_exp_f32 v105, v49
    v_add_f32 v30, v30, v104
    v_add_f32 v30, v30, v105
    v_cvt_pk_bf16_f32 v92, v104, v105
    v_exp_f32 v104, v50
    v_exp_f32 v105, v51
    v_add_f32 v30, v30, v104
    v_add_f32 v30, v30, v105
    v_cvt_pk_bf16_f32 v93, v104, v105
    v_exp_f32 v104, v52
    v_exp_f32 v105, v53
    v_add_f32 v30, v30, v104
    v_add_f32 v30, v30, v105
    v_cvt_pk_bf16_f32 v94, v104, v105
    v_exp_f32 v104, v54
    v_exp_f32 v105, v55
    v_add_f32 v30, v30, v104
    v_add_f32 v30, v30, v105
    v_cvt_pk_bf16_f32 v95, v104, v105
    s_nop 3
    s_setpc_b64 s[30:31]
K1_RARE_100:
    s_nop 15
    v_max3_f32 v30, v56, v57, v58
    v_max3_f32 v31, v59, v60, v61
    v_max3_f32 v30, v30, v62, v63
    v_max3_f32 v31, v31, v64, v65
    v_max3_f32 v30, v30, v66, v67
    v_max3_f32 v31, v31, v68, v69
    v_max3_f32 v30, v30, v70, v71
    v_max_f32 v30, v30, v31
    v_mov_b32 v31, v30
    s_nop 1
    v_permlane32_swap_b32 v30, v31
    v_max_f32 v30, v30, v31
    v_max_f32 v30, 0, v30
    v_sub_f32 v31, 0, v30
    v_exp_f32 v31, v31
    v_sub_f32 v56, v56, v30
    v_sub_f32 v72, v72, v30
    v_sub_f32 v57, v57, v30
    v_sub_f32 v73, v73, v30
    v_sub_f32 v58, v58, v30
    v_sub_f32 v74, v74, v30
    v_sub_f32 v59, v59, v30
    v_sub_f32 v75, v75, v30
    v_sub_f32 v60, v60, v30
    v_sub_f32 v76, v76, v30
    v_sub_f32 v61, v61, v30
    v_sub_f32 v77, v77, v30
    v_sub_f32 v62, v62, v30
    v_sub_f32 v78, v78, v30
    v_sub_f32 v63, v63, v30
    v_sub_f32 v79, v79, v30
    v_sub_f32 v64, v64, v30
    v_sub_f32 v80, v80, v30
    v_sub_f32 v65, v65, v30
    v_sub_f32 v81, v81, v30
    v_sub_f32 v66, v66, v30
    v_sub_f32 v82, v82, v30
    v_sub_f32 v67, v67, v30
    v_sub_f32 v83, v83, v30
    v_sub_f32 v68, v68, v30
    v_sub_f32 v84, v84, v30
    v_sub_f32 v69, v69, v30
    v_sub_f32 v85, v85, v30
    v_sub_f32 v70, v70, v30
    v_sub_f32 v86, v86, v30
    v_sub_f32 v71, v71, v30
    v_sub_f32 v87, v87, v30
    v_mul_f32 v28, v28, v31
    v_accvgpr_read_b32 v104, a144
    v_mul_f32 v104, v104, v31
    v_accvgpr_write_b32 a144, v104
    v_accvgpr_read_b32 v104, a145
    v_mul_f32 v104, v104, v31
    v_accvgpr_write_b32 a145, v104
    v_accvgpr_read_b32 v104, a146
    v_mul_f32 v104, v104, v31
    v_accvgpr_write_b32 a146, v104
    v_accvgpr_read_b32 v104, a147
    v_mul_f32 v104, v104, v31
    v_accvgpr_write_b32 a147, v104
    v_accvgpr_read_b32 v104, a148
    v_mul_f32 v104, v104, v31
    v_accvgpr_write_b32 a148, v104
    v_accvgpr_read_b32 v104, a149
    v_mul_f32 v104, v104, v31
    v_accvgpr_write_b32 a149, v104
    v_accvgpr_read_b32 v104, a150
    v_mul_f32 v104, v104, v31
    v_accvgpr_write_b32 a150, v104
    v_accvgpr_read_b32 v104, a151
    v_mul_f32 v104, v104, v31
    v_accvgpr_write_b32 a151, v104
    v_accvgpr_read_b32 v104, a152
    v_mul_f32 v104, v104, v31
    v_accvgpr_write_b32 a152, v104
    v_accvgpr_read_b32 v104, a153
    v_mul_f32 v104, v104, v31
    v_accvgpr_write_b32 a153, v104
    v_accvgpr_read_b32 v104, a154
    v_mul_f32 v104, v104, v31
    v_accvgpr_write_b32 a154, v104
    v_accvgpr_read_b32 v104, a155
    v_mul_f32 v104, v104, v31
    v_accvgpr_write_b32 a155, v104
    v_accvgpr_read_b32 v104, a156
    v_mul_f32 v104, v104, v31
    v_accvgpr_write_b32 a156, v104
    v_accvgpr_read_b32 v104, a157
    v_mul_f32 v104, v104, v31
    v_accvgpr_write_b32 a157, v104
    v_accvgpr_read_b32 v104, a158
    v_mul_f32 v104, v104, v31
    v_accvgpr_write_b32 a158, v104
    v_accvgpr_read_b32 v104, a159
    v_mul_f32 v104, v104, v31
    v_accvgpr_write_b32 a159, v104
    v_accvgpr_read_b32 v104, a160
    v_mul_f32 v104, v104, v31
    v_accvgpr_write_b32 a160, v104
    v_accvgpr_read_b32 v104, a161
    v_mul_f32 v104, v104, v31
    v_accvgpr_write_b32 a161, v104
    v_accvgpr_read_b32 v104, a162
    v_mul_f32 v104, v104, v31
    v_accvgpr_write_b32 a162, v104
    v_accvgpr_read_b32 v104, a163
    v_mul_f32 v104, v104, v31
    v_accvgpr_write_b32 a163, v104
    v_accvgpr_read_b32 v104, a164
    v_mul_f32 v104, v104, v31
    v_accvgpr_write_b32 a164, v104
    v_accvgpr_read_b32 v104, a165
    v_mul_f32 v104, v104, v31
    v_accvgpr_write_b32 a165, v104
    v_accvgpr_read_b32 v104, a166
    v_mul_f32 v104, v104, v31
    v_accvgpr_write_b32 a166, v104
    v_accvgpr_read_b32 v104, a167
    v_mul_f32 v104, v104, v31
    v_accvgpr_write_b32 a167, v104
    v_accvgpr_read_b32 v104, a168
    v_mul_f32 v104, v104, v31
    v_accvgpr_write_b32 a168, v104
    v_accvgpr_read_b32 v104, a169
    v_mul_f32 v104, v104, v31
    v_accvgpr_write_b32 a169, v104
    v_accvgpr_read_b32 v104, a170
    v_mul_f32 v104, v104, v31
    v_accvgpr_write_b32 a170, v104
    v_accvgpr_read_b32 v104, a171
    v_mul_f32 v104, v104, v31
    v_accvgpr_write_b32 a171, v104
    v_accvgpr_read_b32 v104, a172
    v_mul_f32 v104, v104, v31
    v_accvgpr_write_b32 a172, v104
    v_accvgpr_read_b32 v104, a173
    v_mul_f32 v104, v104, v31
    v_accvgpr_write_b32 a173, v104
    v_accvgpr_read_b32 v104, a174
    v_mul_f32 v104, v104, v31
    v_accvgpr_write_b32 a174, v104
    v_accvgpr_read_b32 v104, a175
    v_mul_f32 v104, v104, v31
    v_accvgpr_write_b32 a175, v104
    v_accvgpr_read_b32 v104, a176
    v_mul_f32 v104, v104, v31
    v_accvgpr_write_b32 a176, v104
    v_accvgpr_read_b32 v104, a177
    v_mul_f32 v104, v104, v31
    v_accvgpr_write_b32 a177, v104
    v_accvgpr_read_b32 v104, a178
    v_mul_f32 v104, v104, v31
    v_accvgpr_write_b32 a178, v104
    v_accvgpr_read_b32 v104, a179
    v_mul_f32 v104, v104, v31
    v_accvgpr_write_b32 a179, v104
    v_accvgpr_read_b32 v104, a180
    v_mul_f32 v104, v104, v31
    v_accvgpr_write_b32 a180, v104
    v_accvgpr_read_b32 v104, a181
    v_mul_f32 v104, v104, v31
    v_accvgpr_write_b32 a181, v104
    v_accvgpr_read_b32 v104, a182
    v_mul_f32 v104, v104, v31
    v_accvgpr_write_b32 a182, v104
    v_accvgpr_read_b32 v104, a183
    v_mul_f32 v104, v104, v31
    v_accvgpr_write_b32 a183, v104
    v_accvgpr_read_b32 v104, a184
    v_mul_f32 v104, v104, v31
    v_accvgpr_write_b32 a184, v104
    v_accvgpr_read_b32 v104, a185
    v_mul_f32 v104, v104, v31
    v_accvgpr_write_b32 a185, v104
    v_accvgpr_read_b32 v104, a186
    v_mul_f32 v104, v104, v31
    v_accvgpr_write_b32 a186, v104
    v_accvgpr_read_b32 v104, a187
    v_mul_f32 v104, v104, v31
    v_accvgpr_write_b32 a187, v104
    v_accvgpr_read_b32 v104, a188
    v_mul_f32 v104, v104, v31
    v_accvgpr_write_b32 a188, v104
    v_accvgpr_read_b32 v104, a189
    v_mul_f32 v104, v104, v31
    v_accvgpr_write_b32 a189, v104
    v_accvgpr_read_b32 v104, a190
    v_mul_f32 v104, v104, v31
    v_accvgpr_write_b32 a190, v104
    v_accvgpr_read_b32 v104, a191
    v_mul_f32 v104, v104, v31
    v_accvgpr_write_b32 a191, v104
    v_accvgpr_read_b32 v104, a192
    v_mul_f32 v104, v104, v31
    v_accvgpr_write_b32 a192, v104
    v_accvgpr_read_b32 v104, a193
    v_mul_f32 v104, v104, v31
    v_accvgpr_write_b32 a193, v104
    v_accvgpr_read_b32 v104, a194
    v_mul_f32 v104, v104, v31
    v_accvgpr_write_b32 a194, v104
    v_accvgpr_read_b32 v104, a195
    v_mul_f32 v104, v104, v31
    v_accvgpr_write_b32 a195, v104
    v_accvgpr_read_b32 v104, a196
    v_mul_f32 v104, v104, v31
    v_accvgpr_write_b32 a196, v104
    v_accvgpr_read_b32 v104, a197
    v_mul_f32 v104, v104, v31
    v_accvgpr_write_b32 a197, v104
    v_accvgpr_read_b32 v104, a198
    v_mul_f32 v104, v104, v31
    v_accvgpr_write_b32 a198, v104
    v_accvgpr_read_b32 v104, a199
    v_mul_f32 v104, v104, v31
    v_accvgpr_write_b32 a199, v104
    v_accvgpr_read_b32 v104, a200
    v_mul_f32 v104, v104, v31
    v_accvgpr_write_b32 a200, v104
    v_accvgpr_read_b32 v104, a201
    v_mul_f32 v104, v104, v31
    v_accvgpr_write_b32 a201, v104
    v_accvgpr_read_b32 v104, a202
    v_mul_f32 v104, v104, v31
    v_accvgpr_write_b32 a202, v104
    v_accvgpr_read_b32 v104, a203
    v_mul_f32 v104, v104, v31
    v_accvgpr_write_b32 a203, v104
    v_accvgpr_read_b32 v104, a204
    v_mul_f32 v104, v104, v31
    v_accvgpr_write_b32 a204, v104
    v_accvgpr_read_b32 v104, a205
    v_mul_f32 v104, v104, v31
    v_accvgpr_write_b32 a205, v104
    v_accvgpr_read_b32 v104, a206
    v_mul_f32 v104, v104, v31
    v_accvgpr_write_b32 a206, v104
    v_accvgpr_read_b32 v104, a207
    v_mul_f32 v104, v104, v31
    v_accvgpr_write_b32 a207, v104
    v_mov_b32 v30, 0
    v_exp_f32 v104, v56
    v_exp_f32 v105, v57
    v_add_f32 v30, v30, v104
    v_add_f32 v30, v30, v105
    v_cvt_pk_bf16_f32 v96, v104, v105
    v_exp_f32 v104, v58
    v_exp_f32 v105, v59
    v_add_f32 v30, v30, v104
    v_add_f32 v30, v30, v105
    v_cvt_pk_bf16_f32 v97, v104, v105
    v_exp_f32 v104, v60
    v_exp_f32 v105, v61
    v_add_f32 v30, v30, v104
    v_add_f32 v30, v30, v105
    v_cvt_pk_bf16_f32 v98, v104, v105
    v_exp_f32 v104, v62
    v_exp_f32 v105, v63
    v_add_f32 v30, v30, v104
    v_add_f32 v30, v30, v105
    v_cvt_pk_bf16_f32 v99, v104, v105
    v_exp_f32 v104, v64
    v_exp_f32 v105, v65
    v_add_f32 v30, v30, v104
    v_add_f32 v30, v30, v105
    v_cvt_pk_bf16_f32 v100, v104, v105
    v_exp_f32 v104, v66
    v_exp_f32 v105, v67
    v_add_f32 v30, v30, v104
    v_add_f32 v30, v30, v105
    v_cvt_pk_bf16_f32 v101, v104, v105
    v_exp_f32 v104, v68
    v_exp_f32 v105, v69
    v_add_f32 v30, v30, v104
    v_add_f32 v30, v30, v105
    v_cvt_pk_bf16_f32 v102, v104, v105
    v_exp_f32 v104, v70
    v_exp_f32 v105, v71
    v_add_f32 v30, v30, v104
    v_add_f32 v30, v30, v105
    v_cvt_pk_bf16_f32 v103, v104, v105
    s_nop 3
    s_setpc_b64 s[30:31]
K1_RARE_111:
    s_nop 15
    v_max3_f32 v30, v56, v57, v58
    v_max3_f32 v31, v59, v60, v61
    v_max3_f32 v30, v30, v62, v63
    v_max3_f32 v31, v31, v64, v65
    v_max3_f32 v30, v30, v66, v67
    v_max3_f32 v31, v31, v68, v69
    v_max3_f32 v30, v30, v70, v71
    v_max_f32 v30, v30, v31
    v_mov_b32 v31, v30
    s_nop 1
    v_permlane32_swap_b32 v30, v31
    v_max_f32 v30, v30, v31
    v_max_f32 v30, 0, v30
    v_sub_f32 v31, 0, v30
    v_exp_f32 v31, v31
    v_sub_f32 v56, v56, v30
    v_sub_f32 v72, v72, v30
    v_sub_f32 v40, v40, v30
    v_sub_f32 v57, v57, v30
    v_sub_f32 v73, v73, v30
    v_sub_f32 v41, v41, v30
    v_sub_f32 v58, v58, v30
    v_sub_f32 v74, v74, v30
    v_sub_f32 v42, v42, v30
    v_sub_f32 v59, v59, v30
    v_sub_f32 v75, v75, v30
    v_sub_f32 v43, v43, v30
    v_sub_f32 v60, v60, v30
    v_sub_f32 v76, v76, v30
    v_sub_f32 v44, v44, v30
    v_sub_f32 v61, v61, v30
    v_sub_f32 v77, v77, v30
    v_sub_f32 v45, v45, v30
    v_sub_f32 v62, v62, v30
    v_sub_f32 v78, v78, v30
    v_sub_f32 v46, v46, v30
    v_sub_f32 v63, v63, v30
    v_sub_f32 v79, v79, v30
    v_sub_f32 v47, v47, v30
    v_sub_f32 v64, v64, v30
    v_sub_f32 v80, v80, v30
    v_sub_f32 v48, v48, v30
    v_sub_f32 v65, v65, v30
    v_sub_f32 v81, v81, v30
    v_sub_f32 v49, v49, v30
    v_sub_f32 v66, v66, v30
    v_sub_f32 v82, v82, v30
    v_sub_f32 v50, v50, v30
    v_sub_f32 v67, v67, v30
    v_sub_f32 v83, v83, v30
    v_sub_f32 v51, v51, v30
    v_sub_f32 v68, v68, v30
    v_sub_f32 v84, v84, v30
    v_sub_f32 v52, v52, v30
    v_sub_f32 v69, v69, v30
    v_sub_f32 v85, v85, v30
    v_sub_f32 v53, v53, v30
    v_sub_f32 v70, v70, v30
    v_sub_f32 v86, v86, v30
    v_sub_f32 v54, v54, v30
    v_sub_f32 v71, v71, v30
    v_sub_f32 v87, v87, v30
    v_sub_f32 v55, v55, v30
    v_mul_f32 v29, v29, v31
    v_mul_f32 v160, v160, v31
    v_mul_f32 v161, v161, v31
    v_mul_f32 v162, v162, v31
    v_mul_f32 v163, v163, v31
    v_mul_f32 v164, v164, v31
    v_mul_f32 v165, v165, v31
    v_mul_f32 v166, v166, v31
    v_mul_f32 v167, v167, v31
    v_mul_f32 v168, v168, v31
    v_mul_f32 v169, v169, v31
    v_mul_f32 v170, v170, v31
    v_mul_f32 v171, v171, v31
    v_mul_f32 v172, v172, v31
    v_mul_f32 v173, v173, v31
    v_mul_f32 v174, v174, v31
    v_mul_f32 v175, v175, v31
    v_mul_f32 v176, v176, v31
    v_mul_f32 v177, v177, v31
    v_mul_f32 v178, v178, v31
    v_mul_f32 v179, v179, v31
    v_mul_f32 v180, v180, v31
    v_mul_f32 v181, v181, v31
    v_mul_f32 v182, v182, v31
    v_mul_f32 v183, v183, v31
    v_mul_f32 v184, v184, v31
    v_mul_f32 v185, v185, v31
    v_mul_f32 v186, v186, v31
    v_mul_f32 v187, v187, v31
    v_mul_f32 v188, v188, v31
    v_mul_f32 v189, v189, v31
    v_mul_f32 v190, v190, v31
    v_mul_f32 v191, v191, v31
    v_mul_f32 v192, v192, v31
    v_mul_f32 v193, v193, v31
    v_mul_f32 v194, v194, v31
    v_mul_f32 v195, v195, v31
    v_mul_f32 v196, v196, v31
    v_mul_f32 v197, v197, v31
    v_mul_f32 v198, v198, v31
    v_mul_f32 v199, v199, v31
    v_mul_f32 v200, v200, v31
    v_mul_f32 v201, v201, v31
    v_mul_f32 v202, v202, v31
    v_mul_f32 v203, v203, v31
    v_mul_f32 v204, v204, v31
    v_mul_f32 v205, v205, v31
    v_mul_f32 v206, v206, v31
    v_mul_f32 v207, v207, v31
    v_mul_f32 v208, v208, v31
    v_mul_f32 v209, v209, v31
    v_mul_f32 v210, v210, v31
    v_mul_f32 v211, v211, v31
    v_mul_f32 v212, v212, v31
    v_mul_f32 v213, v213, v31
    v_mul_f32 v214, v214, v31
    v_mul_f32 v215, v215, v31
    v_mul_f32 v216, v216, v31
    v_mul_f32 v217, v217, v31
    v_mul_f32 v218, v218, v31
    v_mul_f32 v219, v219, v31
    v_mul_f32 v220, v220, v31
    v_mul_f32 v221, v221, v31
    v_mul_f32 v222, v222, v31
    v_mul_f32 v223, v223, v31
    v_mov_b32 v30, 0
    v_exp_f32 v104, v56
    v_exp_f32 v105, v57
    v_add_f32 v30, v30, v104
    v_add_f32 v30, v30, v105
    v_cvt_pk_bf16_f32 v96, v104, v105
    v_exp_f32 v104, v58
    v_exp_f32 v105, v59
    v_add_f32 v30, v30, v104
    v_add_f32 v30, v30, v105
    v_cvt_pk_bf16_f32 v97, v104, v105
    v_exp_f32 v104, v60
    v_exp_f32 v105, v61
    v_add_f32 v30, v30, v104
    v_add_f32 v30, v30, v105
    v_cvt_pk_bf16_f32 v98, v104, v105
    v_exp_f32 v104, v62
    v_exp_f32 v105, v63
    v_add_f32 v30, v30, v104
    v_add_f32 v30, v30, v105
    v_cvt_pk_bf16_f32 v99, v104, v105
    v_exp_f32 v104, v64
    v_exp_f32 v105, v65
    v_add_f32 v30, v30, v104
    v_add_f32 v30, v30, v105
    v_cvt_pk_bf16_f32 v100, v104, v105
    v_exp_f32 v104, v66
    v_exp_f32 v105, v67
    v_add_f32 v30, v30, v104
    v_add_f32 v30, v30, v105
    v_cvt_pk_bf16_f32 v101, v104, v105
    v_exp_f32 v104, v68
    v_exp_f32 v105, v69
    v_add_f32 v30, v30, v104
    v_add_f32 v30, v30, v105
    v_cvt_pk_bf16_f32 v102, v104, v105
    v_exp_f32 v104, v70
    v_exp_f32 v105, v71
    v_add_f32 v30, v30, v104
    v_add_f32 v30, v30, v105
    v_cvt_pk_bf16_f32 v103, v104, v105
    s_nop 3
    s_setpc_b64 s[30:31]
K1_RARE_011:
    s_nop 15
    v_max3_f32 v30, v40, v41, v42
    v_max3_f32 v31, v43, v44, v45
    v_max3_f32 v30, v30, v46, v47
    v_max3_f32 v31, v31, v48, v49
    v_max3_f32 v30, v30, v50, v51
    v_max3_f32 v31, v31, v52, v53
    v_max3_f32 v30, v30, v54, v55
    v_max_f32 v30, v30, v31
    v_mov_b32 v31, v30
    s_nop 1
    v_permlane32_swap_b32 v30, v31
    v_max_f32 v30, v30, v31
    v_max_f32 v30, 0, v30
    v_sub_f32 v31, 0, v30
    v_exp_f32 v31, v31
    v_sub_f32 v40, v40, v30
    v_sub_f32 v72, v72, v30
    v_sub_f32 v56, v56, v30
    v_sub_f32 v41, v41, v30
    v_sub_f32 v73, v73, v30
    v_sub_f32 v57, v57, v30
    v_sub_f32 v42, v42, v30
    v_sub_f32 v74, v74, v30
    v_sub_f32 v58, v58, v30
    v_sub_f32 v43, v43, v30
    v_sub_f32 v75, v75, v30
    v_sub_f32 v59, v59, v30
    v_sub_f32 v44, v44, v30
    v_sub_f32 v76, v76, v30
    v_sub_f32 v60, v60, v30
    v_sub_f32 v45, v45, v30
    v_sub_f32 v77, v77, v30
    v_sub_f32 v61, v61, v30
    v_sub_f32 v46, v46, v30
    v_sub_f32 v78, v78, v30
    v_sub_f32 v62, v62, v30
    v_sub_f32 v47, v47, v30
    v_sub_f32 v79, v79, v30
    v_sub_f32 v63, v63, v30
    v_sub_f32 v48, v48, v30
    v_sub_f32 v80, v80, v30
    v_sub_f32 v64, v64, v30
    v_sub_f32 v49, v49, v30
    v_sub_f32 v81, v81, v30
    v_sub_f32 v65, v65, v30
    v_sub_f32 v50, v50, v30
    v_sub_f32 v82, v82, v30
    v_sub_f32 v66, v66, v30
    v_sub_f32 v51, v51, v30
    v_sub_f32 v83, v83, v30
    v_sub_f32 v67, v67, v30
    v_sub_f32 v52, v52, v30
    v_sub_f32 v84, v84, v30
    v_sub_f32 v68, v68, v30
    v_sub_f32 v53, v53, v30
    v_sub_f32 v85, v85, v30
    v_sub_f32 v69, v69, v30
    v_sub_f32 v54, v54, v30
    v_sub_f32 v86, v86, v30
    v_sub_f32 v70, v70, v30
    v_sub_f32 v55, v55, v30
    v_sub_f32 v87, v87, v30
    v_sub_f32 v71, v71, v30
    v_mul_f32 v29, v29, v31
    v_mul_f32 v160, v160, v31
    v_mul_f32 v161, v161, v31
    v_mul_f32 v162, v162, v31
    v_mul_f32 v163, v163, v31
    v_mul_f32 v164, v164, v31
    v_mul_f32 v165, v165, v31
    v_mul_f32 v166, v166, v31
    v_mul_f32 v167, v167, v31
    v_mul_f32 v168, v168, v31
    v_mul_f32 v169, v169, v31
    v_mul_f32 v170, v170, v31
    v_mul_f32 v171, v171, v31
    v_mul_f32 v172, v172, v31
    v_mul_f32 v173, v173, v31
    v_mul_f32 v174, v174, v31
    v_mul_f32 v175, v175, v31
    v_mul_f32 v176, v176, v31
    v_mul_f32 v177, v177, v31
    v_mul_f32 v178, v178, v31
    v_mul_f32 v179, v179, v31
    v_mul_f32 v180, v180, v31
    v_mul_f32 v181, v181, v31
    v_mul_f32 v182, v182, v31
    v_mul_f32 v183, v183, v31
    v_mul_f32 v184, v184, v31
    v_mul_f32 v185, v185, v31
    v_mul_f32 v186, v186, v31
    v_mul_f32 v187, v187, v31
    v_mul_f32 v188, v188, v31
    v_mul_f32 v189, v189, v31
    v_mul_f32 v190, v190, v31
    v_mul_f32 v191, v191, v31
    v_mul_f32 v192, v192, v31
    v_mul_f32 v193, v193, v31
    v_mul_f32 v194, v194, v31
    v_mul_f32 v195, v195, v31
    v_mul_f32 v196, v196, v31
    v_mul_f32 v197, v197, v31
    v_mul_f32 v198, v198, v31
    v_mul_f32 v199, v199, v31
    v_mul_f32 v200, v200, v31
    v_mul_f32 v201, v201, v31
    v_mul_f32 v202, v202, v31
    v_mul_f32 v203, v203, v31
    v_mul_f32 v204, v204, v31
    v_mul_f32 v205, v205, v31
    v_mul_f32 v206, v206, v31
    v_mul_f32 v207, v207, v31
    v_mul_f32 v208, v208, v31
    v_mul_f32 v209, v209, v31
    v_mul_f32 v210, v210, v31
    v_mul_f32 v211, v211, v31
    v_mul_f32 v212, v212, v31
    v_mul_f32 v213, v213, v31
    v_mul_f32 v214, v214, v31
    v_mul_f32 v215, v215, v31
    v_mul_f32 v216, v216, v31
    v_mul_f32 v217, v217, v31
    v_mul_f32 v218, v218, v31
    v_mul_f32 v219, v219, v31
    v_mul_f32 v220, v220, v31
    v_mul_f32 v221, v221, v31
    v_mul_f32 v222, v222, v31
    v_mul_f32 v223, v223, v31
    v_mov_b32 v30, 0
    v_exp_f32 v104, v40
    v_exp_f32 v105, v41
    v_add_f32 v30, v30, v104
    v_add_f32 v30, v30, v105
    v_cvt_pk_bf16_f32 v88, v104, v105
    v_exp_f32 v104, v42
    v_exp_f32 v105, v43
    v_add_f32 v30, v30, v104
    v_add_f32 v30, v30, v105
    v_cvt_pk_bf16_f32 v89, v104, v105
    v_exp_f32 v104, v44
    v_exp_f32 v105, v45
    v_add_f32 v30, v30, v104
    v_add_f32 v30, v30, v105
    v_cvt_pk_bf16_f32 v90, v104, v105
    v_exp_f32 v104, v46
    v_exp_f32 v105, v47
    v_add_f32 v30, v30, v104
    v_add_f32 v30, v30, v105
    v_cvt_pk_bf16_f32 v91, v104, v105
    v_exp_f32 v104, v48
    v_exp_f32 v105, v49
    v_add_f32 v30, v30, v104
    v_add_f32 v30, v30, v105
    v_cvt_pk_bf16_f32 v92, v104, v105
    v_exp_f32 v104, v50
    v_exp_f32 v105, v51
    v_add_f32 v30, v30, v104
    v_add_f32 v30, v30, v105
    v_cvt_pk_bf16_f32 v93, v104, v105
    v_exp_f32 v104, v52
    v_exp_f32 v105, v53
    v_add_f32 v30, v30, v104
    v_add_f32 v30, v30, v105
    v_cvt_pk_bf16_f32 v94, v104, v105
    v_exp_f32 v104, v54
    v_exp_f32 v105, v55
    v_add_f32 v30, v30, v104
    v_add_f32 v30, v30, v105
    v_cvt_pk_bf16_f32 v95, v104, v105
    s_nop 3
    s_setpc_b64 s[30:31]
K1_RARE_110:
    s_nop 15
    v_max3_f32 v30, v56, v57, v58
    v_max3_f32 v31, v59, v60, v61
    v_max3_f32 v30, v30, v62, v63
    v_max3_f32 v31, v31, v64, v65
    v_max3_f32 v30, v30, v66, v67
    v_max3_f32 v31, v31, v68, v69
    v_max3_f32 v30, v30, v70, v71
    v_max_f32 v30, v30, v31
    v_mov_b32 v31, v30
    s_nop 1
    v_permlane32_swap_b32 v30, v31
    v_max_f32 v30, v30, v31
    v_max_f32 v30, 0, v30
    v_sub_f32 v31, 0, v30
    v_exp_f32 v31, v31
    v_sub_f32 v56, v56, v30
    v_sub_f32 v72, v72, v30
    v_sub_f32 v57, v57, v30
    v_sub_f32 v73, v73, v30
    v_sub_f32 v58, v58, v30
    v_sub_f32 v74, v74, v30
    v_sub_f32 v59, v59, v30
    v_sub_f32 v75, v75, v30
    v_sub_f32 v60, v60, v30
    v_sub_f32 v76, v76, v30
    v_sub_f32 v61, v61, v30
    v_sub_f32 v77, v77, v30
    v_sub_f32 v62, v62, v30
    v_sub_f32 v78, v78, v30
    v_sub_f32 v63, v63, v30
    v_sub_f32 v79, v79, v30
    v_sub_f32 v64, v64, v30
    v_sub_f32 v80, v80, v30
    v_sub_f32 v65, v65, v30
    v_sub_f32 v81, v81, v30
    v_sub_f32 v66, v66, v30
    v_sub_f32 v82, v82, v30
    v_sub_f32 v67, v67, v30
    v_sub_f32 v83, v83, v30
    v_sub_f32 v68, v68, v30
    v_sub_f32 v84, v84, v30
    v_sub_f32 v69, v69, v30
    v_sub_f32 v85, v85, v30
    v_sub_f32 v70, v70, v30
    v_sub_f32 v86, v86, v30
    v_sub_f32 v71, v71, v30
    v_sub_f32 v87, v87, v30
    v_mul_f32 v29, v29, v31
    v_mul_f32 v160, v160, v31
    v_mul_f32 v161, v161, v31
    v_mul_f32 v162, v162, v31
    v_mul_f32 v163, v163, v31
    v_mul_f32 v164, v164, v31
    v_mul_f32 v165, v165, v31
    v_mul_f32 v166, v166, v31
    v_mul_f32 v167, v167, v31
    v_mul_f32 v168, v168, v31
    v_mul_f32 v169, v169, v31
    v_mul_f32 v170, v170, v31
    v_mul_f32 v171, v171, v31
    v_mul_f32 v172, v172, v31
    v_mul_f32 v173, v173, v31
    v_mul_f32 v174, v174, v31
    v_mul_f32 v175, v175, v31
    v_mul_f32 v176, v176, v31
    v_mul_f32 v177, v177, v31
    v_mul_f32 v178, v178, v31
    v_mul_f32 v179, v179, v31
    v_mul_f32 v180, v180, v31
    v_mul_f32 v181, v181, v31
    v_mul_f32 v182, v182, v31
    v_mul_f32 v183, v183, v31
    v_mul_f32 v184, v184, v31
    v_mul_f32 v185, v185, v31
    v_mul_f32 v186, v186, v31
    v_mul_f32 v187, v187, v31
    v_mul_f32 v188, v188, v31
    v_mul_f32 v189, v189, v31
    v_mul_f32 v190, v190, v31
    v_mul_f32 v191, v191, v31
    v_mul_f32 v192, v192, v31
    v_mul_f32 v193, v193, v31
    v_mul_f32 v194, v194, v31
    v_mul_f32 v195, v195, v31
    v_mul_f32 v196, v196, v31
    v_mul_f32 v197, v197, v31
    v_mul_f32 v198, v198, v31
    v_mul_f32 v199, v199, v31
    v_mul_f32 v200, v200, v31
    v_mul_f32 v201, v201, v31
    v_mul_f32 v202, v202, v31
    v_mul_f32 v203, v203, v31
    v_mul_f32 v204, v204, v31
    v_mul_f32 v205, v205, v31
    v_mul_f32 v206, v206, v31
    v_mul_f32 v207, v207, v31
    v_mul_f32 v208, v208, v31
    v_mul_f32 v209, v209, v31
    v_mul_f32 v210, v210, v31
    v_mul_f32 v211, v211, v31
    v_mul_f32 v212, v212, v31
    v_mul_f32 v213, v213, v31
    v_mul_f32 v214, v214, v31
    v_mul_f32 v215, v215, v31
    v_mul_f32 v216, v216, v31
    v_mul_f32 v217, v217, v31
    v_mul_f32 v218, v218, v31
    v_mul_f32 v219, v219, v31
    v_mul_f32 v220, v220, v31
    v_mul_f32 v221, v221, v31
    v_mul_f32 v222, v222, v31
    v_mul_f32 v223, v223, v31
    v_mov_b32 v30, 0
    v_exp_f32 v104, v56
    v_exp_f32 v105, v57
    v_add_f32 v30, v30, v104
    v_add_f32 v30, v30, v105
    v_cvt_pk_bf16_f32 v96, v104, v105
    v_exp_f32 v104, v58
    v_exp_f32 v105, v59
    v_add_f32 v30, v30, v104
    v_add_f32 v30, v30, v105
    v_cvt_pk_bf16_f32 v97, v104, v105
    v_exp_f32 v104, v60
    v_exp_f32 v105, v61
    v_add_f32 v30, v30, v104
    v_add_f32 v30, v30, v105
    v_cvt_pk_bf16_f32 v98, v104, v105
    v_exp_f32 v104, v62
    v_exp_f32 v105, v63
    v_add_f32 v30, v30, v104
    v_add_f32 v30, v30, v105
    v_cvt_pk_bf16_f32 v99, v104, v105
    v_exp_f32 v104, v64
    v_exp_f32 v105, v65
    v_add_f32 v30, v30, v104
    v_add_f32 v30, v30, v105
    v_cvt_pk_bf16_f32 v100, v104, v105
    v_exp_f32 v104, v66
    v_exp_f32 v105, v67
    v_add_f32 v30, v30, v104
    v_add_f32 v30, v30, v105
    v_cvt_pk_bf16_f32 v101, v104, v105
    v_exp_f32 v104, v68
    v_exp_f32 v105, v69
    v_add_f32 v30, v30, v104
    v_add_f32 v30, v30, v105
    v_cvt_pk_bf16_f32 v102, v104, v105
    v_exp_f32 v104, v70
    v_exp_f32 v105, v71
    v_add_f32 v30, v30, v104
    v_add_f32 v30, v30, v105
    v_cvt_pk_bf16_f32 v103, v104, v105
    s_nop 3
    s_setpc_b64 s[30:31]
.section .rodata,"a"
.p2align 6
.amdhsa_kernel concat_heads__mha_block_cached__mha_block_cached__near_ridge_kernel
  .amdhsa_next_free_vgpr 512
  .amdhsa_next_free_sgpr 102
  .amdhsa_accum_offset 256
  .amdhsa_group_segment_fixed_size 0
  .amdhsa_kernarg_size 104
  .amdhsa_user_sgpr_count 2
  .amdhsa_user_sgpr_kernarg_segment_ptr 1
  .amdhsa_system_sgpr_workgroup_id_x 1
.end_amdhsa_kernel
```
